```python
import torch

def _softmax(x, axis=-1):
    return torch.softmax(x, dim=axis)
def _gelu(x):
    return torch.nn.functional.gelu(x, approximate="tanh")
def _silu(x):
    return torch.nn.functional.silu(x)
def _sigmoid(x):
    return torch.sigmoid(x)
def _layernorm(x, axis=-1, eps=1e-5):
    m = x.mean(dim=axis, keepdim=True)
    v = x.var(dim=axis, keepdim=True, unbiased=False)
    return (x - m) / torch.sqrt(v + eps)
def _scatter_add(tgt, idx, src, axis=0):
    return tgt.clone().index_add_(axis, idx, src)
def _segment_sum(src, seg, n):
    out = torch.zeros((n,) + src.shape[1:], dtype=src.dtype)
    return out.index_add_(0, seg, src)
def _pad(x, pw):
    flat = tuple(v for pair in reversed(pw) for v in pair)
    return torch.nn.functional.pad(x, flat)

kernel_name = 'sequential_preLN__linear_kernel_hedgehog__mixer_token_mlp__prompt'

def setup_inputs():

    _w = (lambda a: (lambda t: t.to(torch.bfloat16) if t.is_floating_point() else t)(torch.as_tensor(a)))
    def _A_setup():
        B, S, D, H = 1, 2048, 576, 32
        Dh = D // H
        return {
            "x": _w((lambda *s: torch.randn(*s, dtype=torch.bfloat16) * 0.05)(B, S, D)),
            "wqkv": _w((lambda *s: torch.randn(*s, dtype=torch.bfloat16) * 0.2)(D, 3 * D)),
            "w_phi": _w((lambda *s: torch.randn(*s, dtype=torch.bfloat16) * 0.2)(H, Dh, Dh) * (Dh ** -0.5)),
            "wo": _w((lambda *s: torch.randn(*s, dtype=torch.bfloat16) * 0.05)(D, D)),
        }
    _A_in = _A_setup()

    def _B_setup():
        B, S, D, F = 1, 2048, 576, 4608
        return {
            "x": _w((lambda *s: torch.randn(*s, dtype=torch.bfloat16) * 0.05)(B, S, D)),
            "w1": _w((lambda *s: torch.randn(*s, dtype=torch.bfloat16) * 0.4)(S, F) * (S ** -0.5)),
            "b1": _w((lambda *s: torch.randn(*s, dtype=torch.bfloat16) * 12.8)(F) * 0.02),
            "w2": _w((lambda *s: torch.randn(*s, dtype=torch.bfloat16) * 0.4)(F, S) * (F ** -0.5)),
            "b2": _w((lambda *s: torch.randn(*s, dtype=torch.bfloat16) * 6.4)(S) * 0.02),
        }
    _B_in = _B_setup()

    return {
        "A_x": _A_in["x"],
        "A_wqkv": _A_in["wqkv"],
        "A_w_phi": _A_in["w_phi"],
        "A_wo": _A_in["wo"],
        "B_x": _B_in["x"],
        "B_w1": _B_in["w1"],
        "B_b1": _B_in["b1"],
        "B_w2": _B_in["w2"],
        "B_b2": _B_in["b2"],
    }

def reference(A_x, A_wqkv, A_w_phi, A_wo, B_x, B_w1, B_b1, B_w2, B_b2):
    def _A_ref(x, wqkv, w_phi, wo):
        B, S, D = x.shape
        H = 32; Dh = D // H
        qkv = (lambda x, *d: x.permute(*d))((x @ wqkv).reshape(B, S, 3, H, Dh), 2, 0, 3, 1, 4)
        q, k, v = qkv[0], qkv[1], qkv[2]
        pq = torch.einsum("bhsd,hdf->bhsf", q, w_phi)
        pk = torch.einsum("bhsd,hdf->bhsf", k, w_phi)
        phi_q = torch.concatenate([_softmax(pq, axis=-1), _softmax(-pq, axis=-1)], axis=-1)
        phi_k = torch.concatenate([_softmax(pk, axis=-1), _softmax(-pk, axis=-1)], axis=-1)
        kv = torch.einsum("bhsf,bhsd->bhfd", phi_k, v)
        z  = torch.einsum("bhsf->bhf", phi_k)
        num = torch.einsum("bhqf,bhfd->bhqd", phi_q, kv)
        den = torch.einsum("bhqf,bhf->bhq", phi_q, z)[..., None] + 1e-6
        o = num / den
        return (lambda x, *d: x.permute(*d))(o, 0, 2, 1, 3).reshape(B, S, D) @ wo

    def _B_ref(x, w1, b1, w2, b2):
        B, S, D = x.shape
        h = _layernorm(x, axis=-1)
        u = torch.einsum("bsd,sf->bdf", h, w1) + b1
        u = _gelu(u)
        y = torch.einsum("bdf,fs->bds", u, w2) + b2
        return (lambda x, *d: x.permute(*d))(y, 0, 2, 1)

    x = A_x
    h = x + _A_ref(_layernorm(x, axis=-1), A_wqkv, A_w_phi, A_wo)
    h2 = h + _B_ref(_layernorm(h, axis=-1), B_w1, B_b1, B_w2, B_b2)
    return h2
```

```asm
; @launch kernel=sequential_preLN__linear_kernel_hedgehog__mixer_token_mlp__prompt_kernel grid=(256,1,1) block=(512,1,1) lds=163840
.amdgcn_target "amdgcn-amd-amdhsa--gfx950"
.text
.globl sequential_preLN__linear_kernel_hedgehog__mixer_token_mlp__prompt_kernel
.p2align 8
.type sequential_preLN__linear_kernel_hedgehog__mixer_token_mlp__prompt_kernel,@function
sequential_preLN__linear_kernel_hedgehog__mixer_token_mlp__prompt_kernel:
    s_cmp_ge_u32 s2, 256
    s_cbranch_scc1 sequential_preLN__linear_kernel_hedgehog__mixer_token_mlp__prompt_kernel_end
    s_load_dwordx4 s[4:7], s[0:1], 0
    s_load_dwordx2 s[10:11], s[0:1], 16
    s_load_dwordx4 s[60:63], s[0:1], 80
    s_bfe_u32 s13, s2, 0x30003
    s_and_b32 s14, s2, 7
    s_lshl_b32 s14, s14, 2
    s_lshr_b32 s3, s2, 6
    s_add_u32 s14, s14, s3
    v_lshrrev_b32 v1, 6, v0
    v_and_b32 v2, 63, v0
    v_lshrrev_b32 v4, 3, v2
    v_readfirstlane_b32 s58, v1
    v_and_b32 v5, 7, v2
    v_lshrrev_b32 v1, 4, v2
    v_and_b32 v3, 15, v2
    v_mul_u32_u24 v6, 1152, v4
    v_lshl_add_u32 v6, v5, 4, v6
    s_and_b32 s12, s58, 3
    s_mov_b32 s45, 0xffff0000
    s_lshl_b32 s15, s14, 6
    s_lshl_b32 s46, s12, 4
    s_add_u32 s15, s15, s46
    s_mul_i32 s15, s15, 1152
    s_add_u32 s3, s15, 9216
    s_waitcnt lgkmcnt(0)
    s_mov_b32 s8, s62
    s_mov_b32 s9, s63
    s_mul_i32 s50, s14, 2
    s_mul_i32 s51, s13, 0
    s_add_u32 s50, s50, s51
    s_mul_i32 s51, s50, 7282
    s_lshr_b32 s51, s51, 16
    s_mul_i32 s51, s51, 9
    s_sub_u32 s51, s50, s51
    s_lshl_b32 s51, s51, 1
    s_mov_b32 s59, s51
    s_cmp_lt_u32 s58, 4
    s_cbranch_scc1 sequential_preLN__linear_kernel_hedgehog__mixer_token_mlp__prompt_kernel_kv
    v_and_b32 v220, 2, v1
    v_and_b32 v221, 1, v1
    v_lshl_add_u32 v220, v220, 1, v221
    v_xor_b32 v220, v3, v220
    v_xor_b32 v221, 8, v220
    v_mul_u32_u24 v222, 3456, v1
    v_lshl_add_u32 v8, v220, 4, v222
    v_lshl_add_u32 v9, v221, 4, v222
    v_add_u32 v9, 12800, v9
    s_mov_b32 s20, s6
    s_mov_b32 s21, s7
    s_mov_b32 s22, 1990656
    s_mov_b32 s23, 0x00020000
    s_lshl_b32 s47, s51, 2
    s_add_u32 s47, s47, s12
    s_mul_i32 s47, s47, 27648
    s_mul_i32 s46, s13, 144
    s_and_b32 s46, s46, 0xffffff80
    s_add_u32 s47, s47, s46
    s_lshl_b32 s48, s12, 11
    s_mov_b32 s53, 110592
    s_mov_b32 s54, 4293087232
    s_barrier
    s_add_u32 m0, s48, 0
    s_add_u32 s44, s47, 0
    buffer_load_dwordx4 v8, s[20:23], s44 offen lds
    buffer_load_dwordx4 v9, s[20:23], s44 offen offset:1024 lds
    s_add_u32 m0, s48, 8192
    s_add_u32 s44, s47, 1152
    buffer_load_dwordx4 v8, s[20:23], s44 offen lds
    buffer_load_dwordx4 v9, s[20:23], s44 offen offset:1024 lds
    s_add_u32 m0, s48, 16384
    s_add_u32 s44, s47, 2304
    buffer_load_dwordx4 v8, s[20:23], s44 offen lds
    buffer_load_dwordx4 v9, s[20:23], s44 offen offset:1024 lds
    s_add_u32 s51, s51, 1
    s_cmp_lg_u32 s51, 18
    s_cselect_b32 s44, s53, s54
    s_cselect_b32 s51, s51, 0
    s_add_u32 s47, s47, s44
    s_mov_b32 s24, s10
    s_mov_b32 s25, s11
    s_mov_b32 s26, 20736
    s_mov_b32 s27, 0x00020000
    s_add_u32 s36, s8, 66060288
    s_addc_u32 s37, s9, 0
    s_mov_b32 s38, 65536
    s_mov_b32 s39, 0x00020000
    s_add_u32 s40, s8, 67108864
    s_addc_u32 s41, s9, 0
    s_mov_b32 s42, 65536
    s_mov_b32 s43, 0x00020000
    s_lshl_b32 s46, s12, 8
    s_add_u32 s46, s46, 0
    v_add_u32 v16, s46, v2
    v_mul_u32_u24 v17, 6554, v16
    v_lshrrev_b32 v17, 16, v17
    v_mul_u32_u24 v18, 10, v17
    v_sub_u32 v18, v16, v18
    v_mul_u32_u24 v19, 3277, v17
    v_lshrrev_b32 v19, 16, v19
    v_mul_u32_u24 v20, 20, v19
    v_sub_u32 v20, v17, v20
    v_and_b32 v21, 1, v19
    v_lshlrev_b32 v21, 1, v21
    v_sub_u32 v20, v20, v21
    v_mul_u32_u24 v22, 648, v19
    v_mul_lo_u32 v23, v20, 36
    v_add_u32 v22, v22, v23
    v_lshl_add_u32 v22, v18, 2, v22
    v_cmp_gt_u32 vcc, 18, v20
    v_cmp_gt_u32 s[56:57], 9, v18
    v_cmp_gt_u32 s[92:93], 4, v19
    s_and_b64 vcc, vcc, s[56:57]
    s_and_b64 vcc, vcc, s[92:93]
    v_mov_b32 v23, 0x40000000
    v_cndmask_b32 v22, v23, v22, vcc
    s_lshl_b32 s46, s12, 10
    s_add_u32 m0, s46, 155648
    s_mul_i32 s46, s13, 2592
    buffer_load_dword v22, s[24:27], s46 offen lds
    s_lshl_b32 s46, s12, 8
    s_add_u32 s46, s46, 64
    v_add_u32 v16, s46, v2
    v_mul_u32_u24 v17, 6554, v16
    v_lshrrev_b32 v17, 16, v17
    v_mul_u32_u24 v18, 10, v17
    v_sub_u32 v18, v16, v18
    v_mul_u32_u24 v19, 3277, v17
    v_lshrrev_b32 v19, 16, v19
    v_mul_u32_u24 v20, 20, v19
    v_sub_u32 v20, v17, v20
    v_and_b32 v21, 1, v19
    v_lshlrev_b32 v21, 1, v21
    v_sub_u32 v20, v20, v21
    v_mul_u32_u24 v22, 648, v19
    v_mul_lo_u32 v23, v20, 36
    v_add_u32 v22, v22, v23
    v_lshl_add_u32 v22, v18, 2, v22
    v_cmp_gt_u32 vcc, 18, v20
    v_cmp_gt_u32 s[56:57], 9, v18
    v_cmp_gt_u32 s[92:93], 4, v19
    s_and_b64 vcc, vcc, s[56:57]
    s_and_b64 vcc, vcc, s[92:93]
    v_mov_b32 v23, 0x40000000
    v_cndmask_b32 v22, v23, v22, vcc
    s_lshl_b32 s46, s12, 10
    s_add_u32 m0, s46, 155904
    s_mul_i32 s46, s13, 2592
    buffer_load_dword v22, s[24:27], s46 offen lds
    s_lshl_b32 s46, s12, 8
    s_add_u32 s46, s46, 128
    v_add_u32 v16, s46, v2
    v_mul_u32_u24 v17, 6554, v16
    v_lshrrev_b32 v17, 16, v17
    v_mul_u32_u24 v18, 10, v17
    v_sub_u32 v18, v16, v18
    v_mul_u32_u24 v19, 3277, v17
    v_lshrrev_b32 v19, 16, v19
    v_mul_u32_u24 v20, 20, v19
    v_sub_u32 v20, v17, v20
    v_and_b32 v21, 1, v19
    v_lshlrev_b32 v21, 1, v21
    v_sub_u32 v20, v20, v21
    v_mul_u32_u24 v22, 648, v19
    v_mul_lo_u32 v23, v20, 36
    v_add_u32 v22, v22, v23
    v_lshl_add_u32 v22, v18, 2, v22
    v_cmp_gt_u32 vcc, 18, v20
    v_cmp_gt_u32 s[56:57], 9, v18
    v_cmp_gt_u32 s[92:93], 4, v19
    s_and_b64 vcc, vcc, s[56:57]
    s_and_b64 vcc, vcc, s[92:93]
    v_mov_b32 v23, 0x40000000
    v_cndmask_b32 v22, v23, v22, vcc
    s_lshl_b32 s46, s12, 10
    s_add_u32 m0, s46, 156160
    s_mul_i32 s46, s13, 2592
    buffer_load_dword v22, s[24:27], s46 offen lds
    s_lshl_b32 s46, s12, 8
    s_add_u32 s46, s46, 192
    v_add_u32 v16, s46, v2
    v_mul_u32_u24 v17, 6554, v16
    v_lshrrev_b32 v17, 16, v17
    v_mul_u32_u24 v18, 10, v17
    v_sub_u32 v18, v16, v18
    v_mul_u32_u24 v19, 3277, v17
    v_lshrrev_b32 v19, 16, v19
    v_mul_u32_u24 v20, 20, v19
    v_sub_u32 v20, v17, v20
    v_and_b32 v21, 1, v19
    v_lshlrev_b32 v21, 1, v21
    v_sub_u32 v20, v20, v21
    v_mul_u32_u24 v22, 648, v19
    v_mul_lo_u32 v23, v20, 36
    v_add_u32 v22, v22, v23
    v_lshl_add_u32 v22, v18, 2, v22
    v_cmp_gt_u32 vcc, 18, v20
    v_cmp_gt_u32 s[56:57], 9, v18
    v_cmp_gt_u32 s[92:93], 4, v19
    s_and_b64 vcc, vcc, s[56:57]
    s_and_b64 vcc, vcc, s[92:93]
    v_mov_b32 v23, 0x40000000
    v_cndmask_b32 v22, v23, v22, vcc
    s_lshl_b32 s46, s12, 10
    s_add_u32 m0, s46, 156416
    s_mul_i32 s46, s13, 2592
    buffer_load_dword v22, s[24:27], s46 offen lds
    v_mov_b32 v24, 0
    v_mov_b32 v25, 0
    v_mov_b32 v26, 0
    v_mov_b32 v27, 0
    v_lshlrev_b32 v28, 4, v2
    s_lshl_b32 s46, s2, 2
    s_add_u32 s46, s46, s12
    s_lshl_b32 s46, s46, 6
    s_mov_b64 exec, 15
    buffer_store_dwordx4 v[24:27], v28, s[36:39], s46 offen sc1
    buffer_store_dwordx4 v[24:27], v28, s[40:43], s46 offen sc1
    s_mov_b64 exec, -1
    v_mov_b32 v32, -1
    v_mov_b32 v33, -1
    v_lshlrev_b32 v29, 3, v2
    s_add_u32 s28, s8, 65536000
    s_addc_u32 s29, s9, 0
    s_mov_b32 s30, 51200
    s_mov_b32 s31, 0x00020000
    s_lshl_b32 s46, s13, 5
    s_add_u32 s46, s46, s14
    s_mul_i32 s46, s46, 200
    s_cmp_eq_u32 s12, 0
    s_cselect_b32 s46, s46, 0x40000000
    s_mov_b64 exec, 0x1ffffff
    buffer_store_dwordx2 v[32:33], v29, s[28:31], s46 offen sc1
    s_cmp_lg_u32 s2, 0
    s_cbranch_scc1 sequential_preLN__linear_kernel_hedgehog__mixer_token_mlp__prompt_kernel_nn
    s_cmp_lg_u32 s12, 0
    s_cbranch_scc1 sequential_preLN__linear_kernel_hedgehog__mixer_token_mlp__prompt_kernel_nn
    s_add_u32 s28, s8, 67239936
    s_addc_u32 s29, s9, 0
    s_mov_b32 s30, 24576
    s_mov_b32 s31, 0x00020000
    s_mov_b32 s24, s60
    s_mov_b32 s25, s61
    s_mov_b32 s26, 256
    s_mov_b32 s27, 0x00020000
    s_mov_b64 exec, 1
    v_mov_b32 v29, 0
    s_mov_b32 s46, 8192
    buffer_load_dword v30, v29, s[28:31], s46 offen sc1
    s_waitcnt vmcnt(0)
    v_add_u32 v30, 1, v30
    v_max_u32 v30, 1, v30
    buffer_store_dword v30, v29, s[24:27], 0 offen sc1
    buffer_store_dword v30, v29, s[28:31], s46 offen sc1
    s_waitcnt vmcnt(0)
sequential_preLN__linear_kernel_hedgehog__mixer_token_mlp__prompt_kernel_nn:
    s_mov_b64 exec, -1
    s_nop 1
    s_add_u32 m0, s48, 24576
    s_add_u32 s44, s47, 0
    buffer_load_dwordx4 v8, s[20:23], s44 offen lds
    buffer_load_dwordx4 v9, s[20:23], s44 offen offset:1024 lds
    s_add_u32 m0, s48, 32768
    s_add_u32 s44, s47, 1152
    buffer_load_dwordx4 v8, s[20:23], s44 offen lds
    buffer_load_dwordx4 v9, s[20:23], s44 offen offset:1024 lds
    s_add_u32 m0, s48, 40960
    s_add_u32 s44, s47, 2304
    buffer_load_dwordx4 v8, s[20:23], s44 offen lds
    buffer_load_dwordx4 v9, s[20:23], s44 offen offset:1024 lds
    s_add_u32 s51, s51, 1
    s_cmp_lg_u32 s51, 18
    s_cselect_b32 s44, s53, s54
    s_cselect_b32 s51, s51, 0
    s_add_u32 s47, s47, s44
    s_add_u32 m0, s48, 49152
    s_add_u32 s44, s47, 0
    buffer_load_dwordx4 v8, s[20:23], s44 offen lds
    buffer_load_dwordx4 v9, s[20:23], s44 offen offset:1024 lds
    s_add_u32 m0, s48, 57344
    s_add_u32 s44, s47, 1152
    buffer_load_dwordx4 v8, s[20:23], s44 offen lds
    buffer_load_dwordx4 v9, s[20:23], s44 offen offset:1024 lds
    s_add_u32 m0, s48, 65536
    s_add_u32 s44, s47, 2304
    buffer_load_dwordx4 v8, s[20:23], s44 offen lds
    buffer_load_dwordx4 v9, s[20:23], s44 offen offset:1024 lds
    s_add_u32 s51, s51, 1
    s_cmp_lg_u32 s51, 18
    s_cselect_b32 s44, s53, s54
    s_cselect_b32 s51, s51, 0
    s_add_u32 s47, s47, s44
    s_add_u32 m0, s48, 73728
    s_add_u32 s44, s47, 0
    buffer_load_dwordx4 v8, s[20:23], s44 offen lds
    buffer_load_dwordx4 v9, s[20:23], s44 offen offset:1024 lds
    s_add_u32 m0, s48, 81920
    s_add_u32 s44, s47, 1152
    buffer_load_dwordx4 v8, s[20:23], s44 offen lds
    buffer_load_dwordx4 v9, s[20:23], s44 offen offset:1024 lds
    s_add_u32 m0, s48, 90112
    s_add_u32 s44, s47, 2304
    buffer_load_dwordx4 v8, s[20:23], s44 offen lds
    buffer_load_dwordx4 v9, s[20:23], s44 offen offset:1024 lds
    s_add_u32 s51, s51, 1
    s_cmp_lg_u32 s51, 18
    s_cselect_b32 s44, s53, s54
    s_cselect_b32 s51, s51, 0
    s_add_u32 s47, s47, s44
    s_add_u32 m0, s48, 98304
    s_add_u32 s44, s47, 0
    buffer_load_dwordx4 v8, s[20:23], s44 offen lds
    buffer_load_dwordx4 v9, s[20:23], s44 offen offset:1024 lds
    s_add_u32 m0, s48, 106496
    s_add_u32 s44, s47, 1152
    buffer_load_dwordx4 v8, s[20:23], s44 offen lds
    buffer_load_dwordx4 v9, s[20:23], s44 offen offset:1024 lds
    s_add_u32 m0, s48, 114688
    s_add_u32 s44, s47, 2304
    buffer_load_dwordx4 v8, s[20:23], s44 offen lds
    buffer_load_dwordx4 v9, s[20:23], s44 offen offset:1024 lds
    s_add_u32 s51, s51, 1
    s_cmp_lg_u32 s51, 18
    s_cselect_b32 s44, s53, s54
    s_cselect_b32 s51, s51, 0
    s_add_u32 s47, s47, s44
    s_waitcnt vmcnt(24)
    s_barrier
    s_add_u32 m0, s48, 122880
    s_add_u32 s44, s47, 0
    buffer_load_dwordx4 v8, s[20:23], s44 offen lds
    buffer_load_dwordx4 v9, s[20:23], s44 offen offset:1024 lds
    s_add_u32 m0, s48, 131072
    s_add_u32 s44, s47, 1152
    buffer_load_dwordx4 v8, s[20:23], s44 offen lds
    buffer_load_dwordx4 v9, s[20:23], s44 offen offset:1024 lds
    s_add_u32 m0, s48, 139264
    s_add_u32 s44, s47, 2304
    buffer_load_dwordx4 v8, s[20:23], s44 offen lds
    buffer_load_dwordx4 v9, s[20:23], s44 offen offset:1024 lds
    s_add_u32 s51, s51, 1
    s_cmp_lg_u32 s51, 18
    s_cselect_b32 s44, s53, s54
    s_cselect_b32 s51, s51, 0
    s_add_u32 s47, s47, s44
    s_waitcnt vmcnt(24)
    s_barrier
    s_waitcnt vmcnt(18)
    s_barrier
    s_add_u32 m0, s48, 0
    s_add_u32 s44, s47, 0
    buffer_load_dwordx4 v8, s[20:23], s44 offen lds
    buffer_load_dwordx4 v9, s[20:23], s44 offen offset:1024 lds
    s_add_u32 m0, s48, 8192
    s_add_u32 s44, s47, 1152
    buffer_load_dwordx4 v8, s[20:23], s44 offen lds
    buffer_load_dwordx4 v9, s[20:23], s44 offen offset:1024 lds
    s_add_u32 m0, s48, 16384
    s_add_u32 s44, s47, 2304
    buffer_load_dwordx4 v8, s[20:23], s44 offen lds
    buffer_load_dwordx4 v9, s[20:23], s44 offen offset:1024 lds
    s_add_u32 s51, s51, 1
    s_cmp_lg_u32 s51, 18
    s_cselect_b32 s44, s53, s54
    s_cselect_b32 s51, s51, 0
    s_add_u32 s47, s47, s44
    s_waitcnt vmcnt(18)
    s_barrier
    s_add_u32 m0, s48, 24576
    s_add_u32 s44, s47, 0
    buffer_load_dwordx4 v8, s[20:23], s44 offen lds
    buffer_load_dwordx4 v9, s[20:23], s44 offen offset:1024 lds
    s_add_u32 m0, s48, 32768
    s_add_u32 s44, s47, 1152
    buffer_load_dwordx4 v8, s[20:23], s44 offen lds
    buffer_load_dwordx4 v9, s[20:23], s44 offen offset:1024 lds
    s_add_u32 m0, s48, 40960
    s_add_u32 s44, s47, 2304
    buffer_load_dwordx4 v8, s[20:23], s44 offen lds
    buffer_load_dwordx4 v9, s[20:23], s44 offen offset:1024 lds
    s_add_u32 s51, s51, 1
    s_cmp_lg_u32 s51, 18
    s_cselect_b32 s44, s53, s54
    s_cselect_b32 s51, s51, 0
    s_add_u32 s47, s47, s44
    s_waitcnt vmcnt(18)
    s_barrier
    s_add_u32 m0, s48, 49152
    s_add_u32 s44, s47, 0
    buffer_load_dwordx4 v8, s[20:23], s44 offen lds
    buffer_load_dwordx4 v9, s[20:23], s44 offen offset:1024 lds
    s_add_u32 m0, s48, 57344
    s_add_u32 s44, s47, 1152
    buffer_load_dwordx4 v8, s[20:23], s44 offen lds
    buffer_load_dwordx4 v9, s[20:23], s44 offen offset:1024 lds
    s_add_u32 m0, s48, 65536
    s_add_u32 s44, s47, 2304
    buffer_load_dwordx4 v8, s[20:23], s44 offen lds
    buffer_load_dwordx4 v9, s[20:23], s44 offen offset:1024 lds
    s_add_u32 s51, s51, 1
    s_cmp_lg_u32 s51, 18
    s_cselect_b32 s44, s53, s54
    s_cselect_b32 s51, s51, 0
    s_add_u32 s47, s47, s44
    s_waitcnt vmcnt(18)
    s_barrier
    s_add_u32 m0, s48, 73728
    s_add_u32 s44, s47, 0
    buffer_load_dwordx4 v8, s[20:23], s44 offen lds
    buffer_load_dwordx4 v9, s[20:23], s44 offen offset:1024 lds
    s_add_u32 m0, s48, 81920
    s_add_u32 s44, s47, 1152
    buffer_load_dwordx4 v8, s[20:23], s44 offen lds
    buffer_load_dwordx4 v9, s[20:23], s44 offen offset:1024 lds
    s_add_u32 m0, s48, 90112
    s_add_u32 s44, s47, 2304
    buffer_load_dwordx4 v8, s[20:23], s44 offen lds
    buffer_load_dwordx4 v9, s[20:23], s44 offen offset:1024 lds
    s_add_u32 s51, s51, 1
    s_cmp_lg_u32 s51, 18
    s_cselect_b32 s44, s53, s54
    s_cselect_b32 s51, s51, 0
    s_add_u32 s47, s47, s44
    s_waitcnt vmcnt(18)
    s_barrier
    s_add_u32 m0, s48, 98304
    s_add_u32 s44, s47, 0
    buffer_load_dwordx4 v8, s[20:23], s44 offen lds
    buffer_load_dwordx4 v9, s[20:23], s44 offen offset:1024 lds
    s_add_u32 m0, s48, 106496
    s_add_u32 s44, s47, 1152
    buffer_load_dwordx4 v8, s[20:23], s44 offen lds
    buffer_load_dwordx4 v9, s[20:23], s44 offen offset:1024 lds
    s_add_u32 m0, s48, 114688
    s_add_u32 s44, s47, 2304
    buffer_load_dwordx4 v8, s[20:23], s44 offen lds
    buffer_load_dwordx4 v9, s[20:23], s44 offen offset:1024 lds
    s_add_u32 s51, s51, 1
    s_cmp_lg_u32 s51, 18
    s_cselect_b32 s44, s53, s54
    s_cselect_b32 s51, s51, 0
    s_add_u32 s47, s47, s44
    s_waitcnt vmcnt(18)
    s_barrier
    s_add_u32 m0, s48, 122880
    s_add_u32 s44, s47, 0
    buffer_load_dwordx4 v8, s[20:23], s44 offen lds
    buffer_load_dwordx4 v9, s[20:23], s44 offen offset:1024 lds
    s_add_u32 m0, s48, 131072
    s_add_u32 s44, s47, 1152
    buffer_load_dwordx4 v8, s[20:23], s44 offen lds
    buffer_load_dwordx4 v9, s[20:23], s44 offen offset:1024 lds
    s_add_u32 m0, s48, 139264
    s_add_u32 s44, s47, 2304
    buffer_load_dwordx4 v8, s[20:23], s44 offen lds
    buffer_load_dwordx4 v9, s[20:23], s44 offen offset:1024 lds
    s_add_u32 s51, s51, 1
    s_cmp_lg_u32 s51, 18
    s_cselect_b32 s44, s53, s54
    s_cselect_b32 s51, s51, 0
    s_add_u32 s47, s47, s44
    s_waitcnt vmcnt(18)
    s_barrier
    s_add_u32 m0, s48, 0
    s_add_u32 s44, s47, 0
    buffer_load_dwordx4 v8, s[20:23], s44 offen lds
    buffer_load_dwordx4 v9, s[20:23], s44 offen offset:1024 lds
    s_add_u32 m0, s48, 8192
    s_add_u32 s44, s47, 1152
    buffer_load_dwordx4 v8, s[20:23], s44 offen lds
    buffer_load_dwordx4 v9, s[20:23], s44 offen offset:1024 lds
    s_add_u32 m0, s48, 16384
    s_add_u32 s44, s47, 2304
    buffer_load_dwordx4 v8, s[20:23], s44 offen lds
    buffer_load_dwordx4 v9, s[20:23], s44 offen offset:1024 lds
    s_add_u32 s51, s51, 1
    s_cmp_lg_u32 s51, 18
    s_cselect_b32 s44, s53, s54
    s_cselect_b32 s51, s51, 0
    s_add_u32 s47, s47, s44
    s_waitcnt vmcnt(18)
    s_barrier
    s_add_u32 m0, s48, 24576
    s_add_u32 s44, s47, 0
    buffer_load_dwordx4 v8, s[20:23], s44 offen lds
    buffer_load_dwordx4 v9, s[20:23], s44 offen offset:1024 lds
    s_add_u32 m0, s48, 32768
    s_add_u32 s44, s47, 1152
    buffer_load_dwordx4 v8, s[20:23], s44 offen lds
    buffer_load_dwordx4 v9, s[20:23], s44 offen offset:1024 lds
    s_add_u32 m0, s48, 40960
    s_add_u32 s44, s47, 2304
    buffer_load_dwordx4 v8, s[20:23], s44 offen lds
    buffer_load_dwordx4 v9, s[20:23], s44 offen offset:1024 lds
    s_add_u32 s51, s51, 1
    s_cmp_lg_u32 s51, 18
    s_cselect_b32 s44, s53, s54
    s_cselect_b32 s51, s51, 0
    s_add_u32 s47, s47, s44
    s_waitcnt vmcnt(18)
    s_barrier
    s_add_u32 m0, s48, 49152
    s_add_u32 s44, s47, 0
    buffer_load_dwordx4 v8, s[20:23], s44 offen lds
    buffer_load_dwordx4 v9, s[20:23], s44 offen offset:1024 lds
    s_add_u32 m0, s48, 57344
    s_add_u32 s44, s47, 1152
    buffer_load_dwordx4 v8, s[20:23], s44 offen lds
    buffer_load_dwordx4 v9, s[20:23], s44 offen offset:1024 lds
    s_add_u32 m0, s48, 65536
    s_add_u32 s44, s47, 2304
    buffer_load_dwordx4 v8, s[20:23], s44 offen lds
    buffer_load_dwordx4 v9, s[20:23], s44 offen offset:1024 lds
    s_add_u32 s51, s51, 1
    s_cmp_lg_u32 s51, 18
    s_cselect_b32 s44, s53, s54
    s_cselect_b32 s51, s51, 0
    s_add_u32 s47, s47, s44
    s_waitcnt vmcnt(18)
    s_barrier
    s_add_u32 m0, s48, 73728
    s_add_u32 s44, s47, 0
    buffer_load_dwordx4 v8, s[20:23], s44 offen lds
    buffer_load_dwordx4 v9, s[20:23], s44 offen offset:1024 lds
    s_add_u32 m0, s48, 81920
    s_add_u32 s44, s47, 1152
    buffer_load_dwordx4 v8, s[20:23], s44 offen lds
    buffer_load_dwordx4 v9, s[20:23], s44 offen offset:1024 lds
    s_add_u32 m0, s48, 90112
    s_add_u32 s44, s47, 2304
    buffer_load_dwordx4 v8, s[20:23], s44 offen lds
    buffer_load_dwordx4 v9, s[20:23], s44 offen offset:1024 lds
    s_add_u32 s51, s51, 1
    s_cmp_lg_u32 s51, 18
    s_cselect_b32 s44, s53, s54
    s_cselect_b32 s51, s51, 0
    s_add_u32 s47, s47, s44
    s_waitcnt vmcnt(18)
    s_barrier
    s_add_u32 m0, s48, 98304
    s_add_u32 s44, s47, 0
    buffer_load_dwordx4 v8, s[20:23], s44 offen lds
    buffer_load_dwordx4 v9, s[20:23], s44 offen offset:1024 lds
    s_add_u32 m0, s48, 106496
    s_add_u32 s44, s47, 1152
    buffer_load_dwordx4 v8, s[20:23], s44 offen lds
    buffer_load_dwordx4 v9, s[20:23], s44 offen offset:1024 lds
    s_add_u32 m0, s48, 114688
    s_add_u32 s44, s47, 2304
    buffer_load_dwordx4 v8, s[20:23], s44 offen lds
    buffer_load_dwordx4 v9, s[20:23], s44 offen offset:1024 lds
    s_add_u32 s51, s51, 1
    s_cmp_lg_u32 s51, 18
    s_cselect_b32 s44, s53, s54
    s_cselect_b32 s51, s51, 0
    s_add_u32 s47, s47, s44
    s_waitcnt vmcnt(18)
    s_barrier
    s_add_u32 m0, s48, 122880
    s_add_u32 s44, s47, 0
    buffer_load_dwordx4 v8, s[20:23], s44 offen lds
    buffer_load_dwordx4 v9, s[20:23], s44 offen offset:1024 lds
    s_add_u32 m0, s48, 131072
    s_add_u32 s44, s47, 1152
    buffer_load_dwordx4 v8, s[20:23], s44 offen lds
    buffer_load_dwordx4 v9, s[20:23], s44 offen offset:1024 lds
    s_add_u32 m0, s48, 139264
    s_add_u32 s44, s47, 2304
    buffer_load_dwordx4 v8, s[20:23], s44 offen lds
    buffer_load_dwordx4 v9, s[20:23], s44 offen offset:1024 lds
    s_add_u32 s51, s51, 1
    s_cmp_lg_u32 s51, 18
    s_cselect_b32 s44, s53, s54
    s_cselect_b32 s51, s51, 0
    s_add_u32 s47, s47, s44
    s_load_dwordx2 s[36:37], s[0:1], 24
    s_load_dwordx2 s[38:39], s[0:1], 40
    s_lshr_b32 s10, s2, 3
    s_lshl_b32 s10, s10, 2
    s_add_u32 s10, s10, s12
    s_mul_i32 s11, s10, 41
    v_add_u32 v244, s11, v2
    v_lshlrev_b32 v244, 7, v244
    s_mul_i32 s10, s10, 0
    s_and_b32 s11, s2, 7
    s_mul_i32 s11, s11, 9
    s_lshr_b32 s11, s11, 1
    s_lshl_b32 s11, s11, 8
    s_mov_b32 s40, 429496730
    s_mov_b32 s41, 9216
    s_waitcnt lgkmcnt(0)
    s_mov_b32 s16, s36
    s_mov_b32 s17, s37
    s_mov_b32 s18, 663552
    s_mov_b32 s19, 0x00020000
    s_mov_b32 s32, s38
    s_mov_b32 s33, s39
    s_mov_b32 s34, 18874368
    s_mov_b32 s35, 0x00020000
    s_mov_b32 exec_hi, 0x1ff
    buffer_load_dword v245, v244, s[16:19], 0 offen
    s_mov_b32 exec_hi, -1
    s_mov_b32 s24, s60
    s_mov_b32 s25, s61
    s_mov_b32 s26, 256
    s_mov_b32 s27, 0x00020000
    v_mov_b32 v48, 0
    buffer_load_dword v49, v48, s[24:27], 0 offen sc1
    s_add_u32 s28, s8, 50331648
    s_addc_u32 s29, s9, 0
    s_mov_b32 s30, 4718592
    s_mov_b32 s31, 0x00020000
    s_add_u32 s32, s8, 67239936
    s_addc_u32 s33, s9, 0
    s_mov_b32 s34, 24576
    s_mov_b32 s35, 0x00020000
    v_and_b32 v220, 3, v2
    v_cmp_eq_u32 vcc, v220, v1
    v_mul_u32_u24 v8, 800, v1
    v_mov_b32 v221, 3200
    v_cndmask_b32 v8, v221, v8, vcc
    v_bfe_u32 v221, v2, 2, 2
    v_mul_u32_u24 v221, 40, v221
    s_mov_b32 s46, 155648
    v_add3_u32 v8, v8, v221, s46
    ds_read_b64_tr_b16 v[56:57], v8 offset:0
    ds_read_b64_tr_b16 v[58:59], v8 offset:160
    ds_read_b64_tr_b16 v[60:61], v8 offset:320
    ds_read_b64_tr_b16 v[62:63], v8 offset:480
    ds_read_b64_tr_b16 v[64:65], v8 offset:640
    ds_read_b64_tr_b16 v[66:67], v8 offset:8
    ds_read_b64_tr_b16 v[68:69], v8 offset:168
    ds_read_b64_tr_b16 v[70:71], v8 offset:328
    ds_read_b64_tr_b16 v[72:73], v8 offset:488
    ds_read_b64_tr_b16 v[74:75], v8 offset:648
    ds_read_b64_tr_b16 v[76:77], v8 offset:16
    ds_read_b64_tr_b16 v[78:79], v8 offset:176
    ds_read_b64_tr_b16 v[80:81], v8 offset:336
    ds_read_b64_tr_b16 v[82:83], v8 offset:496
    ds_read_b64_tr_b16 v[84:85], v8 offset:656
    ds_read_b64_tr_b16 v[86:87], v8 offset:24
    ds_read_b64_tr_b16 v[88:89], v8 offset:184
    ds_read_b64_tr_b16 v[90:91], v8 offset:344
    ds_read_b64_tr_b16 v[92:93], v8 offset:504
    ds_read_b64_tr_b16 v[94:95], v8 offset:664
    ds_read_b64_tr_b16 v[96:97], v8 offset:32
    ds_read_b64_tr_b16 v[98:99], v8 offset:192
    ds_read_b64_tr_b16 v[100:101], v8 offset:352
    ds_read_b64_tr_b16 v[102:103], v8 offset:512
    ds_read_b64_tr_b16 v[104:105], v8 offset:672
    v_lshlrev_b32 v10, 4, v2
    v_lshlrev_b32 v11, 3, v2
    s_mul_i32 s46, s12, 2560
    s_add_u32 s46, s46, 49152
    v_add_u32 v50, s46, v10
    v_add_u32 v51, s46, v11
    s_lshl_b32 s46, s12, 2
    s_add_u32 s46, s46, 159664
    v_mov_b32 v12, s46
    v_mov_b32 v13, 159656
    v_mov_b32 v14, 1
    v_lshlrev_b32 v15, 10, v2
    s_lshl_b32 s52, s14, 2
    s_add_u32 s52, s52, s12
    s_lshl_b32 s52, s52, 3
    s_add_u32 s52, s52, s13
    s_mul_i32 s52, s52, 4608
    s_add_u32 s53, s52, 4096
    s_lshl_b32 s54, s13, 7
    s_lshl_b32 s47, s14, 2
    s_add_u32 s54, s54, s47
    s_add_u32 s54, s54, 16384
    s_waitcnt vmcnt(20)
    s_barrier
    s_waitcnt vmcnt(14)
    s_barrier
    s_waitcnt vmcnt(8)
    s_barrier
    s_waitcnt vmcnt(2)
    s_barrier
sequential_preLN__linear_kernel_hedgehog__mixer_token_mlp__prompt_kernel_qs:
    ds_read_b32 v220, v12
    s_waitcnt lgkmcnt(0)
    v_cmp_eq_u32 vcc, 0, v220
    s_cbranch_vccnz sequential_preLN__linear_kernel_hedgehog__mixer_token_mlp__prompt_kernel_qs
    ds_read_b128 v[128:131], v50
    ds_read_b128 v[132:135], v50 offset:1024
    ds_read_b64 v[136:137], v51 offset:2048
    s_waitcnt lgkmcnt(0)
    v_mfma_f32_16x16x32_bf16 v[108:111], v[56:59], v[128:131], 0
    v_mfma_f32_16x16x32_bf16 v[112:115], v[66:69], v[128:131], 0
    v_mfma_f32_16x16x32_bf16 v[116:119], v[76:79], v[128:131], 0
    v_mfma_f32_16x16x32_bf16 v[120:123], v[86:89], v[128:131], 0
    v_mfma_f32_16x16x32_bf16 v[124:127], v[96:99], v[128:131], 0
    v_mfma_f32_16x16x32_bf16 v[108:111], v[60:63], v[132:135], v[108:111]
    v_mfma_f32_16x16x32_bf16 v[112:115], v[70:73], v[132:135], v[112:115]
    v_mfma_f32_16x16x32_bf16 v[116:119], v[80:83], v[132:135], v[116:119]
    v_mfma_f32_16x16x32_bf16 v[120:123], v[90:93], v[132:135], v[120:123]
    v_mfma_f32_16x16x32_bf16 v[124:127], v[100:103], v[132:135], v[124:127]
    v_mfma_f32_16x16x16_bf16 v[108:111], v[64:65], v[136:137], v[108:111]
    v_mfma_f32_16x16x16_bf16 v[112:115], v[74:75], v[136:137], v[112:115]
    v_mfma_f32_16x16x16_bf16 v[116:119], v[84:85], v[136:137], v[116:119]
    v_mfma_f32_16x16x16_bf16 v[120:123], v[94:95], v[136:137], v[120:123]
    v_mfma_f32_16x16x16_bf16 v[124:127], v[104:105], v[136:137], v[124:127]
    s_nop 7
    v_max3_f32 v220, v108, v109, v110
    v_min3_f32 v222, v108, v109, v110
    v_max3_f32 v220, v220, v111, v112
    v_min3_f32 v222, v222, v111, v112
    v_max3_f32 v220, v220, v113, v114
    v_min3_f32 v222, v222, v113, v114
    v_max3_f32 v220, v220, v115, v116
    v_min3_f32 v222, v222, v115, v116
    v_max3_f32 v220, v220, v117, v118
    v_min3_f32 v222, v222, v117, v118
    v_max3_f32 v220, v220, v119, v120
    v_min3_f32 v222, v222, v119, v120
    v_max3_f32 v220, v220, v121, v122
    v_min3_f32 v222, v222, v121, v122
    v_max3_f32 v220, v220, v123, v124
    v_min3_f32 v222, v222, v123, v124
    v_max_f32 v220, v220, v125
    v_min_f32 v222, v222, v125
    v_mov_b32 v224, 1069066811
    v_mov_b32 v225, 1069066811
    v_mov_b32 v226, 3216550459
    v_mov_b32 v227, 3216550459
    v_mul_f32 v220, v220, v226
    v_mul_f32 v222, v222, v224
    v_mov_b32 v221, v220
    v_mov_b32 v223, v222
    v_pk_fma_f32 v[56:57], v[108:109], v[224:225], v[220:221]
    v_pk_fma_f32 v[74:75], v[108:109], v[226:227], v[222:223]
    v_pk_fma_f32 v[58:59], v[110:111], v[224:225], v[220:221]
    v_pk_fma_f32 v[76:77], v[110:111], v[226:227], v[222:223]
    v_pk_fma_f32 v[60:61], v[112:113], v[224:225], v[220:221]
    v_pk_fma_f32 v[78:79], v[112:113], v[226:227], v[222:223]
    v_pk_fma_f32 v[62:63], v[114:115], v[224:225], v[220:221]
    v_pk_fma_f32 v[80:81], v[114:115], v[226:227], v[222:223]
    v_pk_fma_f32 v[64:65], v[116:117], v[224:225], v[220:221]
    v_pk_fma_f32 v[82:83], v[116:117], v[226:227], v[222:223]
    v_pk_fma_f32 v[66:67], v[118:119], v[224:225], v[220:221]
    v_pk_fma_f32 v[84:85], v[118:119], v[226:227], v[222:223]
    v_pk_fma_f32 v[68:69], v[120:121], v[224:225], v[220:221]
    v_pk_fma_f32 v[86:87], v[120:121], v[226:227], v[222:223]
    v_pk_fma_f32 v[70:71], v[122:123], v[224:225], v[220:221]
    v_pk_fma_f32 v[88:89], v[122:123], v[226:227], v[222:223]
    v_pk_fma_f32 v[72:73], v[124:125], v[224:225], v[220:221]
    v_pk_fma_f32 v[90:91], v[124:125], v[226:227], v[222:223]
    v_exp_f32 v56, v56
    v_exp_f32 v57, v57
    v_exp_f32 v58, v58
    v_exp_f32 v59, v59
    v_exp_f32 v60, v60
    v_exp_f32 v61, v61
    v_exp_f32 v62, v62
    v_exp_f32 v63, v63
    v_exp_f32 v64, v64
    v_exp_f32 v65, v65
    v_exp_f32 v66, v66
    v_exp_f32 v67, v67
    v_exp_f32 v68, v68
    v_exp_f32 v69, v69
    v_exp_f32 v70, v70
    v_exp_f32 v71, v71
    v_exp_f32 v72, v72
    v_exp_f32 v73, v73
    v_exp_f32 v74, v74
    v_exp_f32 v75, v75
    v_exp_f32 v76, v76
    v_exp_f32 v77, v77
    v_exp_f32 v78, v78
    v_exp_f32 v79, v79
    v_exp_f32 v80, v80
    v_exp_f32 v81, v81
    v_exp_f32 v82, v82
    v_exp_f32 v83, v83
    v_exp_f32 v84, v84
    v_exp_f32 v85, v85
    v_exp_f32 v86, v86
    v_exp_f32 v87, v87
    v_exp_f32 v88, v88
    v_exp_f32 v89, v89
    v_exp_f32 v90, v90
    v_exp_f32 v91, v91
    v_pk_add_f32 v[220:221], v[56:57], v[58:59]
    v_pk_add_f32 v[222:223], v[74:75], v[76:77]
    v_pk_add_f32 v[220:221], v[220:221], v[60:61]
    v_pk_add_f32 v[222:223], v[222:223], v[78:79]
    v_pk_add_f32 v[220:221], v[220:221], v[62:63]
    v_pk_add_f32 v[222:223], v[222:223], v[80:81]
    v_pk_add_f32 v[220:221], v[220:221], v[64:65]
    v_pk_add_f32 v[222:223], v[222:223], v[82:83]
    v_pk_add_f32 v[220:221], v[220:221], v[66:67]
    v_pk_add_f32 v[222:223], v[222:223], v[84:85]
    v_pk_add_f32 v[220:221], v[220:221], v[68:69]
    v_pk_add_f32 v[222:223], v[222:223], v[86:87]
    v_pk_add_f32 v[220:221], v[220:221], v[70:71]
    v_pk_add_f32 v[222:223], v[222:223], v[88:89]
    v_pk_add_f32 v[220:221], v[220:221], v[72:73]
    v_pk_add_f32 v[222:223], v[222:223], v[90:91]
    v_add_f32 v220, v220, v221
    v_add_f32 v222, v222, v223
    v_rcp_f32 v220, v220
    v_rcp_f32 v222, v222
    s_nop 0
    v_mov_b32 v221, v220
    v_mov_b32 v223, v222
    v_pk_mul_f32 v[56:57], v[56:57], v[220:221]
    v_pk_mul_f32 v[74:75], v[74:75], v[222:223]
    v_pk_mul_f32 v[58:59], v[58:59], v[220:221]
    v_pk_mul_f32 v[76:77], v[76:77], v[222:223]
    v_pk_mul_f32 v[60:61], v[60:61], v[220:221]
    v_pk_mul_f32 v[78:79], v[78:79], v[222:223]
    v_pk_mul_f32 v[62:63], v[62:63], v[220:221]
    v_pk_mul_f32 v[80:81], v[80:81], v[222:223]
    v_pk_mul_f32 v[64:65], v[64:65], v[220:221]
    v_pk_mul_f32 v[82:83], v[82:83], v[222:223]
    v_pk_mul_f32 v[66:67], v[66:67], v[220:221]
    v_pk_mul_f32 v[84:85], v[84:85], v[222:223]
    v_pk_mul_f32 v[68:69], v[68:69], v[220:221]
    v_pk_mul_f32 v[86:87], v[86:87], v[222:223]
    v_pk_mul_f32 v[70:71], v[70:71], v[220:221]
    v_pk_mul_f32 v[88:89], v[88:89], v[222:223]
    v_pk_mul_f32 v[72:73], v[72:73], v[220:221]
    v_pk_mul_f32 v[90:91], v[90:91], v[222:223]
    v_cvt_pk_bf16_f32 v188, v56, v57
    v_cvt_pk_bf16_f32 v189, v58, v59
    v_cvt_pk_bf16_f32 v190, v60, v61
    v_cvt_pk_bf16_f32 v191, v62, v63
    v_cvt_pk_bf16_f32 v192, v64, v65
    v_cvt_pk_bf16_f32 v193, v66, v67
    v_cvt_pk_bf16_f32 v194, v68, v69
    v_cvt_pk_bf16_f32 v195, v70, v71
    v_cvt_pk_bf16_f32 v196, v72, v73
    v_cvt_pk_bf16_f32 v197, v74, v75
    v_cvt_pk_bf16_f32 v198, v76, v77
    v_cvt_pk_bf16_f32 v199, v78, v79
    v_cvt_pk_bf16_f32 v200, v80, v81
    v_cvt_pk_bf16_f32 v201, v82, v83
    v_cvt_pk_bf16_f32 v202, v84, v85
    v_cvt_pk_bf16_f32 v203, v86, v87
    v_cvt_pk_bf16_f32 v204, v88, v89
    v_cvt_pk_bf16_f32 v205, v90, v91
    buffer_store_dwordx4 v[188:191], v10, s[28:31], s52 offen offset:0 sc1
    buffer_store_dwordx4 v[192:195], v10, s[28:31], s52 offen offset:1024 sc1
    buffer_store_dwordx4 v[196:199], v10, s[28:31], s52 offen offset:2048 sc1
    buffer_store_dwordx4 v[200:203], v10, s[28:31], s52 offen offset:3072 sc1
    buffer_store_dwordx2 v[204:205], v11, s[28:31], s53 offen sc1
    s_waitcnt vmcnt(0)
sequential_preLN__linear_kernel_hedgehog__mixer_token_mlp__prompt_kernel_npb:
    v_cmp_ne_u32 vcc, 0, v49
    s_cbranch_vccnz sequential_preLN__linear_kernel_hedgehog__mixer_token_mlp__prompt_kernel_okb
    buffer_load_dword v49, v48, s[24:27], 0 offen sc1
    s_waitcnt vmcnt(0)
    s_branch sequential_preLN__linear_kernel_hedgehog__mixer_token_mlp__prompt_kernel_npb
sequential_preLN__linear_kernel_hedgehog__mixer_token_mlp__prompt_kernel_okb:
    s_mov_b64 exec, 1
    ds_add_rtn_u32 v52, v13, v14
    s_waitcnt lgkmcnt(0)
    v_readfirstlane_b32 s47, v52
    s_cmp_lg_u32 s47, 3
    s_cbranch_scc1 sequential_preLN__linear_kernel_hedgehog__mixer_token_mlp__prompt_kernel_nfb
    s_mov_b64 exec, 0xff
    buffer_store_dword v49, v15, s[32:35], s54 offen sc1
sequential_preLN__linear_kernel_hedgehog__mixer_token_mlp__prompt_kernel_nfb:
    s_mov_b64 exec, -1
    s_mov_b64 exec, -1
    s_branch k2_phase
sequential_preLN__linear_kernel_hedgehog__mixer_token_mlp__prompt_kernel_kv:
    s_mov_b32 s16, s4
    s_mov_b32 s17, s5
    s_mov_b32 s18, 2359296
    s_mov_b32 s19, 0x00020000
    s_lshl_b32 s49, s59, 6
    s_add_u32 s46, s15, s49
    s_add_u32 s47, s3, s49
    buffer_load_dwordx4 v[56:59], v6, s[16:19], s46 offen
    buffer_load_dwordx4 v[60:63], v6, s[16:19], s47 offen
    s_add_u32 s49, s49, 128
    s_cmp_lg_u32 s49, 1152
    s_cselect_b32 s49, s49, 0
    s_add_u32 s46, s15, s49
    s_add_u32 s47, s3, s49
    buffer_load_dwordx4 v[64:67], v6, s[16:19], s46 offen
    buffer_load_dwordx4 v[68:71], v6, s[16:19], s47 offen
    s_add_u32 s49, s49, 128
    s_cmp_lg_u32 s49, 1152
    s_cselect_b32 s49, s49, 0
    s_add_u32 s46, s15, s49
    s_add_u32 s47, s3, s49
    buffer_load_dwordx4 v[72:75], v6, s[16:19], s46 offen
    buffer_load_dwordx4 v[76:79], v6, s[16:19], s47 offen
    s_add_u32 s49, s49, 128
    s_cmp_lg_u32 s49, 1152
    s_cselect_b32 s49, s49, 0
    s_add_u32 s46, s15, s49
    s_add_u32 s47, s3, s49
    buffer_load_dwordx4 v[80:83], v6, s[16:19], s46 offen
    buffer_load_dwordx4 v[84:87], v6, s[16:19], s47 offen
    s_add_u32 s49, s49, 128
    s_cmp_lg_u32 s49, 1152
    s_cselect_b32 s49, s49, 0
    s_add_u32 s46, s15, s49
    s_add_u32 s47, s3, s49
    buffer_load_dwordx4 v[88:91], v6, s[16:19], s46 offen
    buffer_load_dwordx4 v[92:95], v6, s[16:19], s47 offen
    s_add_u32 s49, s49, 128
    s_cmp_lg_u32 s49, 1152
    s_cselect_b32 s49, s49, 0
    s_add_u32 s46, s15, s49
    s_add_u32 s47, s3, s49
    buffer_load_dwordx4 v[96:99], v6, s[16:19], s46 offen
    buffer_load_dwordx4 v[100:103], v6, s[16:19], s47 offen
    s_add_u32 s49, s49, 128
    s_cmp_lg_u32 s49, 1152
    s_cselect_b32 s49, s49, 0
    s_add_u32 s46, s15, s49
    s_add_u32 s47, s3, s49
    buffer_load_dwordx4 v[104:107], v6, s[16:19], s46 offen
    buffer_load_dwordx4 v[108:111], v6, s[16:19], s47 offen
    s_add_u32 s49, s49, 128
    s_cmp_lg_u32 s49, 1152
    s_cselect_b32 s49, s49, 0
    s_add_u32 s46, s15, s49
    s_add_u32 s47, s3, s49
    buffer_load_dwordx4 v[112:115], v6, s[16:19], s46 offen
    buffer_load_dwordx4 v[116:119], v6, s[16:19], s47 offen
    s_add_u32 s49, s49, 128
    s_cmp_lg_u32 s49, 1152
    s_cselect_b32 s49, s49, 0
    s_add_u32 s46, s15, s49
    s_add_u32 s47, s3, s49
    buffer_load_dwordx4 v[120:123], v6, s[16:19], s46 offen
    buffer_load_dwordx4 v[124:127], v6, s[16:19], s47 offen
    s_barrier
    v_and_b32 v228, 1, v5
    v_lshrrev_b32 v229, 2, v5
    v_lshlrev_b32 v230, 1, v228
    v_lshl_add_u32 v230, v229, 2, v230
    v_xor_b32 v231, v4, v230
    v_lshlrev_b32 v231, 4, v231
    v_lshl_add_u32 v231, v228, 9, v231
    v_lshl_add_u32 v231, v229, 10, v231
    v_bfe_u32 v232, v5, 1, 1
    v_lshl_add_u32 v231, v232, 3, v231
    s_lshl_b32 s55, s12, 11
    s_add_u32 s55, s55, 147456
    v_add_u32 v231, s55, v231
    v_and_b32 v228, 2, v1
    v_xor_b32 v228, v3, v228
    v_xor_b32 v229, 4, v228
    v_lshlrev_b32 v230, 8, v1
    v_lshl_add_u32 v228, v228, 4, v230
    v_lshl_add_u32 v229, v229, 4, v230
    v_add_u32 v228, s55, v228
    v_add_u32 v229, s55, v229
    v_lshrrev_b32 v232, 2, v2
    v_and_b32 v234, 6, v232
    v_and_b32 v235, 1, v232
    v_lshl_add_u32 v234, v234, 1, v235
    v_lshlrev_b32 v234, 4, v234
    v_lshlrev_b32 v232, 8, v232
    v_and_b32 v233, 3, v2
    v_mul_u32_u24 v235, 36, v233
    v_and_b32 v235, -8, v235
    s_lshl_b32 s46, s13, 4
    v_add_u32 v235, s46, v235
    v_add_u32 v240, 0, v235
    v_xor_b32 v240, v240, v234
    v_add_u32 v240, v240, v232
    v_add_u32 v245, 65536, v240
    v_add_u32 v250, 131072, v240
    v_add_u32 v241, 8, v235
    v_xor_b32 v241, v241, v234
    v_add_u32 v241, v241, v232
    v_add_u32 v246, 65536, v241
    v_add_u32 v251, 131072, v241
    v_add_u32 v242, 16, v235
    v_xor_b32 v242, v242, v234
    v_add_u32 v242, v242, v232
    v_add_u32 v247, 65536, v242
    v_add_u32 v252, 131072, v242
    v_add_u32 v243, 24, v235
    v_xor_b32 v243, v243, v234
    v_add_u32 v243, v243, v232
    v_add_u32 v248, 65536, v243
    v_add_u32 v253, 131072, v243
    v_add_u32 v244, 32, v235
    v_xor_b32 v244, v244, v234
    v_add_u32 v244, v244, v232
    v_add_u32 v249, 65536, v244
    v_add_u32 v254, 131072, v244
    v_cmp_eq_u32 vcc, v233, v1
    v_mul_u32_u24 v8, 800, v1
    v_mov_b32 v232, 3200
    v_cndmask_b32 v8, v232, v8, vcc
    v_bfe_u32 v232, v2, 2, 2
    v_mul_u32_u24 v232, 40, v232
    s_mov_b32 s46, 155648
    v_add3_u32 v8, v8, v232, s46
    v_pk_mov_b32 v[128:129], 0, 0
    v_pk_mov_b32 v[130:131], 0, 0
    v_pk_mov_b32 v[132:133], 0, 0
    v_pk_mov_b32 v[134:135], 0, 0
    v_pk_mov_b32 v[136:137], 0, 0
    v_pk_mov_b32 v[138:139], 0, 0
    v_pk_mov_b32 v[140:141], 0, 0
    v_pk_mov_b32 v[142:143], 0, 0
    v_pk_mov_b32 v[144:145], 0, 0
    v_pk_mov_b32 v[146:147], 0, 0
    v_pk_mov_b32 v[148:149], 0, 0
    v_pk_mov_b32 v[150:151], 0, 0
    v_pk_mov_b32 v[152:153], 0, 0
    v_pk_mov_b32 v[154:155], 0, 0
    v_pk_mov_b32 v[156:157], 0, 0
    v_pk_mov_b32 v[158:159], 0, 0
    v_pk_mov_b32 v[160:161], 0, 0
    v_pk_mov_b32 v[162:163], 0, 0
    v_pk_mov_b32 v[164:165], 0, 0
    v_pk_mov_b32 v[166:167], 0, 0
    v_pk_mov_b32 v[168:169], 0, 0
    v_pk_mov_b32 v[170:171], 0, 0
    v_pk_mov_b32 v[172:173], 0, 0
    v_pk_mov_b32 v[174:175], 0, 0
    v_pk_mov_b32 v[176:177], 0, 0
    v_pk_mov_b32 v[178:179], 0, 0
    v_pk_mov_b32 v[180:181], 0, 0
    v_pk_mov_b32 v[182:183], 0, 0
    v_pk_mov_b32 v[184:185], 0, 0
    v_pk_mov_b32 v[186:187], 0, 0
    s_waitcnt lgkmcnt(0)
    v_mov_b32 v222, 0x3f803f80
    v_mov_b32 v48, 0
    v_mov_b32 v49, 0
    v_mov_b32 v50, 0
    v_mov_b32 v51, 0
    v_mov_b32 v188, 0
    v_mov_b32 v189, 0
    v_mov_b32 v190, 0
    v_mov_b32 v191, 0
    s_waitcnt vmcnt(16)
    v_dot2c_f32_bf16 v48, v56, v222
    v_dot2c_f32_bf16 v49, v56, v56
    v_dot2c_f32_bf16 v50, v57, v222
    v_dot2c_f32_bf16 v51, v57, v57
    v_dot2c_f32_bf16 v48, v58, v222
    v_dot2c_f32_bf16 v49, v58, v58
    v_dot2c_f32_bf16 v50, v59, v222
    v_dot2c_f32_bf16 v51, v59, v59
    v_dot2c_f32_bf16 v188, v60, v222
    v_dot2c_f32_bf16 v189, v60, v60
    v_dot2c_f32_bf16 v190, v61, v222
    v_dot2c_f32_bf16 v191, v61, v61
    v_dot2c_f32_bf16 v188, v62, v222
    v_dot2c_f32_bf16 v189, v62, v62
    v_dot2c_f32_bf16 v190, v63, v222
    v_dot2c_f32_bf16 v191, v63, v63
    s_waitcnt vmcnt(14)
    v_dot2c_f32_bf16 v48, v64, v222
    v_dot2c_f32_bf16 v49, v64, v64
    v_dot2c_f32_bf16 v50, v65, v222
    v_dot2c_f32_bf16 v51, v65, v65
    v_dot2c_f32_bf16 v48, v66, v222
    v_dot2c_f32_bf16 v49, v66, v66
    v_dot2c_f32_bf16 v50, v67, v222
    v_dot2c_f32_bf16 v51, v67, v67
    v_dot2c_f32_bf16 v188, v68, v222
    v_dot2c_f32_bf16 v189, v68, v68
    v_dot2c_f32_bf16 v190, v69, v222
    v_dot2c_f32_bf16 v191, v69, v69
    v_dot2c_f32_bf16 v188, v70, v222
    v_dot2c_f32_bf16 v189, v70, v70
    v_dot2c_f32_bf16 v190, v71, v222
    v_dot2c_f32_bf16 v191, v71, v71
    s_waitcnt vmcnt(12)
    v_dot2c_f32_bf16 v48, v72, v222
    v_dot2c_f32_bf16 v49, v72, v72
    v_dot2c_f32_bf16 v50, v73, v222
    v_dot2c_f32_bf16 v51, v73, v73
    v_dot2c_f32_bf16 v48, v74, v222
    v_dot2c_f32_bf16 v49, v74, v74
    v_dot2c_f32_bf16 v50, v75, v222
    v_dot2c_f32_bf16 v51, v75, v75
    v_dot2c_f32_bf16 v188, v76, v222
    v_dot2c_f32_bf16 v189, v76, v76
    v_dot2c_f32_bf16 v190, v77, v222
    v_dot2c_f32_bf16 v191, v77, v77
    v_dot2c_f32_bf16 v188, v78, v222
    v_dot2c_f32_bf16 v189, v78, v78
    v_dot2c_f32_bf16 v190, v79, v222
    v_dot2c_f32_bf16 v191, v79, v79
    s_waitcnt vmcnt(10)
    v_dot2c_f32_bf16 v48, v80, v222
    v_dot2c_f32_bf16 v49, v80, v80
    v_dot2c_f32_bf16 v50, v81, v222
    v_dot2c_f32_bf16 v51, v81, v81
    v_dot2c_f32_bf16 v48, v82, v222
    v_dot2c_f32_bf16 v49, v82, v82
    v_dot2c_f32_bf16 v50, v83, v222
    v_dot2c_f32_bf16 v51, v83, v83
    v_dot2c_f32_bf16 v188, v84, v222
    v_dot2c_f32_bf16 v189, v84, v84
    v_dot2c_f32_bf16 v190, v85, v222
    v_dot2c_f32_bf16 v191, v85, v85
    v_dot2c_f32_bf16 v188, v86, v222
    v_dot2c_f32_bf16 v189, v86, v86
    v_dot2c_f32_bf16 v190, v87, v222
    v_dot2c_f32_bf16 v191, v87, v87
    s_waitcnt vmcnt(8)
    v_dot2c_f32_bf16 v48, v88, v222
    v_dot2c_f32_bf16 v49, v88, v88
    v_dot2c_f32_bf16 v50, v89, v222
    v_dot2c_f32_bf16 v51, v89, v89
    v_dot2c_f32_bf16 v48, v90, v222
    v_dot2c_f32_bf16 v49, v90, v90
    v_dot2c_f32_bf16 v50, v91, v222
    v_dot2c_f32_bf16 v51, v91, v91
    v_dot2c_f32_bf16 v188, v92, v222
    v_dot2c_f32_bf16 v189, v92, v92
    v_dot2c_f32_bf16 v190, v93, v222
    v_dot2c_f32_bf16 v191, v93, v93
    v_dot2c_f32_bf16 v188, v94, v222
    v_dot2c_f32_bf16 v189, v94, v94
    v_dot2c_f32_bf16 v190, v95, v222
    v_dot2c_f32_bf16 v191, v95, v95
    s_waitcnt vmcnt(6)
    v_dot2c_f32_bf16 v48, v96, v222
    v_dot2c_f32_bf16 v49, v96, v96
    v_dot2c_f32_bf16 v50, v97, v222
    v_dot2c_f32_bf16 v51, v97, v97
    v_dot2c_f32_bf16 v48, v98, v222
    v_dot2c_f32_bf16 v49, v98, v98
    v_dot2c_f32_bf16 v50, v99, v222
    v_dot2c_f32_bf16 v51, v99, v99
    v_dot2c_f32_bf16 v188, v100, v222
    v_dot2c_f32_bf16 v189, v100, v100
    v_dot2c_f32_bf16 v190, v101, v222
    v_dot2c_f32_bf16 v191, v101, v101
    v_dot2c_f32_bf16 v188, v102, v222
    v_dot2c_f32_bf16 v189, v102, v102
    v_dot2c_f32_bf16 v190, v103, v222
    v_dot2c_f32_bf16 v191, v103, v103
    s_waitcnt vmcnt(4)
    v_dot2c_f32_bf16 v48, v104, v222
    v_dot2c_f32_bf16 v49, v104, v104
    v_dot2c_f32_bf16 v50, v105, v222
    v_dot2c_f32_bf16 v51, v105, v105
    v_dot2c_f32_bf16 v48, v106, v222
    v_dot2c_f32_bf16 v49, v106, v106
    v_dot2c_f32_bf16 v50, v107, v222
    v_dot2c_f32_bf16 v51, v107, v107
    v_dot2c_f32_bf16 v188, v108, v222
    v_dot2c_f32_bf16 v189, v108, v108
    v_dot2c_f32_bf16 v190, v109, v222
    v_dot2c_f32_bf16 v191, v109, v109
    v_dot2c_f32_bf16 v188, v110, v222
    v_dot2c_f32_bf16 v189, v110, v110
    v_dot2c_f32_bf16 v190, v111, v222
    v_dot2c_f32_bf16 v191, v111, v111
    s_waitcnt vmcnt(2)
    v_dot2c_f32_bf16 v48, v112, v222
    v_dot2c_f32_bf16 v49, v112, v112
    v_dot2c_f32_bf16 v50, v113, v222
    v_dot2c_f32_bf16 v51, v113, v113
    v_dot2c_f32_bf16 v48, v114, v222
    v_dot2c_f32_bf16 v49, v114, v114
    v_dot2c_f32_bf16 v50, v115, v222
    v_dot2c_f32_bf16 v51, v115, v115
    v_dot2c_f32_bf16 v188, v116, v222
    v_dot2c_f32_bf16 v189, v116, v116
    v_dot2c_f32_bf16 v190, v117, v222
    v_dot2c_f32_bf16 v191, v117, v117
    v_dot2c_f32_bf16 v188, v118, v222
    v_dot2c_f32_bf16 v189, v118, v118
    v_dot2c_f32_bf16 v190, v119, v222
    v_dot2c_f32_bf16 v191, v119, v119
    s_waitcnt vmcnt(0)
    v_dot2c_f32_bf16 v48, v120, v222
    v_dot2c_f32_bf16 v49, v120, v120
    v_dot2c_f32_bf16 v50, v121, v222
    v_dot2c_f32_bf16 v51, v121, v121
    v_dot2c_f32_bf16 v48, v122, v222
    v_dot2c_f32_bf16 v49, v122, v122
    v_dot2c_f32_bf16 v50, v123, v222
    v_dot2c_f32_bf16 v51, v123, v123
    v_dot2c_f32_bf16 v188, v124, v222
    v_dot2c_f32_bf16 v189, v124, v124
    v_dot2c_f32_bf16 v190, v125, v222
    v_dot2c_f32_bf16 v191, v125, v125
    v_dot2c_f32_bf16 v188, v126, v222
    v_dot2c_f32_bf16 v189, v126, v126
    v_dot2c_f32_bf16 v190, v127, v222
    v_dot2c_f32_bf16 v191, v127, v127
    s_nop 2
    v_add_f32 v48, v48, v50
    v_add_f32 v49, v49, v51
    v_add_f32 v188, v188, v190
    v_add_f32 v189, v189, v191
    v_add_f32_dpp v48, v48, v48 quad_perm:[1,0,3,2] row_mask:0xf bank_mask:0xf
    v_add_f32_dpp v49, v49, v49 quad_perm:[1,0,3,2] row_mask:0xf bank_mask:0xf
    v_add_f32_dpp v188, v188, v188 quad_perm:[1,0,3,2] row_mask:0xf bank_mask:0xf
    v_add_f32_dpp v189, v189, v189 quad_perm:[1,0,3,2] row_mask:0xf bank_mask:0xf
    v_add_f32_dpp v48, v48, v48 quad_perm:[2,3,0,1] row_mask:0xf bank_mask:0xf
    v_add_f32_dpp v49, v49, v49 quad_perm:[2,3,0,1] row_mask:0xf bank_mask:0xf
    v_add_f32_dpp v188, v188, v188 quad_perm:[2,3,0,1] row_mask:0xf bank_mask:0xf
    v_add_f32_dpp v189, v189, v189 quad_perm:[2,3,0,1] row_mask:0xf bank_mask:0xf
    v_add_f32_dpp v48, v48, v48 row_half_mirror row_mask:0xf bank_mask:0xf
    v_add_f32_dpp v49, v49, v49 row_half_mirror row_mask:0xf bank_mask:0xf
    v_add_f32_dpp v188, v188, v188 row_half_mirror row_mask:0xf bank_mask:0xf
    v_add_f32_dpp v189, v189, v189 row_half_mirror row_mask:0xf bank_mask:0xf
    v_mul_f32 v48, 987991609, v48
    v_mul_f32 v49, 987991609, v49
    v_mul_f32 v188, 987991609, v188
    v_mul_f32 v189, 987991609, v189
    v_fma_f32 v49, -v48, v48, v49
    v_max_f32 v49, 0, v49
    v_add_f32 v49, 925353388, v49
    v_fma_f32 v189, -v188, v188, v189
    v_max_f32 v189, 0, v189
    v_add_f32 v189, 925353388, v189
    v_rsq_f32 v52, v49
    v_rsq_f32 v192, v189
    s_nop 0
    v_mov_b32 v53, v52
    v_mul_f32 v54, v48, v52
    v_sub_f32 v54, 0, v54
    v_mov_b32 v55, v54
    v_mov_b32 v193, v192
    v_mul_f32 v194, v188, v192
    v_sub_f32 v194, 0, v194
    v_mov_b32 v195, v194
    v_lshlrev_b32 v16, 16, v56
    v_and_b32 v17, s45, v56
    v_lshlrev_b32 v18, 16, v57
    v_and_b32 v19, s45, v57
    v_lshlrev_b32 v20, 16, v58
    v_and_b32 v21, s45, v58
    v_lshlrev_b32 v22, 16, v59
    v_and_b32 v23, s45, v59
    v_pk_fma_f32 v[16:17], v[16:17], v[52:53], v[54:55]
    v_pk_fma_f32 v[18:19], v[18:19], v[52:53], v[54:55]
    v_pk_fma_f32 v[20:21], v[20:21], v[52:53], v[54:55]
    v_pk_fma_f32 v[22:23], v[22:23], v[52:53], v[54:55]
    v_cvt_pk_bf16_f32 v24, v16, v17
    v_cvt_pk_bf16_f32 v25, v18, v19
    v_cvt_pk_bf16_f32 v26, v20, v21
    v_cvt_pk_bf16_f32 v27, v22, v23
    ds_write_b64 v231, v[24:25] offset:0
    ds_write_b64 v231, v[26:27] offset:256
    v_lshlrev_b32 v32, 16, v60
    v_and_b32 v33, s45, v60
    v_lshlrev_b32 v34, 16, v61
    v_and_b32 v35, s45, v61
    v_lshlrev_b32 v36, 16, v62
    v_and_b32 v37, s45, v62
    v_lshlrev_b32 v38, 16, v63
    v_and_b32 v39, s45, v63
    v_pk_fma_f32 v[32:33], v[32:33], v[192:193], v[194:195]
    v_pk_fma_f32 v[34:35], v[34:35], v[192:193], v[194:195]
    v_pk_fma_f32 v[36:37], v[36:37], v[192:193], v[194:195]
    v_pk_fma_f32 v[38:39], v[38:39], v[192:193], v[194:195]
    v_cvt_pk_bf16_f32 v40, v32, v33
    v_cvt_pk_bf16_f32 v41, v34, v35
    v_cvt_pk_bf16_f32 v42, v36, v37
    v_cvt_pk_bf16_f32 v43, v38, v39
    ds_write_b64 v231, v[40:41] offset:128
    ds_write_b64 v231, v[42:43] offset:384
    ds_read_b128 v[56:59], v228 offset:0
    ds_read_b128 v[60:63], v229 offset:1024
    v_lshlrev_b32 v16, 16, v64
    v_and_b32 v17, s45, v64
    v_lshlrev_b32 v18, 16, v65
    v_and_b32 v19, s45, v65
    v_lshlrev_b32 v20, 16, v66
    v_and_b32 v21, s45, v66
    v_lshlrev_b32 v22, 16, v67
    v_and_b32 v23, s45, v67
    v_pk_fma_f32 v[16:17], v[16:17], v[52:53], v[54:55]
    v_pk_fma_f32 v[18:19], v[18:19], v[52:53], v[54:55]
    v_pk_fma_f32 v[20:21], v[20:21], v[52:53], v[54:55]
    v_pk_fma_f32 v[22:23], v[22:23], v[52:53], v[54:55]
    v_cvt_pk_bf16_f32 v28, v16, v17
    v_cvt_pk_bf16_f32 v29, v18, v19
    v_cvt_pk_bf16_f32 v30, v20, v21
    v_cvt_pk_bf16_f32 v31, v22, v23
    ds_write_b64 v231, v[28:29] offset:0
    ds_write_b64 v231, v[30:31] offset:256
    v_lshlrev_b32 v32, 16, v68
    v_and_b32 v33, s45, v68
    v_lshlrev_b32 v34, 16, v69
    v_and_b32 v35, s45, v69
    v_lshlrev_b32 v36, 16, v70
    v_and_b32 v37, s45, v70
    v_lshlrev_b32 v38, 16, v71
    v_and_b32 v39, s45, v71
    v_pk_fma_f32 v[32:33], v[32:33], v[192:193], v[194:195]
    v_pk_fma_f32 v[34:35], v[34:35], v[192:193], v[194:195]
    v_pk_fma_f32 v[36:37], v[36:37], v[192:193], v[194:195]
    v_pk_fma_f32 v[38:39], v[38:39], v[192:193], v[194:195]
    v_cvt_pk_bf16_f32 v44, v32, v33
    v_cvt_pk_bf16_f32 v45, v34, v35
    v_cvt_pk_bf16_f32 v46, v36, v37
    v_cvt_pk_bf16_f32 v47, v38, v39
    ds_write_b64 v231, v[44:45] offset:128
    ds_write_b64 v231, v[46:47] offset:384
    ds_read_b128 v[64:67], v228 offset:0
    ds_read_b128 v[68:71], v229 offset:1024
    v_lshlrev_b32 v16, 16, v72
    v_and_b32 v17, s45, v72
    v_lshlrev_b32 v18, 16, v73
    v_and_b32 v19, s45, v73
    v_lshlrev_b32 v20, 16, v74
    v_and_b32 v21, s45, v74
    v_lshlrev_b32 v22, 16, v75
    v_and_b32 v23, s45, v75
    v_pk_fma_f32 v[16:17], v[16:17], v[52:53], v[54:55]
    v_pk_fma_f32 v[18:19], v[18:19], v[52:53], v[54:55]
    v_pk_fma_f32 v[20:21], v[20:21], v[52:53], v[54:55]
    v_pk_fma_f32 v[22:23], v[22:23], v[52:53], v[54:55]
    v_cvt_pk_bf16_f32 v24, v16, v17
    v_cvt_pk_bf16_f32 v25, v18, v19
    v_cvt_pk_bf16_f32 v26, v20, v21
    v_cvt_pk_bf16_f32 v27, v22, v23
    ds_write_b64 v231, v[24:25] offset:0
    ds_write_b64 v231, v[26:27] offset:256
    v_lshlrev_b32 v32, 16, v76
    v_and_b32 v33, s45, v76
    v_lshlrev_b32 v34, 16, v77
    v_and_b32 v35, s45, v77
    v_lshlrev_b32 v36, 16, v78
    v_and_b32 v37, s45, v78
    v_lshlrev_b32 v38, 16, v79
    v_and_b32 v39, s45, v79
    v_pk_fma_f32 v[32:33], v[32:33], v[192:193], v[194:195]
    v_pk_fma_f32 v[34:35], v[34:35], v[192:193], v[194:195]
    v_pk_fma_f32 v[36:37], v[36:37], v[192:193], v[194:195]
    v_pk_fma_f32 v[38:39], v[38:39], v[192:193], v[194:195]
    v_cvt_pk_bf16_f32 v40, v32, v33
    v_cvt_pk_bf16_f32 v41, v34, v35
    v_cvt_pk_bf16_f32 v42, v36, v37
    v_cvt_pk_bf16_f32 v43, v38, v39
    ds_write_b64 v231, v[40:41] offset:128
    ds_write_b64 v231, v[42:43] offset:384
    ds_read_b128 v[72:75], v228 offset:0
    ds_read_b128 v[76:79], v229 offset:1024
    v_lshlrev_b32 v16, 16, v80
    v_and_b32 v17, s45, v80
    v_lshlrev_b32 v18, 16, v81
    v_and_b32 v19, s45, v81
    v_lshlrev_b32 v20, 16, v82
    v_and_b32 v21, s45, v82
    v_lshlrev_b32 v22, 16, v83
    v_and_b32 v23, s45, v83
    v_pk_fma_f32 v[16:17], v[16:17], v[52:53], v[54:55]
    v_pk_fma_f32 v[18:19], v[18:19], v[52:53], v[54:55]
    v_pk_fma_f32 v[20:21], v[20:21], v[52:53], v[54:55]
    v_pk_fma_f32 v[22:23], v[22:23], v[52:53], v[54:55]
    v_cvt_pk_bf16_f32 v28, v16, v17
    v_cvt_pk_bf16_f32 v29, v18, v19
    v_cvt_pk_bf16_f32 v30, v20, v21
    v_cvt_pk_bf16_f32 v31, v22, v23
    ds_write_b64 v231, v[28:29] offset:0
    ds_write_b64 v231, v[30:31] offset:256
    v_lshlrev_b32 v32, 16, v84
    v_and_b32 v33, s45, v84
    v_lshlrev_b32 v34, 16, v85
    v_and_b32 v35, s45, v85
    v_lshlrev_b32 v36, 16, v86
    v_and_b32 v37, s45, v86
    v_lshlrev_b32 v38, 16, v87
    v_and_b32 v39, s45, v87
    v_pk_fma_f32 v[32:33], v[32:33], v[192:193], v[194:195]
    v_pk_fma_f32 v[34:35], v[34:35], v[192:193], v[194:195]
    v_pk_fma_f32 v[36:37], v[36:37], v[192:193], v[194:195]
    v_pk_fma_f32 v[38:39], v[38:39], v[192:193], v[194:195]
    v_cvt_pk_bf16_f32 v44, v32, v33
    v_cvt_pk_bf16_f32 v45, v34, v35
    v_cvt_pk_bf16_f32 v46, v36, v37
    v_cvt_pk_bf16_f32 v47, v38, v39
    ds_write_b64 v231, v[44:45] offset:128
    ds_write_b64 v231, v[46:47] offset:384
    ds_read_b128 v[80:83], v228 offset:0
    ds_read_b128 v[84:87], v229 offset:1024
    v_lshlrev_b32 v16, 16, v88
    v_and_b32 v17, s45, v88
    v_lshlrev_b32 v18, 16, v89
    v_and_b32 v19, s45, v89
    v_lshlrev_b32 v20, 16, v90
    v_and_b32 v21, s45, v90
    v_lshlrev_b32 v22, 16, v91
    v_and_b32 v23, s45, v91
    v_pk_fma_f32 v[16:17], v[16:17], v[52:53], v[54:55]
    v_pk_fma_f32 v[18:19], v[18:19], v[52:53], v[54:55]
    v_pk_fma_f32 v[20:21], v[20:21], v[52:53], v[54:55]
    v_pk_fma_f32 v[22:23], v[22:23], v[52:53], v[54:55]
    v_cvt_pk_bf16_f32 v24, v16, v17
    v_cvt_pk_bf16_f32 v25, v18, v19
    v_cvt_pk_bf16_f32 v26, v20, v21
    v_cvt_pk_bf16_f32 v27, v22, v23
    ds_write_b64 v231, v[24:25] offset:0
    ds_write_b64 v231, v[26:27] offset:256
    v_lshlrev_b32 v32, 16, v92
    v_and_b32 v33, s45, v92
    v_lshlrev_b32 v34, 16, v93
    v_and_b32 v35, s45, v93
    v_lshlrev_b32 v36, 16, v94
    v_and_b32 v37, s45, v94
    v_lshlrev_b32 v38, 16, v95
    v_and_b32 v39, s45, v95
    v_pk_fma_f32 v[32:33], v[32:33], v[192:193], v[194:195]
    v_pk_fma_f32 v[34:35], v[34:35], v[192:193], v[194:195]
    v_pk_fma_f32 v[36:37], v[36:37], v[192:193], v[194:195]
    v_pk_fma_f32 v[38:39], v[38:39], v[192:193], v[194:195]
    v_cvt_pk_bf16_f32 v40, v32, v33
    v_cvt_pk_bf16_f32 v41, v34, v35
    v_cvt_pk_bf16_f32 v42, v36, v37
    v_cvt_pk_bf16_f32 v43, v38, v39
    ds_write_b64 v231, v[40:41] offset:128
    ds_write_b64 v231, v[42:43] offset:384
    ds_read_b128 v[88:91], v228 offset:0
    ds_read_b128 v[92:95], v229 offset:1024
    v_lshlrev_b32 v16, 16, v96
    v_and_b32 v17, s45, v96
    v_lshlrev_b32 v18, 16, v97
    v_and_b32 v19, s45, v97
    v_lshlrev_b32 v20, 16, v98
    v_and_b32 v21, s45, v98
    v_lshlrev_b32 v22, 16, v99
    v_and_b32 v23, s45, v99
    v_pk_fma_f32 v[16:17], v[16:17], v[52:53], v[54:55]
    v_pk_fma_f32 v[18:19], v[18:19], v[52:53], v[54:55]
    v_pk_fma_f32 v[20:21], v[20:21], v[52:53], v[54:55]
    v_pk_fma_f32 v[22:23], v[22:23], v[52:53], v[54:55]
    v_cvt_pk_bf16_f32 v28, v16, v17
    v_cvt_pk_bf16_f32 v29, v18, v19
    v_cvt_pk_bf16_f32 v30, v20, v21
    v_cvt_pk_bf16_f32 v31, v22, v23
    ds_write_b64 v231, v[28:29] offset:0
    ds_write_b64 v231, v[30:31] offset:256
    v_lshlrev_b32 v32, 16, v100
    v_and_b32 v33, s45, v100
    v_lshlrev_b32 v34, 16, v101
    v_and_b32 v35, s45, v101
    v_lshlrev_b32 v36, 16, v102
    v_and_b32 v37, s45, v102
    v_lshlrev_b32 v38, 16, v103
    v_and_b32 v39, s45, v103
    v_pk_fma_f32 v[32:33], v[32:33], v[192:193], v[194:195]
    v_pk_fma_f32 v[34:35], v[34:35], v[192:193], v[194:195]
    v_pk_fma_f32 v[36:37], v[36:37], v[192:193], v[194:195]
    v_pk_fma_f32 v[38:39], v[38:39], v[192:193], v[194:195]
    v_cvt_pk_bf16_f32 v44, v32, v33
    v_cvt_pk_bf16_f32 v45, v34, v35
    v_cvt_pk_bf16_f32 v46, v36, v37
    v_cvt_pk_bf16_f32 v47, v38, v39
    ds_write_b64 v231, v[44:45] offset:128
    ds_write_b64 v231, v[46:47] offset:384
    ds_read_b128 v[96:99], v228 offset:0
    ds_read_b128 v[100:103], v229 offset:1024
    v_lshlrev_b32 v16, 16, v104
    v_and_b32 v17, s45, v104
    v_lshlrev_b32 v18, 16, v105
    v_and_b32 v19, s45, v105
    v_lshlrev_b32 v20, 16, v106
    v_and_b32 v21, s45, v106
    v_lshlrev_b32 v22, 16, v107
    v_and_b32 v23, s45, v107
    v_pk_fma_f32 v[16:17], v[16:17], v[52:53], v[54:55]
    v_pk_fma_f32 v[18:19], v[18:19], v[52:53], v[54:55]
    v_pk_fma_f32 v[20:21], v[20:21], v[52:53], v[54:55]
    v_pk_fma_f32 v[22:23], v[22:23], v[52:53], v[54:55]
    v_cvt_pk_bf16_f32 v24, v16, v17
    v_cvt_pk_bf16_f32 v25, v18, v19
    v_cvt_pk_bf16_f32 v26, v20, v21
    v_cvt_pk_bf16_f32 v27, v22, v23
    ds_write_b64 v231, v[24:25] offset:0
    ds_write_b64 v231, v[26:27] offset:256
    v_lshlrev_b32 v32, 16, v108
    v_and_b32 v33, s45, v108
    v_lshlrev_b32 v34, 16, v109
    v_and_b32 v35, s45, v109
    v_lshlrev_b32 v36, 16, v110
    v_and_b32 v37, s45, v110
    v_lshlrev_b32 v38, 16, v111
    v_and_b32 v39, s45, v111
    v_pk_fma_f32 v[32:33], v[32:33], v[192:193], v[194:195]
    v_pk_fma_f32 v[34:35], v[34:35], v[192:193], v[194:195]
    v_pk_fma_f32 v[36:37], v[36:37], v[192:193], v[194:195]
    v_pk_fma_f32 v[38:39], v[38:39], v[192:193], v[194:195]
    v_cvt_pk_bf16_f32 v40, v32, v33
    v_cvt_pk_bf16_f32 v41, v34, v35
    v_cvt_pk_bf16_f32 v42, v36, v37
    v_cvt_pk_bf16_f32 v43, v38, v39
    ds_write_b64 v231, v[40:41] offset:128
    ds_write_b64 v231, v[42:43] offset:384
    ds_read_b128 v[104:107], v228 offset:0
    ds_read_b128 v[108:111], v229 offset:1024
    v_lshlrev_b32 v16, 16, v112
    v_and_b32 v17, s45, v112
    v_lshlrev_b32 v18, 16, v113
    v_and_b32 v19, s45, v113
    v_lshlrev_b32 v20, 16, v114
    v_and_b32 v21, s45, v114
    v_lshlrev_b32 v22, 16, v115
    v_and_b32 v23, s45, v115
    v_pk_fma_f32 v[16:17], v[16:17], v[52:53], v[54:55]
    v_pk_fma_f32 v[18:19], v[18:19], v[52:53], v[54:55]
    v_pk_fma_f32 v[20:21], v[20:21], v[52:53], v[54:55]
    v_pk_fma_f32 v[22:23], v[22:23], v[52:53], v[54:55]
    v_cvt_pk_bf16_f32 v28, v16, v17
    v_cvt_pk_bf16_f32 v29, v18, v19
    v_cvt_pk_bf16_f32 v30, v20, v21
    v_cvt_pk_bf16_f32 v31, v22, v23
    ds_write_b64 v231, v[28:29] offset:0
    ds_write_b64 v231, v[30:31] offset:256
    v_lshlrev_b32 v32, 16, v116
    v_and_b32 v33, s45, v116
    v_lshlrev_b32 v34, 16, v117
    v_and_b32 v35, s45, v117
    v_lshlrev_b32 v36, 16, v118
    v_and_b32 v37, s45, v118
    v_lshlrev_b32 v38, 16, v119
    v_and_b32 v39, s45, v119
    v_pk_fma_f32 v[32:33], v[32:33], v[192:193], v[194:195]
    v_pk_fma_f32 v[34:35], v[34:35], v[192:193], v[194:195]
    v_pk_fma_f32 v[36:37], v[36:37], v[192:193], v[194:195]
    v_pk_fma_f32 v[38:39], v[38:39], v[192:193], v[194:195]
    v_cvt_pk_bf16_f32 v44, v32, v33
    v_cvt_pk_bf16_f32 v45, v34, v35
    v_cvt_pk_bf16_f32 v46, v36, v37
    v_cvt_pk_bf16_f32 v47, v38, v39
    ds_write_b64 v231, v[44:45] offset:128
    ds_write_b64 v231, v[46:47] offset:384
    ds_read_b128 v[112:115], v228 offset:0
    ds_read_b128 v[116:119], v229 offset:1024
    v_lshlrev_b32 v16, 16, v120
    v_and_b32 v17, s45, v120
    v_lshlrev_b32 v18, 16, v121
    v_and_b32 v19, s45, v121
    v_lshlrev_b32 v20, 16, v122
    v_and_b32 v21, s45, v122
    v_lshlrev_b32 v22, 16, v123
    v_and_b32 v23, s45, v123
    v_pk_fma_f32 v[16:17], v[16:17], v[52:53], v[54:55]
    v_pk_fma_f32 v[18:19], v[18:19], v[52:53], v[54:55]
    v_pk_fma_f32 v[20:21], v[20:21], v[52:53], v[54:55]
    v_pk_fma_f32 v[22:23], v[22:23], v[52:53], v[54:55]
    v_cvt_pk_bf16_f32 v24, v16, v17
    v_cvt_pk_bf16_f32 v25, v18, v19
    v_cvt_pk_bf16_f32 v26, v20, v21
    v_cvt_pk_bf16_f32 v27, v22, v23
    ds_write_b64 v231, v[24:25] offset:0
    ds_write_b64 v231, v[26:27] offset:256
    v_lshlrev_b32 v32, 16, v124
    v_and_b32 v33, s45, v124
    v_lshlrev_b32 v34, 16, v125
    v_and_b32 v35, s45, v125
    v_lshlrev_b32 v36, 16, v126
    v_and_b32 v37, s45, v126
    v_lshlrev_b32 v38, 16, v127
    v_and_b32 v39, s45, v127
    v_pk_fma_f32 v[32:33], v[32:33], v[192:193], v[194:195]
    v_pk_fma_f32 v[34:35], v[34:35], v[192:193], v[194:195]
    v_pk_fma_f32 v[36:37], v[36:37], v[192:193], v[194:195]
    v_pk_fma_f32 v[38:39], v[38:39], v[192:193], v[194:195]
    v_cvt_pk_bf16_f32 v40, v32, v33
    v_cvt_pk_bf16_f32 v41, v34, v35
    v_cvt_pk_bf16_f32 v42, v36, v37
    v_cvt_pk_bf16_f32 v43, v38, v39
    ds_write_b64 v231, v[40:41] offset:128
    ds_write_b64 v231, v[42:43] offset:384
    ds_read_b128 v[120:123], v228 offset:0
    ds_read_b128 v[124:127], v229 offset:1024
    s_barrier
    ds_read_b64_tr_b16 v[188:189], v240 offset:0
    ds_read_b64_tr_b16 v[190:191], v240 offset:4096
    ds_read_b64_tr_b16 v[192:193], v241 offset:0
    ds_read_b64_tr_b16 v[194:195], v241 offset:4096
    ds_read_b64_tr_b16 v[196:197], v242 offset:0
    ds_read_b64_tr_b16 v[198:199], v242 offset:4096
    ds_read_b64_tr_b16 v[200:201], v243 offset:0
    ds_read_b64_tr_b16 v[202:203], v243 offset:4096
    ds_read_b64_tr_b16 v[204:205], v244 offset:0
    ds_read_b64_tr_b16 v[206:207], v244 offset:4096
    ds_read_b64_tr_b16 v[208:209], v240 offset:8192
    ds_read_b64_tr_b16 v[210:211], v240 offset:12288
    ds_read_b64_tr_b16 v[212:213], v241 offset:8192
    ds_read_b64_tr_b16 v[214:215], v241 offset:12288
    ds_read_b64_tr_b16 v[216:217], v242 offset:8192
    ds_read_b64_tr_b16 v[218:219], v242 offset:12288
    s_waitcnt lgkmcnt(12)
    v_mfma_f32_16x16x32_bf16 v[168:171], v[188:191], v[56:59], v[168:171]
    ds_read_b64_tr_b16 v[188:189], v243 offset:8192
    ds_read_b64_tr_b16 v[190:191], v243 offset:12288
    v_mfma_f32_16x16x32_bf16 v[172:175], v[192:195], v[56:59], v[172:175]
    ds_read_b64_tr_b16 v[192:193], v244 offset:8192
    ds_read_b64_tr_b16 v[194:195], v244 offset:12288
    s_waitcnt lgkmcnt(12)
    v_mfma_f32_16x16x32_bf16 v[176:179], v[196:199], v[56:59], v[176:179]
    ds_read_b64_tr_b16 v[196:197], v240 offset:16384
    ds_read_b64_tr_b16 v[198:199], v240 offset:20480
    v_mfma_f32_16x16x32_bf16 v[180:183], v[200:203], v[56:59], v[180:183]
    ds_read_b64_tr_b16 v[200:201], v241 offset:16384
    ds_read_b64_tr_b16 v[202:203], v241 offset:20480
    s_waitcnt lgkmcnt(12)
    v_mfma_f32_16x16x32_bf16 v[184:187], v[204:207], v[56:59], v[184:187]
    ds_read_b64_tr_b16 v[204:205], v242 offset:16384
    ds_read_b64_tr_b16 v[206:207], v242 offset:20480
    v_mfma_f32_16x16x32_bf16 v[128:131], v[208:211], v[56:59], v[128:131]
    ds_read_b64_tr_b16 v[208:209], v243 offset:16384
    ds_read_b64_tr_b16 v[210:211], v243 offset:20480
    s_waitcnt lgkmcnt(12)
    v_mfma_f32_16x16x32_bf16 v[132:135], v[212:215], v[56:59], v[132:135]
    ds_read_b64_tr_b16 v[212:213], v244 offset:16384
    ds_read_b64_tr_b16 v[214:215], v244 offset:20480
    v_mfma_f32_16x16x32_bf16 v[136:139], v[216:219], v[56:59], v[136:139]
    s_barrier
    ds_read_b64_tr_b16 v[216:217], v240 offset:24576
    ds_read_b64_tr_b16 v[218:219], v240 offset:28672
    s_waitcnt lgkmcnt(12)
    v_mfma_f32_16x16x32_bf16 v[140:143], v[188:191], v[56:59], v[140:143]
    ds_read_b64_tr_b16 v[188:189], v241 offset:24576
    ds_read_b64_tr_b16 v[190:191], v241 offset:28672
    v_mfma_f32_16x16x32_bf16 v[144:147], v[192:195], v[56:59], v[144:147]
    ds_read_b64_tr_b16 v[192:193], v242 offset:24576
    ds_read_b64_tr_b16 v[194:195], v242 offset:28672
    s_waitcnt lgkmcnt(12)
    v_mfma_f32_16x16x32_bf16 v[148:151], v[196:199], v[56:59], v[148:151]
    ds_read_b64_tr_b16 v[196:197], v243 offset:24576
    ds_read_b64_tr_b16 v[198:199], v243 offset:28672
    v_mfma_f32_16x16x32_bf16 v[152:155], v[200:203], v[56:59], v[152:155]
    ds_read_b64_tr_b16 v[200:201], v244 offset:24576
    ds_read_b64_tr_b16 v[202:203], v244 offset:28672
    s_waitcnt lgkmcnt(12)
    v_mfma_f32_16x16x32_bf16 v[156:159], v[204:207], v[56:59], v[156:159]
    ds_read_b64_tr_b16 v[204:205], v240 offset:32768
    ds_read_b64_tr_b16 v[206:207], v240 offset:36864
    v_mfma_f32_16x16x32_bf16 v[160:163], v[208:211], v[56:59], v[160:163]
    ds_read_b64_tr_b16 v[208:209], v241 offset:32768
    ds_read_b64_tr_b16 v[210:211], v241 offset:36864
    s_waitcnt lgkmcnt(12)
    v_mfma_f32_16x16x32_bf16 v[164:167], v[212:215], v[56:59], v[164:167]
    ds_read_b64_tr_b16 v[212:213], v242 offset:32768
    ds_read_b64_tr_b16 v[214:215], v242 offset:36864
    v_mfma_f32_16x16x32_bf16 v[168:171], v[216:219], v[60:63], v[168:171]
    ds_read_b64_tr_b16 v[216:217], v243 offset:32768
    ds_read_b64_tr_b16 v[218:219], v243 offset:36864
    s_waitcnt lgkmcnt(12)
    v_mfma_f32_16x16x32_bf16 v[172:175], v[188:191], v[60:63], v[172:175]
    ds_read_b64_tr_b16 v[188:189], v244 offset:32768
    ds_read_b64_tr_b16 v[190:191], v244 offset:36864
    v_mfma_f32_16x16x32_bf16 v[176:179], v[192:195], v[60:63], v[176:179]
    ds_read_b64_tr_b16 v[192:193], v240 offset:40960
    ds_read_b64_tr_b16 v[194:195], v240 offset:45056
    s_waitcnt lgkmcnt(12)
    v_mfma_f32_16x16x32_bf16 v[180:183], v[196:199], v[60:63], v[180:183]
    ds_read_b64_tr_b16 v[196:197], v241 offset:40960
    ds_read_b64_tr_b16 v[198:199], v241 offset:45056
    v_mfma_f32_16x16x32_bf16 v[184:187], v[200:203], v[60:63], v[184:187]
    ds_read_b64_tr_b16 v[200:201], v242 offset:40960
    ds_read_b64_tr_b16 v[202:203], v242 offset:45056
    s_waitcnt lgkmcnt(12)
    v_mfma_f32_16x16x32_bf16 v[128:131], v[204:207], v[60:63], v[128:131]
    ds_read_b64_tr_b16 v[204:205], v243 offset:40960
    ds_read_b64_tr_b16 v[206:207], v243 offset:45056
    v_mfma_f32_16x16x32_bf16 v[132:135], v[208:211], v[60:63], v[132:135]
    ds_read_b64_tr_b16 v[208:209], v244 offset:40960
    ds_read_b64_tr_b16 v[210:211], v244 offset:45056
    s_waitcnt lgkmcnt(12)
    v_mfma_f32_16x16x32_bf16 v[136:139], v[212:215], v[60:63], v[136:139]
    s_barrier
    ds_read_b64_tr_b16 v[212:213], v240 offset:49152
    ds_read_b64_tr_b16 v[214:215], v240 offset:53248
    v_mfma_f32_16x16x32_bf16 v[140:143], v[216:219], v[60:63], v[140:143]
    s_lshl_b32 s46, s12, 4
    v_add_u32 v9, s46, v3
    v_mul_u32_u24 v9, 544, v9
    ds_read_b64_tr_b16 v[216:217], v241 offset:49152
    ds_read_b64_tr_b16 v[218:219], v241 offset:53248
    s_waitcnt lgkmcnt(12)
    v_mfma_f32_16x16x32_bf16 v[144:147], v[188:191], v[60:63], v[144:147]
    v_lshl_add_u32 v9, v1, 7, v9
    v_lshrrev_b32 v10, 2, v2
    v_mul_u32_u24 v10, 544, v10
    ds_read_b64_tr_b16 v[188:189], v242 offset:49152
    ds_read_b64_tr_b16 v[190:191], v242 offset:53248
    v_mfma_f32_16x16x32_bf16 v[148:151], v[192:195], v[60:63], v[148:151]
    v_and_b32 v52, 3, v2
    v_lshl_add_u32 v10, v52, 3, v10
    s_lshl_b32 s46, s12, 7
    ds_read_b64_tr_b16 v[192:193], v243 offset:49152
    ds_read_b64_tr_b16 v[194:195], v243 offset:53248
    s_waitcnt lgkmcnt(12)
    v_mfma_f32_16x16x32_bf16 v[152:155], v[196:199], v[60:63], v[152:155]
    v_add_u32 v10, s46, v10
    v_mov_b32 v11, 159648
    ds_read_b64_tr_b16 v[196:197], v244 offset:49152
    ds_read_b64_tr_b16 v[198:199], v244 offset:53248
    v_mfma_f32_16x16x32_bf16 v[156:159], v[200:203], v[60:63], v[156:159]
    ds_read_b64_tr_b16 v[200:201], v240 offset:57344
    ds_read_b64_tr_b16 v[202:203], v240 offset:61440
    s_waitcnt lgkmcnt(12)
    v_mfma_f32_16x16x32_bf16 v[160:163], v[204:207], v[60:63], v[160:163]
    ds_read_b64_tr_b16 v[204:205], v241 offset:57344
    ds_read_b64_tr_b16 v[206:207], v241 offset:61440
    v_mfma_f32_16x16x32_bf16 v[164:167], v[208:211], v[60:63], v[164:167]
    ds_read_b64_tr_b16 v[208:209], v242 offset:57344
    ds_read_b64_tr_b16 v[210:211], v242 offset:61440
    s_waitcnt lgkmcnt(12)
    v_mfma_f32_16x16x32_bf16 v[168:171], v[212:215], v[64:67], v[168:171]
    ds_read_b64_tr_b16 v[212:213], v243 offset:57344
    ds_read_b64_tr_b16 v[214:215], v243 offset:61440
    v_mfma_f32_16x16x32_bf16 v[172:175], v[216:219], v[64:67], v[172:175]
    ds_read_b64_tr_b16 v[216:217], v244 offset:57344
    ds_read_b64_tr_b16 v[218:219], v244 offset:61440
    s_waitcnt lgkmcnt(12)
    v_mfma_f32_16x16x32_bf16 v[176:179], v[188:191], v[64:67], v[176:179]
    ds_read_b64_tr_b16 v[188:189], v245 offset:0
    ds_read_b64_tr_b16 v[190:191], v245 offset:4096
    v_mfma_f32_16x16x32_bf16 v[180:183], v[192:195], v[64:67], v[180:183]
    ds_read_b64_tr_b16 v[192:193], v246 offset:0
    ds_read_b64_tr_b16 v[194:195], v246 offset:4096
    s_waitcnt lgkmcnt(12)
    v_mfma_f32_16x16x32_bf16 v[184:187], v[196:199], v[64:67], v[184:187]
    ds_read_b64_tr_b16 v[196:197], v247 offset:0
    ds_read_b64_tr_b16 v[198:199], v247 offset:4096
    v_mfma_f32_16x16x32_bf16 v[128:131], v[200:203], v[64:67], v[128:131]
    ds_read_b64_tr_b16 v[200:201], v248 offset:0
    ds_read_b64_tr_b16 v[202:203], v248 offset:4096
    s_waitcnt lgkmcnt(12)
    v_mfma_f32_16x16x32_bf16 v[132:135], v[204:207], v[64:67], v[132:135]
    ds_read_b64_tr_b16 v[204:205], v249 offset:0
    ds_read_b64_tr_b16 v[206:207], v249 offset:4096
    v_mfma_f32_16x16x32_bf16 v[136:139], v[208:211], v[64:67], v[136:139]
    s_barrier
    ds_read_b64_tr_b16 v[208:209], v245 offset:8192
    ds_read_b64_tr_b16 v[210:211], v245 offset:12288
    s_waitcnt lgkmcnt(12)
    v_mfma_f32_16x16x32_bf16 v[140:143], v[212:215], v[64:67], v[140:143]
    v_mov_b32 v12, 1
    v_lshlrev_b32 v15, 10, v2
    v_mov_b32 v48, 0
    ds_read_b64_tr_b16 v[212:213], v246 offset:8192
    ds_read_b64_tr_b16 v[214:215], v246 offset:12288
    v_mfma_f32_16x16x32_bf16 v[144:147], v[216:219], v[64:67], v[144:147]
    s_mul_i32 s46, s12, 2560
    s_add_u32 s46, s46, 49152
    v_lshl_add_u32 v50, v2, 4, s46
    ds_read_b64_tr_b16 v[216:217], v247 offset:8192
    ds_read_b64_tr_b16 v[218:219], v247 offset:12288
    s_waitcnt lgkmcnt(12)
    v_mfma_f32_16x16x32_bf16 v[148:151], v[188:191], v[64:67], v[148:151]
    v_lshl_add_u32 v51, v2, 3, s46
    s_lshl_b32 s46, s12, 2
    s_add_u32 s46, s46, 159664
    ds_read_b64_tr_b16 v[188:189], v248 offset:8192
    ds_read_b64_tr_b16 v[190:191], v248 offset:12288
    v_mfma_f32_16x16x32_bf16 v[152:155], v[192:195], v[64:67], v[152:155]
    v_mov_b32 v4, s46
    v_mov_b32 v5, 159652
    ds_read_b64_tr_b16 v[192:193], v249 offset:8192
    ds_read_b64_tr_b16 v[194:195], v249 offset:12288
    s_waitcnt lgkmcnt(12)
    v_mfma_f32_16x16x32_bf16 v[156:159], v[196:199], v[64:67], v[156:159]
    ds_read_b64_tr_b16 v[196:197], v245 offset:16384
    ds_read_b64_tr_b16 v[198:199], v245 offset:20480
    v_mfma_f32_16x16x32_bf16 v[160:163], v[200:203], v[64:67], v[160:163]
    ds_read_b64_tr_b16 v[200:201], v246 offset:16384
    ds_read_b64_tr_b16 v[202:203], v246 offset:20480
    s_waitcnt lgkmcnt(12)
    v_mfma_f32_16x16x32_bf16 v[164:167], v[204:207], v[64:67], v[164:167]
    ds_read_b64_tr_b16 v[204:205], v247 offset:16384
    ds_read_b64_tr_b16 v[206:207], v247 offset:20480
    v_mfma_f32_16x16x32_bf16 v[168:171], v[208:211], v[68:71], v[168:171]
    ds_read_b64_tr_b16 v[208:209], v248 offset:16384
    ds_read_b64_tr_b16 v[210:211], v248 offset:20480
    s_waitcnt lgkmcnt(12)
    v_mfma_f32_16x16x32_bf16 v[172:175], v[212:215], v[68:71], v[172:175]
    ds_read_b64_tr_b16 v[212:213], v249 offset:16384
    ds_read_b64_tr_b16 v[214:215], v249 offset:20480
    v_mfma_f32_16x16x32_bf16 v[176:179], v[216:219], v[68:71], v[176:179]
    ds_read_b64_tr_b16 v[216:217], v245 offset:24576
    ds_read_b64_tr_b16 v[218:219], v245 offset:28672
    s_waitcnt lgkmcnt(12)
    v_mfma_f32_16x16x32_bf16 v[180:183], v[188:191], v[68:71], v[180:183]
    ds_read_b64_tr_b16 v[188:189], v246 offset:24576
    ds_read_b64_tr_b16 v[190:191], v246 offset:28672
    v_mfma_f32_16x16x32_bf16 v[184:187], v[192:195], v[68:71], v[184:187]
    ds_read_b64_tr_b16 v[192:193], v247 offset:24576
    ds_read_b64_tr_b16 v[194:195], v247 offset:28672
    s_waitcnt lgkmcnt(12)
    v_mfma_f32_16x16x32_bf16 v[128:131], v[196:199], v[68:71], v[128:131]
    ds_read_b64_tr_b16 v[196:197], v248 offset:24576
    ds_read_b64_tr_b16 v[198:199], v248 offset:28672
    v_mfma_f32_16x16x32_bf16 v[132:135], v[200:203], v[68:71], v[132:135]
    ds_read_b64_tr_b16 v[200:201], v249 offset:24576
    ds_read_b64_tr_b16 v[202:203], v249 offset:28672
    s_waitcnt lgkmcnt(12)
    v_mfma_f32_16x16x32_bf16 v[136:139], v[204:207], v[68:71], v[136:139]
    s_barrier
    ds_read_b64_tr_b16 v[204:205], v245 offset:32768
    ds_read_b64_tr_b16 v[206:207], v245 offset:36864
    v_mfma_f32_16x16x32_bf16 v[140:143], v[208:211], v[68:71], v[140:143]
    s_and_b32 s46, s12, 1
    s_lshl_b32 s46, s46, 1
    v_add_u32 v52, 0, v3
    ds_read_b64_tr_b16 v[208:209], v246 offset:32768
    ds_read_b64_tr_b16 v[210:211], v246 offset:36864
    s_waitcnt lgkmcnt(12)
    v_mfma_f32_16x16x32_bf16 v[144:147], v[212:215], v[68:71], v[144:147]
    v_subrev_u32 v53, s46, v52
    v_cmp_eq_u32 vcc, 20, v52
    v_cmp_gt_u32 s[48:49], 18, v53
    ds_read_b64_tr_b16 v[212:213], v247 offset:32768
    ds_read_b64_tr_b16 v[214:215], v247 offset:36864
    v_mfma_f32_16x16x32_bf16 v[148:151], v[216:219], v[68:71], v[148:151]
    v_mov_b32 v54, 18
    v_cndmask_b32 v53, v53, v54, vcc
    s_or_b64 vcc, vcc, s[48:49]
    ds_read_b64_tr_b16 v[216:217], v248 offset:32768
    ds_read_b64_tr_b16 v[218:219], v248 offset:36864
    s_waitcnt lgkmcnt(12)
    v_mfma_f32_16x16x32_bf16 v[152:155], v[188:191], v[68:71], v[152:155]
    v_lshrrev_b32 v54, 2, v53
    v_mul_u32_u24 v54, 5, v54
    ds_read_b64_tr_b16 v[188:189], v249 offset:32768
    ds_read_b64_tr_b16 v[190:191], v249 offset:36864
    v_mfma_f32_16x16x32_bf16 v[156:159], v[192:195], v[68:71], v[156:159]
    ds_read_b64_tr_b16 v[192:193], v245 offset:40960
    ds_read_b64_tr_b16 v[194:195], v245 offset:45056
    s_waitcnt lgkmcnt(12)
    v_mfma_f32_16x16x32_bf16 v[160:163], v[196:199], v[68:71], v[160:163]
    ds_read_b64_tr_b16 v[196:197], v246 offset:40960
    ds_read_b64_tr_b16 v[198:199], v246 offset:45056
    v_mfma_f32_16x16x32_bf16 v[164:167], v[200:203], v[68:71], v[164:167]
    ds_read_b64_tr_b16 v[200:201], v247 offset:40960
    ds_read_b64_tr_b16 v[202:203], v247 offset:45056
    s_waitcnt lgkmcnt(12)
    v_mfma_f32_16x16x32_bf16 v[168:171], v[204:207], v[72:75], v[168:171]
    ds_read_b64_tr_b16 v[204:205], v248 offset:40960
    ds_read_b64_tr_b16 v[206:207], v248 offset:45056
    v_mfma_f32_16x16x32_bf16 v[172:175], v[208:211], v[72:75], v[172:175]
    ds_read_b64_tr_b16 v[208:209], v249 offset:40960
    ds_read_b64_tr_b16 v[210:211], v249 offset:45056
    s_waitcnt lgkmcnt(12)
    v_mfma_f32_16x16x32_bf16 v[176:179], v[212:215], v[72:75], v[176:179]
    ds_read_b64_tr_b16 v[212:213], v245 offset:49152
    ds_read_b64_tr_b16 v[214:215], v245 offset:53248
    v_mfma_f32_16x16x32_bf16 v[180:183], v[216:219], v[72:75], v[180:183]
    ds_read_b64_tr_b16 v[216:217], v246 offset:49152
    ds_read_b64_tr_b16 v[218:219], v246 offset:53248
    s_waitcnt lgkmcnt(12)
    v_mfma_f32_16x16x32_bf16 v[184:187], v[188:191], v[72:75], v[184:187]
    ds_read_b64_tr_b16 v[188:189], v247 offset:49152
    ds_read_b64_tr_b16 v[190:191], v247 offset:53248
    v_mfma_f32_16x16x32_bf16 v[128:131], v[192:195], v[72:75], v[128:131]
    ds_read_b64_tr_b16 v[192:193], v248 offset:49152
    ds_read_b64_tr_b16 v[194:195], v248 offset:53248
    s_waitcnt lgkmcnt(12)
    v_mfma_f32_16x16x32_bf16 v[132:135], v[196:199], v[72:75], v[132:135]
    ds_read_b64_tr_b16 v[196:197], v249 offset:49152
    ds_read_b64_tr_b16 v[198:199], v249 offset:53248
    v_mfma_f32_16x16x32_bf16 v[136:139], v[200:203], v[72:75], v[136:139]
    s_barrier
    ds_read_b64_tr_b16 v[200:201], v245 offset:57344
    ds_read_b64_tr_b16 v[202:203], v245 offset:61440
    s_waitcnt lgkmcnt(12)
    v_mfma_f32_16x16x32_bf16 v[140:143], v[204:207], v[72:75], v[140:143]
    v_lshrrev_b32 v55, 1, v1
    v_add_u32 v54, v54, v55
    v_lshlrev_b32 v54, 13, v54
    ds_read_b64_tr_b16 v[204:205], v246 offset:57344
    ds_read_b64_tr_b16 v[206:207], v246 offset:61440
    v_mfma_f32_16x16x32_bf16 v[144:147], v[208:211], v[72:75], v[144:147]
    v_and_b32 v53, 3, v53
    v_lshl_add_u32 v54, v53, 4, v54
    v_and_b32 v55, 1, v1
    ds_read_b64_tr_b16 v[208:209], v247 offset:57344
    ds_read_b64_tr_b16 v[210:211], v247 offset:61440
    s_waitcnt lgkmcnt(12)
    v_mfma_f32_16x16x32_bf16 v[148:151], v[212:215], v[72:75], v[148:151]
    v_lshl_add_u32 v54, v55, 3, v54
    v_mov_b32 v55, 0x40000000
    v_cndmask_b32 v13, v55, v54, vcc
    ds_read_b64_tr_b16 v[212:213], v248 offset:57344
    ds_read_b64_tr_b16 v[214:215], v248 offset:61440
    v_mfma_f32_16x16x32_bf16 v[152:155], v[216:219], v[72:75], v[152:155]
    v_add_u32 v52, 16, v3
    v_subrev_u32 v53, s46, v52
    ds_read_b64_tr_b16 v[216:217], v249 offset:57344
    ds_read_b64_tr_b16 v[218:219], v249 offset:61440
    s_waitcnt lgkmcnt(12)
    v_mfma_f32_16x16x32_bf16 v[156:159], v[188:191], v[72:75], v[156:159]
    ds_read_b64_tr_b16 v[188:189], v250 offset:0
    ds_read_b64_tr_b16 v[190:191], v250 offset:4096
    v_mfma_f32_16x16x32_bf16 v[160:163], v[192:195], v[72:75], v[160:163]
    ds_read_b64_tr_b16 v[192:193], v251 offset:0
    ds_read_b64_tr_b16 v[194:195], v251 offset:4096
    s_waitcnt lgkmcnt(12)
    v_mfma_f32_16x16x32_bf16 v[164:167], v[196:199], v[72:75], v[164:167]
    ds_read_b64_tr_b16 v[196:197], v252 offset:0
    ds_read_b64_tr_b16 v[198:199], v252 offset:4096
    v_mfma_f32_16x16x32_bf16 v[168:171], v[200:203], v[76:79], v[168:171]
    ds_read_b64_tr_b16 v[200:201], v253 offset:0
    ds_read_b64_tr_b16 v[202:203], v253 offset:4096
    s_waitcnt lgkmcnt(12)
    v_mfma_f32_16x16x32_bf16 v[172:175], v[204:207], v[76:79], v[172:175]
    ds_read_b64_tr_b16 v[204:205], v254 offset:0
    ds_read_b64_tr_b16 v[206:207], v254 offset:4096
    v_mfma_f32_16x16x32_bf16 v[176:179], v[208:211], v[76:79], v[176:179]
    ds_read_b64_tr_b16 v[208:209], v250 offset:8192
    ds_read_b64_tr_b16 v[210:211], v250 offset:12288
    s_waitcnt lgkmcnt(12)
    v_mfma_f32_16x16x32_bf16 v[180:183], v[212:215], v[76:79], v[180:183]
    ds_read_b64_tr_b16 v[212:213], v251 offset:8192
    ds_read_b64_tr_b16 v[214:215], v251 offset:12288
    v_mfma_f32_16x16x32_bf16 v[184:187], v[216:219], v[76:79], v[184:187]
    ds_read_b64_tr_b16 v[216:217], v252 offset:8192
    ds_read_b64_tr_b16 v[218:219], v252 offset:12288
    s_waitcnt lgkmcnt(12)
    v_mfma_f32_16x16x32_bf16 v[128:131], v[188:191], v[76:79], v[128:131]
    ds_read_b64_tr_b16 v[188:189], v253 offset:8192
    ds_read_b64_tr_b16 v[190:191], v253 offset:12288
    v_mfma_f32_16x16x32_bf16 v[132:135], v[192:195], v[76:79], v[132:135]
    ds_read_b64_tr_b16 v[192:193], v254 offset:8192
    ds_read_b64_tr_b16 v[194:195], v254 offset:12288
    s_waitcnt lgkmcnt(12)
    v_mfma_f32_16x16x32_bf16 v[136:139], v[196:199], v[76:79], v[136:139]
    s_barrier
    ds_read_b64_tr_b16 v[196:197], v240 offset:0
    ds_read_b64_tr_b16 v[198:199], v240 offset:4096
    v_mfma_f32_16x16x32_bf16 v[140:143], v[200:203], v[76:79], v[140:143]
    v_cmp_eq_u32 vcc, 20, v52
    v_cmp_gt_u32 s[48:49], 18, v53
    v_mov_b32 v54, 18
    ds_read_b64_tr_b16 v[200:201], v241 offset:0
    ds_read_b64_tr_b16 v[202:203], v241 offset:4096
    s_waitcnt lgkmcnt(12)
    v_mfma_f32_16x16x32_bf16 v[144:147], v[204:207], v[76:79], v[144:147]
    v_cndmask_b32 v53, v53, v54, vcc
    s_or_b64 vcc, vcc, s[48:49]
    v_lshrrev_b32 v54, 2, v53
    ds_read_b64_tr_b16 v[204:205], v242 offset:0
    ds_read_b64_tr_b16 v[206:207], v242 offset:4096
    v_mfma_f32_16x16x32_bf16 v[148:151], v[208:211], v[76:79], v[148:151]
    v_mul_u32_u24 v54, 5, v54
    v_lshrrev_b32 v55, 1, v1
    v_add_u32 v54, v54, v55
    ds_read_b64_tr_b16 v[208:209], v243 offset:0
    ds_read_b64_tr_b16 v[210:211], v243 offset:4096
    s_waitcnt lgkmcnt(12)
    v_mfma_f32_16x16x32_bf16 v[152:155], v[212:215], v[76:79], v[152:155]
    v_lshlrev_b32 v54, 13, v54
    v_and_b32 v53, 3, v53
    ds_read_b64_tr_b16 v[212:213], v244 offset:0
    ds_read_b64_tr_b16 v[214:215], v244 offset:4096
    v_mfma_f32_16x16x32_bf16 v[156:159], v[216:219], v[76:79], v[156:159]
    ds_read_b64_tr_b16 v[216:217], v240 offset:8192
    ds_read_b64_tr_b16 v[218:219], v240 offset:12288
    s_waitcnt lgkmcnt(12)
    v_mfma_f32_16x16x32_bf16 v[160:163], v[188:191], v[76:79], v[160:163]
    ds_read_b64_tr_b16 v[188:189], v241 offset:8192
    ds_read_b64_tr_b16 v[190:191], v241 offset:12288
    v_mfma_f32_16x16x32_bf16 v[164:167], v[192:195], v[76:79], v[164:167]
    ds_read_b64_tr_b16 v[192:193], v242 offset:8192
    ds_read_b64_tr_b16 v[194:195], v242 offset:12288
    s_waitcnt lgkmcnt(12)
    v_mfma_f32_16x16x32_bf16 v[168:171], v[196:199], v[80:83], v[168:171]
    ds_read_b64_tr_b16 v[196:197], v243 offset:8192
    ds_read_b64_tr_b16 v[198:199], v243 offset:12288
    v_mfma_f32_16x16x32_bf16 v[172:175], v[200:203], v[80:83], v[172:175]
    ds_read_b64_tr_b16 v[200:201], v244 offset:8192
    ds_read_b64_tr_b16 v[202:203], v244 offset:12288
    s_waitcnt lgkmcnt(12)
    v_mfma_f32_16x16x32_bf16 v[176:179], v[204:207], v[80:83], v[176:179]
    ds_read_b64_tr_b16 v[204:205], v240 offset:16384
    ds_read_b64_tr_b16 v[206:207], v240 offset:20480
    v_mfma_f32_16x16x32_bf16 v[180:183], v[208:211], v[80:83], v[180:183]
    ds_read_b64_tr_b16 v[208:209], v241 offset:16384
    ds_read_b64_tr_b16 v[210:211], v241 offset:20480
    s_waitcnt lgkmcnt(12)
    v_mfma_f32_16x16x32_bf16 v[184:187], v[212:215], v[80:83], v[184:187]
    ds_read_b64_tr_b16 v[212:213], v242 offset:16384
    ds_read_b64_tr_b16 v[214:215], v242 offset:20480
    v_mfma_f32_16x16x32_bf16 v[128:131], v[216:219], v[80:83], v[128:131]
    ds_read_b64_tr_b16 v[216:217], v243 offset:16384
    ds_read_b64_tr_b16 v[218:219], v243 offset:20480
    s_waitcnt lgkmcnt(12)
    v_mfma_f32_16x16x32_bf16 v[132:135], v[188:191], v[80:83], v[132:135]
    ds_read_b64_tr_b16 v[188:189], v244 offset:16384
    ds_read_b64_tr_b16 v[190:191], v244 offset:20480
    v_mfma_f32_16x16x32_bf16 v[136:139], v[192:195], v[80:83], v[136:139]
    s_barrier
    ds_read_b64_tr_b16 v[192:193], v240 offset:24576
    ds_read_b64_tr_b16 v[194:195], v240 offset:28672
    s_waitcnt lgkmcnt(12)
    v_mfma_f32_16x16x32_bf16 v[140:143], v[196:199], v[80:83], v[140:143]
    v_lshl_add_u32 v54, v53, 4, v54
    v_and_b32 v55, 1, v1
    v_lshl_add_u32 v54, v55, 3, v54
    ds_read_b64_tr_b16 v[196:197], v241 offset:24576
    ds_read_b64_tr_b16 v[198:199], v241 offset:28672
    v_mfma_f32_16x16x32_bf16 v[144:147], v[200:203], v[80:83], v[144:147]
    v_mov_b32 v55, 0x40000000
    v_cndmask_b32 v14, v55, v54, vcc
    s_mul_i32 s52, s13, 204800
    ds_read_b64_tr_b16 v[200:201], v242 offset:24576
    ds_read_b64_tr_b16 v[202:203], v242 offset:28672
    s_waitcnt lgkmcnt(12)
    v_mfma_f32_16x16x32_bf16 v[148:151], v[204:207], v[80:83], v[148:151]
    s_lshl_b32 s47, s14, 8
    s_add_u32 s52, s52, s47
    s_lshl_b32 s47, s12, 6
    ds_read_b64_tr_b16 v[204:205], v243 offset:24576
    ds_read_b64_tr_b16 v[206:207], v243 offset:28672
    v_mfma_f32_16x16x32_bf16 v[152:155], v[208:211], v[80:83], v[152:155]
    s_add_u32 s52, s52, s47
    s_add_u32 s53, s52, 16384
    ds_read_b64_tr_b16 v[208:209], v244 offset:24576
    ds_read_b64_tr_b16 v[210:211], v244 offset:28672
    s_waitcnt lgkmcnt(12)
    v_mfma_f32_16x16x32_bf16 v[156:159], v[212:215], v[80:83], v[156:159]
    ds_read_b64_tr_b16 v[212:213], v240 offset:32768
    ds_read_b64_tr_b16 v[214:215], v240 offset:36864
    v_mfma_f32_16x16x32_bf16 v[160:163], v[216:219], v[80:83], v[160:163]
    ds_read_b64_tr_b16 v[216:217], v241 offset:32768
    ds_read_b64_tr_b16 v[218:219], v241 offset:36864
    s_waitcnt lgkmcnt(12)
    v_mfma_f32_16x16x32_bf16 v[164:167], v[188:191], v[80:83], v[164:167]
    ds_read_b64_tr_b16 v[188:189], v242 offset:32768
    ds_read_b64_tr_b16 v[190:191], v242 offset:36864
    v_mfma_f32_16x16x32_bf16 v[168:171], v[192:195], v[84:87], v[168:171]
    ds_read_b64_tr_b16 v[192:193], v243 offset:32768
    ds_read_b64_tr_b16 v[194:195], v243 offset:36864
    s_waitcnt lgkmcnt(12)
    v_mfma_f32_16x16x32_bf16 v[172:175], v[196:199], v[84:87], v[172:175]
    ds_read_b64_tr_b16 v[196:197], v244 offset:32768
    ds_read_b64_tr_b16 v[198:199], v244 offset:36864
    v_mfma_f32_16x16x32_bf16 v[176:179], v[200:203], v[84:87], v[176:179]
    ds_read_b64_tr_b16 v[200:201], v240 offset:40960
    ds_read_b64_tr_b16 v[202:203], v240 offset:45056
    s_waitcnt lgkmcnt(12)
    v_mfma_f32_16x16x32_bf16 v[180:183], v[204:207], v[84:87], v[180:183]
    ds_read_b64_tr_b16 v[204:205], v241 offset:40960
    ds_read_b64_tr_b16 v[206:207], v241 offset:45056
    v_mfma_f32_16x16x32_bf16 v[184:187], v[208:211], v[84:87], v[184:187]
    ds_read_b64_tr_b16 v[208:209], v242 offset:40960
    ds_read_b64_tr_b16 v[210:211], v242 offset:45056
    s_waitcnt lgkmcnt(12)
    v_mfma_f32_16x16x32_bf16 v[128:131], v[212:215], v[84:87], v[128:131]
    ds_read_b64_tr_b16 v[212:213], v243 offset:40960
    ds_read_b64_tr_b16 v[214:215], v243 offset:45056
    v_mfma_f32_16x16x32_bf16 v[132:135], v[216:219], v[84:87], v[132:135]
    ds_read_b64_tr_b16 v[216:217], v244 offset:40960
    ds_read_b64_tr_b16 v[218:219], v244 offset:45056
    s_waitcnt lgkmcnt(12)
    v_mfma_f32_16x16x32_bf16 v[136:139], v[188:191], v[84:87], v[136:139]
    s_barrier
    ds_read_b64_tr_b16 v[188:189], v240 offset:49152
    ds_read_b64_tr_b16 v[190:191], v240 offset:53248
    v_mfma_f32_16x16x32_bf16 v[140:143], v[192:195], v[84:87], v[140:143]
    s_add_u32 s54, s52, 32768
    s_mov_b32 s24, s60
    s_mov_b32 s25, s61
    ds_read_b64_tr_b16 v[192:193], v241 offset:49152
    ds_read_b64_tr_b16 v[194:195], v241 offset:53248
    s_waitcnt lgkmcnt(12)
    v_mfma_f32_16x16x32_bf16 v[144:147], v[196:199], v[84:87], v[144:147]
    s_mov_b32 s26, 256
    s_mov_b32 s27, 0x00020000
    s_add_u32 s28, s8, 58720256
    ds_read_b64_tr_b16 v[196:197], v242 offset:49152
    ds_read_b64_tr_b16 v[198:199], v242 offset:53248
    v_mfma_f32_16x16x32_bf16 v[148:151], v[200:203], v[84:87], v[148:151]
    s_addc_u32 s29, s9, 0
    s_mov_b32 s30, 3276800
    s_mov_b32 s31, 0x00020000
    ds_read_b64_tr_b16 v[200:201], v243 offset:49152
    ds_read_b64_tr_b16 v[202:203], v243 offset:53248
    s_waitcnt lgkmcnt(12)
    v_mfma_f32_16x16x32_bf16 v[152:155], v[204:207], v[84:87], v[152:155]
    s_add_u32 s32, s8, 67239936
    s_addc_u32 s33, s9, 0
    ds_read_b64_tr_b16 v[204:205], v244 offset:49152
    ds_read_b64_tr_b16 v[206:207], v244 offset:53248
    v_mfma_f32_16x16x32_bf16 v[156:159], v[208:211], v[84:87], v[156:159]
    ds_read_b64_tr_b16 v[208:209], v240 offset:57344
    ds_read_b64_tr_b16 v[210:211], v240 offset:61440
    s_waitcnt lgkmcnt(12)
    v_mfma_f32_16x16x32_bf16 v[160:163], v[212:215], v[84:87], v[160:163]
    ds_read_b64_tr_b16 v[212:213], v241 offset:57344
    ds_read_b64_tr_b16 v[214:215], v241 offset:61440
    v_mfma_f32_16x16x32_bf16 v[164:167], v[216:219], v[84:87], v[164:167]
    ds_read_b64_tr_b16 v[216:217], v242 offset:57344
    ds_read_b64_tr_b16 v[218:219], v242 offset:61440
    s_waitcnt lgkmcnt(12)
    v_mfma_f32_16x16x32_bf16 v[168:171], v[188:191], v[88:91], v[168:171]
    ds_read_b64_tr_b16 v[188:189], v243 offset:57344
    ds_read_b64_tr_b16 v[190:191], v243 offset:61440
    v_mfma_f32_16x16x32_bf16 v[172:175], v[192:195], v[88:91], v[172:175]
    ds_read_b64_tr_b16 v[192:193], v244 offset:57344
    ds_read_b64_tr_b16 v[194:195], v244 offset:61440
    s_waitcnt lgkmcnt(12)
    v_mfma_f32_16x16x32_bf16 v[176:179], v[196:199], v[88:91], v[176:179]
    ds_read_b64_tr_b16 v[196:197], v245 offset:0
    ds_read_b64_tr_b16 v[198:199], v245 offset:4096
    v_mfma_f32_16x16x32_bf16 v[180:183], v[200:203], v[88:91], v[180:183]
    ds_read_b64_tr_b16 v[200:201], v246 offset:0
    ds_read_b64_tr_b16 v[202:203], v246 offset:4096
    s_waitcnt lgkmcnt(12)
    v_mfma_f32_16x16x32_bf16 v[184:187], v[204:207], v[88:91], v[184:187]
    ds_read_b64_tr_b16 v[204:205], v247 offset:0
    ds_read_b64_tr_b16 v[206:207], v247 offset:4096
    v_mfma_f32_16x16x32_bf16 v[128:131], v[208:211], v[88:91], v[128:131]
    ds_read_b64_tr_b16 v[208:209], v248 offset:0
    ds_read_b64_tr_b16 v[210:211], v248 offset:4096
    s_waitcnt lgkmcnt(12)
    v_mfma_f32_16x16x32_bf16 v[132:135], v[212:215], v[88:91], v[132:135]
    ds_read_b64_tr_b16 v[212:213], v249 offset:0
    ds_read_b64_tr_b16 v[214:215], v249 offset:4096
    v_mfma_f32_16x16x32_bf16 v[136:139], v[216:219], v[88:91], v[136:139]
    s_barrier
    ds_read_b64_tr_b16 v[216:217], v245 offset:8192
    ds_read_b64_tr_b16 v[218:219], v245 offset:12288
    s_waitcnt lgkmcnt(12)
    v_mfma_f32_16x16x32_bf16 v[140:143], v[188:191], v[88:91], v[140:143]
    s_mov_b32 s34, 24576
    s_mov_b32 s35, 0x00020000
    s_lshl_b32 s55, s13, 7
    ds_read_b64_tr_b16 v[188:189], v246 offset:8192
    ds_read_b64_tr_b16 v[190:191], v246 offset:12288
    v_mfma_f32_16x16x32_bf16 v[144:147], v[192:195], v[88:91], v[144:147]
    s_lshl_b32 s47, s14, 2
    s_add_u32 s55, s55, s47
    v_mov_b32 v44, 0x00003f80
    ds_read_b64_tr_b16 v[192:193], v247 offset:8192
    ds_read_b64_tr_b16 v[194:195], v247 offset:12288
    s_waitcnt lgkmcnt(12)
    v_mfma_f32_16x16x32_bf16 v[148:151], v[196:199], v[88:91], v[148:151]
    v_mov_b32 v45, 0
    v_mov_b32 v46, 0
    v_mov_b32 v47, 0
    ds_read_b64_tr_b16 v[196:197], v248 offset:8192
    ds_read_b64_tr_b16 v[198:199], v248 offset:12288
    v_mfma_f32_16x16x32_bf16 v[152:155], v[200:203], v[88:91], v[152:155]
    ds_read_b64_tr_b16 v[200:201], v249 offset:8192
    ds_read_b64_tr_b16 v[202:203], v249 offset:12288
    s_waitcnt lgkmcnt(12)
    v_mfma_f32_16x16x32_bf16 v[156:159], v[204:207], v[88:91], v[156:159]
    ds_read_b64_tr_b16 v[204:205], v245 offset:16384
    ds_read_b64_tr_b16 v[206:207], v245 offset:20480
    v_mfma_f32_16x16x32_bf16 v[160:163], v[208:211], v[88:91], v[160:163]
    ds_read_b64_tr_b16 v[208:209], v246 offset:16384
    ds_read_b64_tr_b16 v[210:211], v246 offset:20480
    s_waitcnt lgkmcnt(12)
    v_mfma_f32_16x16x32_bf16 v[164:167], v[212:215], v[88:91], v[164:167]
    ds_read_b64_tr_b16 v[212:213], v247 offset:16384
    ds_read_b64_tr_b16 v[214:215], v247 offset:20480
    v_mfma_f32_16x16x32_bf16 v[168:171], v[216:219], v[92:95], v[168:171]
    ds_read_b64_tr_b16 v[216:217], v248 offset:16384
    ds_read_b64_tr_b16 v[218:219], v248 offset:20480
    s_waitcnt lgkmcnt(12)
    v_mfma_f32_16x16x32_bf16 v[172:175], v[188:191], v[92:95], v[172:175]
    ds_read_b64_tr_b16 v[188:189], v249 offset:16384
    ds_read_b64_tr_b16 v[190:191], v249 offset:20480
    v_mfma_f32_16x16x32_bf16 v[176:179], v[192:195], v[92:95], v[176:179]
    ds_read_b64_tr_b16 v[192:193], v245 offset:24576
    ds_read_b64_tr_b16 v[194:195], v245 offset:28672
    s_waitcnt lgkmcnt(12)
    v_mfma_f32_16x16x32_bf16 v[180:183], v[196:199], v[92:95], v[180:183]
    ds_read_b64_tr_b16 v[196:197], v246 offset:24576
    ds_read_b64_tr_b16 v[198:199], v246 offset:28672
    v_mfma_f32_16x16x32_bf16 v[184:187], v[200:203], v[92:95], v[184:187]
    ds_read_b64_tr_b16 v[200:201], v247 offset:24576
    ds_read_b64_tr_b16 v[202:203], v247 offset:28672
    s_waitcnt lgkmcnt(12)
    v_mfma_f32_16x16x32_bf16 v[128:131], v[204:207], v[92:95], v[128:131]
    ds_read_b64_tr_b16 v[204:205], v248 offset:24576
    ds_read_b64_tr_b16 v[206:207], v248 offset:28672
    v_mfma_f32_16x16x32_bf16 v[132:135], v[208:211], v[92:95], v[132:135]
    ds_read_b64_tr_b16 v[208:209], v249 offset:24576
    ds_read_b64_tr_b16 v[210:211], v249 offset:28672
    s_waitcnt lgkmcnt(12)
    v_mfma_f32_16x16x32_bf16 v[136:139], v[212:215], v[92:95], v[136:139]
    s_barrier
    ds_read_b64_tr_b16 v[212:213], v245 offset:32768
    ds_read_b64_tr_b16 v[214:215], v245 offset:36864
    v_mfma_f32_16x16x32_bf16 v[140:143], v[216:219], v[92:95], v[140:143]
    ds_read_b64_tr_b16 v[216:217], v246 offset:32768
    ds_read_b64_tr_b16 v[218:219], v246 offset:36864
    s_waitcnt lgkmcnt(12)
    v_mfma_f32_16x16x32_bf16 v[144:147], v[188:191], v[92:95], v[144:147]
    ds_read_b64_tr_b16 v[188:189], v247 offset:32768
    ds_read_b64_tr_b16 v[190:191], v247 offset:36864
    v_mfma_f32_16x16x32_bf16 v[148:151], v[192:195], v[92:95], v[148:151]
    ds_read_b64_tr_b16 v[192:193], v248 offset:32768
    ds_read_b64_tr_b16 v[194:195], v248 offset:36864
    s_waitcnt lgkmcnt(12)
    v_mfma_f32_16x16x32_bf16 v[152:155], v[196:199], v[92:95], v[152:155]
    ds_read_b64_tr_b16 v[196:197], v249 offset:32768
    ds_read_b64_tr_b16 v[198:199], v249 offset:36864
    v_mfma_f32_16x16x32_bf16 v[156:159], v[200:203], v[92:95], v[156:159]
    ds_read_b64_tr_b16 v[200:201], v245 offset:40960
    ds_read_b64_tr_b16 v[202:203], v245 offset:45056
    s_waitcnt lgkmcnt(12)
    v_mfma_f32_16x16x32_bf16 v[160:163], v[204:207], v[92:95], v[160:163]
    ds_read_b64_tr_b16 v[204:205], v246 offset:40960
    ds_read_b64_tr_b16 v[206:207], v246 offset:45056
    v_mfma_f32_16x16x32_bf16 v[164:167], v[208:211], v[92:95], v[164:167]
    ds_read_b64_tr_b16 v[208:209], v247 offset:40960
    ds_read_b64_tr_b16 v[210:211], v247 offset:45056
    s_waitcnt lgkmcnt(12)
    v_mfma_f32_16x16x32_bf16 v[168:171], v[212:215], v[96:99], v[168:171]
    ds_read_b64_tr_b16 v[212:213], v248 offset:40960
    ds_read_b64_tr_b16 v[214:215], v248 offset:45056
    v_mfma_f32_16x16x32_bf16 v[172:175], v[216:219], v[96:99], v[172:175]
    ds_read_b64_tr_b16 v[216:217], v249 offset:40960
    ds_read_b64_tr_b16 v[218:219], v249 offset:45056
    s_waitcnt lgkmcnt(12)
    v_mfma_f32_16x16x32_bf16 v[176:179], v[188:191], v[96:99], v[176:179]
    ds_read_b64_tr_b16 v[188:189], v245 offset:49152
    ds_read_b64_tr_b16 v[190:191], v245 offset:53248
    v_mfma_f32_16x16x32_bf16 v[180:183], v[192:195], v[96:99], v[180:183]
    ds_read_b64_tr_b16 v[192:193], v246 offset:49152
    ds_read_b64_tr_b16 v[194:195], v246 offset:53248
    s_waitcnt lgkmcnt(12)
    v_mfma_f32_16x16x32_bf16 v[184:187], v[196:199], v[96:99], v[184:187]
    ds_read_b64_tr_b16 v[196:197], v247 offset:49152
    ds_read_b64_tr_b16 v[198:199], v247 offset:53248
    v_mfma_f32_16x16x32_bf16 v[128:131], v[200:203], v[96:99], v[128:131]
    ds_read_b64_tr_b16 v[200:201], v248 offset:49152
    ds_read_b64_tr_b16 v[202:203], v248 offset:53248
    s_waitcnt lgkmcnt(12)
    v_mfma_f32_16x16x32_bf16 v[132:135], v[204:207], v[96:99], v[132:135]
    ds_read_b64_tr_b16 v[204:205], v249 offset:49152
    ds_read_b64_tr_b16 v[206:207], v249 offset:53248
    v_mfma_f32_16x16x32_bf16 v[136:139], v[208:211], v[96:99], v[136:139]
    s_barrier
    ds_read_b64_tr_b16 v[208:209], v245 offset:57344
    ds_read_b64_tr_b16 v[210:211], v245 offset:61440
    s_waitcnt lgkmcnt(12)
    v_mfma_f32_16x16x32_bf16 v[140:143], v[212:215], v[96:99], v[140:143]
    ds_read_b64_tr_b16 v[212:213], v246 offset:57344
    ds_read_b64_tr_b16 v[214:215], v246 offset:61440
    v_mfma_f32_16x16x32_bf16 v[144:147], v[216:219], v[96:99], v[144:147]
    ds_read_b64_tr_b16 v[216:217], v247 offset:57344
    ds_read_b64_tr_b16 v[218:219], v247 offset:61440
    s_waitcnt lgkmcnt(12)
    v_mfma_f32_16x16x32_bf16 v[148:151], v[188:191], v[96:99], v[148:151]
    ds_read_b64_tr_b16 v[188:189], v248 offset:57344
    ds_read_b64_tr_b16 v[190:191], v248 offset:61440
    v_mfma_f32_16x16x32_bf16 v[152:155], v[192:195], v[96:99], v[152:155]
    ds_read_b64_tr_b16 v[192:193], v249 offset:57344
    ds_read_b64_tr_b16 v[194:195], v249 offset:61440
    s_waitcnt lgkmcnt(12)
    v_mfma_f32_16x16x32_bf16 v[156:159], v[196:199], v[96:99], v[156:159]
    ds_read_b64_tr_b16 v[196:197], v250 offset:0
    ds_read_b64_tr_b16 v[198:199], v250 offset:4096
    v_mfma_f32_16x16x32_bf16 v[160:163], v[200:203], v[96:99], v[160:163]
    ds_read_b64_tr_b16 v[200:201], v251 offset:0
    ds_read_b64_tr_b16 v[202:203], v251 offset:4096
    s_waitcnt lgkmcnt(12)
    v_mfma_f32_16x16x32_bf16 v[164:167], v[204:207], v[96:99], v[164:167]
    ds_read_b64_tr_b16 v[204:205], v252 offset:0
    ds_read_b64_tr_b16 v[206:207], v252 offset:4096
    v_mfma_f32_16x16x32_bf16 v[168:171], v[208:211], v[100:103], v[168:171]
    ds_read_b64_tr_b16 v[208:209], v253 offset:0
    ds_read_b64_tr_b16 v[210:211], v253 offset:4096
    s_waitcnt lgkmcnt(12)
    v_mfma_f32_16x16x32_bf16 v[172:175], v[212:215], v[100:103], v[172:175]
    ds_read_b64_tr_b16 v[212:213], v254 offset:0
    ds_read_b64_tr_b16 v[214:215], v254 offset:4096
    v_mfma_f32_16x16x32_bf16 v[176:179], v[216:219], v[100:103], v[176:179]
    ds_read_b64_tr_b16 v[216:217], v250 offset:8192
    ds_read_b64_tr_b16 v[218:219], v250 offset:12288
    s_waitcnt lgkmcnt(12)
    v_mfma_f32_16x16x32_bf16 v[180:183], v[188:191], v[100:103], v[180:183]
    ds_read_b64_tr_b16 v[188:189], v251 offset:8192
    ds_read_b64_tr_b16 v[190:191], v251 offset:12288
    v_mfma_f32_16x16x32_bf16 v[184:187], v[192:195], v[100:103], v[184:187]
    ds_read_b64_tr_b16 v[192:193], v252 offset:8192
    ds_read_b64_tr_b16 v[194:195], v252 offset:12288
    s_waitcnt lgkmcnt(12)
    v_mfma_f32_16x16x32_bf16 v[128:131], v[196:199], v[100:103], v[128:131]
    ds_read_b64_tr_b16 v[196:197], v253 offset:8192
    ds_read_b64_tr_b16 v[198:199], v253 offset:12288
    v_mfma_f32_16x16x32_bf16 v[132:135], v[200:203], v[100:103], v[132:135]
    ds_read_b64_tr_b16 v[200:201], v254 offset:8192
    ds_read_b64_tr_b16 v[202:203], v254 offset:12288
    s_waitcnt lgkmcnt(12)
    v_mfma_f32_16x16x32_bf16 v[136:139], v[204:207], v[100:103], v[136:139]
    s_barrier
    ds_read_b64_tr_b16 v[204:205], v240 offset:0
    ds_read_b64_tr_b16 v[206:207], v240 offset:4096
    v_mfma_f32_16x16x32_bf16 v[140:143], v[208:211], v[100:103], v[140:143]
    buffer_load_dword v49, v48, s[24:27], 0 offen sc1
    ds_read_b64_tr_b16 v[208:209], v241 offset:0
    ds_read_b64_tr_b16 v[210:211], v241 offset:4096
    s_waitcnt lgkmcnt(12)
    v_mfma_f32_16x16x32_bf16 v[144:147], v[212:215], v[100:103], v[144:147]
    ds_read_b64_tr_b16 v[212:213], v242 offset:0
    ds_read_b64_tr_b16 v[214:215], v242 offset:4096
    v_mfma_f32_16x16x32_bf16 v[148:151], v[216:219], v[100:103], v[148:151]
    ds_read_b64_tr_b16 v[216:217], v243 offset:0
    ds_read_b64_tr_b16 v[218:219], v243 offset:4096
    s_waitcnt lgkmcnt(12)
    v_mfma_f32_16x16x32_bf16 v[152:155], v[188:191], v[100:103], v[152:155]
    ds_read_b64_tr_b16 v[188:189], v244 offset:0
    ds_read_b64_tr_b16 v[190:191], v244 offset:4096
    v_mfma_f32_16x16x32_bf16 v[156:159], v[192:195], v[100:103], v[156:159]
    ds_read_b64_tr_b16 v[192:193], v240 offset:8192
    ds_read_b64_tr_b16 v[194:195], v240 offset:12288
    s_waitcnt lgkmcnt(12)
    v_mfma_f32_16x16x32_bf16 v[160:163], v[196:199], v[100:103], v[160:163]
    ds_read_b64_tr_b16 v[196:197], v241 offset:8192
    ds_read_b64_tr_b16 v[198:199], v241 offset:12288
    v_mfma_f32_16x16x32_bf16 v[164:167], v[200:203], v[100:103], v[164:167]
    ds_read_b64_tr_b16 v[200:201], v242 offset:8192
    ds_read_b64_tr_b16 v[202:203], v242 offset:12288
    s_waitcnt lgkmcnt(12)
    v_mfma_f32_16x16x32_bf16 v[168:171], v[204:207], v[104:107], v[168:171]
    ds_read_b64_tr_b16 v[204:205], v243 offset:8192
    ds_read_b64_tr_b16 v[206:207], v243 offset:12288
    v_mfma_f32_16x16x32_bf16 v[172:175], v[208:211], v[104:107], v[172:175]
    ds_read_b64_tr_b16 v[208:209], v244 offset:8192
    ds_read_b64_tr_b16 v[210:211], v244 offset:12288
    s_waitcnt lgkmcnt(12)
    v_mfma_f32_16x16x32_bf16 v[176:179], v[212:215], v[104:107], v[176:179]
    ds_read_b64_tr_b16 v[212:213], v240 offset:16384
    ds_read_b64_tr_b16 v[214:215], v240 offset:20480
    v_mfma_f32_16x16x32_bf16 v[180:183], v[216:219], v[104:107], v[180:183]
    ds_read_b64_tr_b16 v[216:217], v241 offset:16384
    ds_read_b64_tr_b16 v[218:219], v241 offset:20480
    s_waitcnt lgkmcnt(12)
    v_mfma_f32_16x16x32_bf16 v[184:187], v[188:191], v[104:107], v[184:187]
    ds_read_b64_tr_b16 v[188:189], v242 offset:16384
    ds_read_b64_tr_b16 v[190:191], v242 offset:20480
    v_mfma_f32_16x16x32_bf16 v[128:131], v[192:195], v[104:107], v[128:131]
    ds_read_b64_tr_b16 v[192:193], v243 offset:16384
    ds_read_b64_tr_b16 v[194:195], v243 offset:20480
    s_waitcnt lgkmcnt(12)
    v_mfma_f32_16x16x32_bf16 v[132:135], v[196:199], v[104:107], v[132:135]
    ds_read_b64_tr_b16 v[196:197], v244 offset:16384
    ds_read_b64_tr_b16 v[198:199], v244 offset:20480
    v_mfma_f32_16x16x32_bf16 v[136:139], v[200:203], v[104:107], v[136:139]
    s_barrier
    ds_read_b64_tr_b16 v[200:201], v240 offset:24576
    ds_read_b64_tr_b16 v[202:203], v240 offset:28672
    s_waitcnt lgkmcnt(12)
    v_mfma_f32_16x16x32_bf16 v[140:143], v[204:207], v[104:107], v[140:143]
    ds_read_b64_tr_b16 v[204:205], v241 offset:24576
    ds_read_b64_tr_b16 v[206:207], v241 offset:28672
    v_mfma_f32_16x16x32_bf16 v[144:147], v[208:211], v[104:107], v[144:147]
    ds_read_b64_tr_b16 v[208:209], v242 offset:24576
    ds_read_b64_tr_b16 v[210:211], v242 offset:28672
    s_waitcnt lgkmcnt(12)
    v_mfma_f32_16x16x32_bf16 v[148:151], v[212:215], v[104:107], v[148:151]
    ds_read_b64_tr_b16 v[212:213], v243 offset:24576
    ds_read_b64_tr_b16 v[214:215], v243 offset:28672
    v_mfma_f32_16x16x32_bf16 v[152:155], v[216:219], v[104:107], v[152:155]
    ds_read_b64_tr_b16 v[216:217], v244 offset:24576
    ds_read_b64_tr_b16 v[218:219], v244 offset:28672
    s_waitcnt lgkmcnt(12)
    v_mfma_f32_16x16x32_bf16 v[156:159], v[188:191], v[104:107], v[156:159]
    ds_read_b64_tr_b16 v[188:189], v240 offset:32768
    ds_read_b64_tr_b16 v[190:191], v240 offset:36864
    v_mfma_f32_16x16x32_bf16 v[160:163], v[192:195], v[104:107], v[160:163]
    ds_read_b64_tr_b16 v[192:193], v241 offset:32768
    ds_read_b64_tr_b16 v[194:195], v241 offset:36864
    s_waitcnt lgkmcnt(12)
    v_mfma_f32_16x16x32_bf16 v[164:167], v[196:199], v[104:107], v[164:167]
    ds_read_b64_tr_b16 v[196:197], v242 offset:32768
    ds_read_b64_tr_b16 v[198:199], v242 offset:36864
    v_mfma_f32_16x16x32_bf16 v[168:171], v[200:203], v[108:111], v[168:171]
    ds_read_b64_tr_b16 v[200:201], v243 offset:32768
    ds_read_b64_tr_b16 v[202:203], v243 offset:36864
    s_waitcnt lgkmcnt(12)
    v_mfma_f32_16x16x32_bf16 v[172:175], v[204:207], v[108:111], v[172:175]
    ds_read_b64_tr_b16 v[204:205], v244 offset:32768
    ds_read_b64_tr_b16 v[206:207], v244 offset:36864
    v_mfma_f32_16x16x32_bf16 v[176:179], v[208:211], v[108:111], v[176:179]
    ds_read_b64_tr_b16 v[208:209], v240 offset:40960
    ds_read_b64_tr_b16 v[210:211], v240 offset:45056
    s_waitcnt lgkmcnt(12)
    v_mfma_f32_16x16x32_bf16 v[180:183], v[212:215], v[108:111], v[180:183]
    ds_read_b64_tr_b16 v[212:213], v241 offset:40960
    ds_read_b64_tr_b16 v[214:215], v241 offset:45056
    v_mfma_f32_16x16x32_bf16 v[184:187], v[216:219], v[108:111], v[184:187]
    ds_read_b64_tr_b16 v[216:217], v242 offset:40960
    ds_read_b64_tr_b16 v[218:219], v242 offset:45056
    s_waitcnt lgkmcnt(12)
    v_mfma_f32_16x16x32_bf16 v[128:131], v[188:191], v[108:111], v[128:131]
    ds_read_b64_tr_b16 v[188:189], v243 offset:40960
    ds_read_b64_tr_b16 v[190:191], v243 offset:45056
    v_mfma_f32_16x16x32_bf16 v[132:135], v[192:195], v[108:111], v[132:135]
    ds_read_b64_tr_b16 v[192:193], v244 offset:40960
    ds_read_b64_tr_b16 v[194:195], v244 offset:45056
    s_waitcnt lgkmcnt(12)
    v_mfma_f32_16x16x32_bf16 v[136:139], v[196:199], v[108:111], v[136:139]
    s_barrier
    ds_read_b64_tr_b16 v[196:197], v240 offset:49152
    ds_read_b64_tr_b16 v[198:199], v240 offset:53248
    v_mfma_f32_16x16x32_bf16 v[140:143], v[200:203], v[108:111], v[140:143]
    ds_read_b64_tr_b16 v[200:201], v241 offset:49152
    ds_read_b64_tr_b16 v[202:203], v241 offset:53248
    s_waitcnt lgkmcnt(12)
    v_mfma_f32_16x16x32_bf16 v[144:147], v[204:207], v[108:111], v[144:147]
    ds_read_b64_tr_b16 v[204:205], v242 offset:49152
    ds_read_b64_tr_b16 v[206:207], v242 offset:53248
    v_mfma_f32_16x16x32_bf16 v[148:151], v[208:211], v[108:111], v[148:151]
    ds_read_b64_tr_b16 v[208:209], v243 offset:49152
    ds_read_b64_tr_b16 v[210:211], v243 offset:53248
    s_waitcnt lgkmcnt(12)
    v_mfma_f32_16x16x32_bf16 v[152:155], v[212:215], v[108:111], v[152:155]
    ds_read_b64_tr_b16 v[212:213], v244 offset:49152
    ds_read_b64_tr_b16 v[214:215], v244 offset:53248
    v_mfma_f32_16x16x32_bf16 v[156:159], v[216:219], v[108:111], v[156:159]
    ds_read_b64_tr_b16 v[216:217], v240 offset:57344
    ds_read_b64_tr_b16 v[218:219], v240 offset:61440
    s_waitcnt lgkmcnt(12)
    v_mfma_f32_16x16x32_bf16 v[160:163], v[188:191], v[108:111], v[160:163]
    ds_read_b64_tr_b16 v[188:189], v241 offset:57344
    ds_read_b64_tr_b16 v[190:191], v241 offset:61440
    v_mfma_f32_16x16x32_bf16 v[164:167], v[192:195], v[108:111], v[164:167]
    ds_read_b64_tr_b16 v[192:193], v242 offset:57344
    ds_read_b64_tr_b16 v[194:195], v242 offset:61440
    s_waitcnt lgkmcnt(12)
    v_mfma_f32_16x16x32_bf16 v[168:171], v[196:199], v[112:115], v[168:171]
    ds_read_b64_tr_b16 v[196:197], v243 offset:57344
    ds_read_b64_tr_b16 v[198:199], v243 offset:61440
    v_mfma_f32_16x16x32_bf16 v[172:175], v[200:203], v[112:115], v[172:175]
    ds_read_b64_tr_b16 v[200:201], v244 offset:57344
    ds_read_b64_tr_b16 v[202:203], v244 offset:61440
    s_waitcnt lgkmcnt(12)
    v_mfma_f32_16x16x32_bf16 v[176:179], v[204:207], v[112:115], v[176:179]
    ds_read_b64_tr_b16 v[204:205], v245 offset:0
    ds_read_b64_tr_b16 v[206:207], v245 offset:4096
    v_mfma_f32_16x16x32_bf16 v[180:183], v[208:211], v[112:115], v[180:183]
    ds_read_b64_tr_b16 v[208:209], v246 offset:0
    ds_read_b64_tr_b16 v[210:211], v246 offset:4096
    s_waitcnt lgkmcnt(12)
    v_mfma_f32_16x16x32_bf16 v[184:187], v[212:215], v[112:115], v[184:187]
    ds_read_b64_tr_b16 v[212:213], v247 offset:0
    ds_read_b64_tr_b16 v[214:215], v247 offset:4096
    v_mfma_f32_16x16x32_bf16 v[128:131], v[216:219], v[112:115], v[128:131]
    ds_read_b64_tr_b16 v[216:217], v248 offset:0
    ds_read_b64_tr_b16 v[218:219], v248 offset:4096
    s_waitcnt lgkmcnt(12)
    v_mfma_f32_16x16x32_bf16 v[132:135], v[188:191], v[112:115], v[132:135]
    ds_read_b64_tr_b16 v[188:189], v249 offset:0
    ds_read_b64_tr_b16 v[190:191], v249 offset:4096
    v_mfma_f32_16x16x32_bf16 v[136:139], v[192:195], v[112:115], v[136:139]
    s_barrier
    ds_read_b64_tr_b16 v[192:193], v245 offset:8192
    ds_read_b64_tr_b16 v[194:195], v245 offset:12288
    s_waitcnt lgkmcnt(12)
    v_mfma_f32_16x16x32_bf16 v[140:143], v[196:199], v[112:115], v[140:143]
    ds_read_b64_tr_b16 v[196:197], v246 offset:8192
    ds_read_b64_tr_b16 v[198:199], v246 offset:12288
    v_mfma_f32_16x16x32_bf16 v[144:147], v[200:203], v[112:115], v[144:147]
    ds_read_b64_tr_b16 v[200:201], v247 offset:8192
    ds_read_b64_tr_b16 v[202:203], v247 offset:12288
    s_waitcnt lgkmcnt(12)
    v_mfma_f32_16x16x32_bf16 v[148:151], v[204:207], v[112:115], v[148:151]
    ds_read_b64_tr_b16 v[204:205], v248 offset:8192
    ds_read_b64_tr_b16 v[206:207], v248 offset:12288
    v_mfma_f32_16x16x32_bf16 v[152:155], v[208:211], v[112:115], v[152:155]
    ds_read_b64_tr_b16 v[208:209], v249 offset:8192
    ds_read_b64_tr_b16 v[210:211], v249 offset:12288
    s_waitcnt lgkmcnt(12)
    v_mfma_f32_16x16x32_bf16 v[156:159], v[212:215], v[112:115], v[156:159]
    ds_read_b64_tr_b16 v[212:213], v245 offset:16384
    ds_read_b64_tr_b16 v[214:215], v245 offset:20480
    v_mfma_f32_16x16x32_bf16 v[160:163], v[216:219], v[112:115], v[160:163]
    ds_read_b64_tr_b16 v[216:217], v246 offset:16384
    ds_read_b64_tr_b16 v[218:219], v246 offset:20480
    s_waitcnt lgkmcnt(12)
    v_mfma_f32_16x16x32_bf16 v[164:167], v[188:191], v[112:115], v[164:167]
    ds_read_b64_tr_b16 v[188:189], v247 offset:16384
    ds_read_b64_tr_b16 v[190:191], v247 offset:20480
    v_mfma_f32_16x16x32_bf16 v[168:171], v[192:195], v[116:119], v[168:171]
    ds_read_b64_tr_b16 v[192:193], v248 offset:16384
    ds_read_b64_tr_b16 v[194:195], v248 offset:20480
    s_waitcnt lgkmcnt(12)
    v_mfma_f32_16x16x32_bf16 v[172:175], v[196:199], v[116:119], v[172:175]
    ds_read_b64_tr_b16 v[196:197], v249 offset:16384
    ds_read_b64_tr_b16 v[198:199], v249 offset:20480
    v_mfma_f32_16x16x32_bf16 v[176:179], v[200:203], v[116:119], v[176:179]
    ds_read_b64_tr_b16 v[200:201], v245 offset:24576
    ds_read_b64_tr_b16 v[202:203], v245 offset:28672
    s_waitcnt lgkmcnt(12)
    v_mfma_f32_16x16x32_bf16 v[180:183], v[204:207], v[116:119], v[180:183]
    ds_read_b64_tr_b16 v[204:205], v246 offset:24576
    ds_read_b64_tr_b16 v[206:207], v246 offset:28672
    v_mfma_f32_16x16x32_bf16 v[184:187], v[208:211], v[116:119], v[184:187]
    ds_read_b64_tr_b16 v[208:209], v247 offset:24576
    ds_read_b64_tr_b16 v[210:211], v247 offset:28672
    s_waitcnt lgkmcnt(12)
    v_mfma_f32_16x16x32_bf16 v[128:131], v[212:215], v[116:119], v[128:131]
    ds_read_b64_tr_b16 v[212:213], v248 offset:24576
    ds_read_b64_tr_b16 v[214:215], v248 offset:28672
    v_mfma_f32_16x16x32_bf16 v[132:135], v[216:219], v[116:119], v[132:135]
    ds_read_b64_tr_b16 v[216:217], v249 offset:24576
    ds_read_b64_tr_b16 v[218:219], v249 offset:28672
    s_waitcnt lgkmcnt(12)
    v_mfma_f32_16x16x32_bf16 v[136:139], v[188:191], v[116:119], v[136:139]
    s_barrier
    ds_read_b64_tr_b16 v[188:189], v245 offset:32768
    ds_read_b64_tr_b16 v[190:191], v245 offset:36864
    v_mfma_f32_16x16x32_bf16 v[140:143], v[192:195], v[116:119], v[140:143]
    ds_read_b64_tr_b16 v[192:193], v246 offset:32768
    ds_read_b64_tr_b16 v[194:195], v246 offset:36864
    s_waitcnt lgkmcnt(12)
    v_mfma_f32_16x16x32_bf16 v[144:147], v[196:199], v[116:119], v[144:147]
    ds_read_b64_tr_b16 v[196:197], v247 offset:32768
    ds_read_b64_tr_b16 v[198:199], v247 offset:36864
    v_mfma_f32_16x16x32_bf16 v[148:151], v[200:203], v[116:119], v[148:151]
    ds_read_b64_tr_b16 v[200:201], v248 offset:32768
    ds_read_b64_tr_b16 v[202:203], v248 offset:36864
    s_waitcnt lgkmcnt(12)
    v_mfma_f32_16x16x32_bf16 v[152:155], v[204:207], v[116:119], v[152:155]
    ds_read_b64_tr_b16 v[204:205], v249 offset:32768
    ds_read_b64_tr_b16 v[206:207], v249 offset:36864
    v_mfma_f32_16x16x32_bf16 v[156:159], v[208:211], v[116:119], v[156:159]
    ds_read_b64_tr_b16 v[208:209], v245 offset:40960
    ds_read_b64_tr_b16 v[210:211], v245 offset:45056
    s_waitcnt lgkmcnt(12)
    v_mfma_f32_16x16x32_bf16 v[160:163], v[212:215], v[116:119], v[160:163]
    ds_read_b64_tr_b16 v[212:213], v246 offset:40960
    ds_read_b64_tr_b16 v[214:215], v246 offset:45056
    v_mfma_f32_16x16x32_bf16 v[164:167], v[216:219], v[116:119], v[164:167]
    ds_read_b64_tr_b16 v[216:217], v247 offset:40960
    ds_read_b64_tr_b16 v[218:219], v247 offset:45056
    s_waitcnt lgkmcnt(12)
    v_mfma_f32_16x16x32_bf16 v[168:171], v[188:191], v[120:123], v[168:171]
    ds_read_b64_tr_b16 v[188:189], v248 offset:40960
    ds_read_b64_tr_b16 v[190:191], v248 offset:45056
    v_mfma_f32_16x16x32_bf16 v[172:175], v[192:195], v[120:123], v[172:175]
    ds_read_b64_tr_b16 v[192:193], v249 offset:40960
    ds_read_b64_tr_b16 v[194:195], v249 offset:45056
    s_waitcnt lgkmcnt(12)
    v_mfma_f32_16x16x32_bf16 v[176:179], v[196:199], v[120:123], v[176:179]
    ds_read_b64_tr_b16 v[196:197], v245 offset:49152
    ds_read_b64_tr_b16 v[198:199], v245 offset:53248
    v_mfma_f32_16x16x32_bf16 v[180:183], v[200:203], v[120:123], v[180:183]
    ds_read_b64_tr_b16 v[200:201], v246 offset:49152
    ds_read_b64_tr_b16 v[202:203], v246 offset:53248
    s_waitcnt lgkmcnt(12)
    v_mfma_f32_16x16x32_bf16 v[184:187], v[204:207], v[120:123], v[184:187]
    ds_read_b64_tr_b16 v[204:205], v247 offset:49152
    ds_read_b64_tr_b16 v[206:207], v247 offset:53248
    v_mfma_f32_16x16x32_bf16 v[128:131], v[208:211], v[120:123], v[128:131]
    ds_read_b64_tr_b16 v[208:209], v248 offset:49152
    ds_read_b64_tr_b16 v[210:211], v248 offset:53248
    s_waitcnt lgkmcnt(12)
    v_mfma_f32_16x16x32_bf16 v[132:135], v[212:215], v[120:123], v[132:135]
    ds_read_b64_tr_b16 v[212:213], v249 offset:49152
    ds_read_b64_tr_b16 v[214:215], v249 offset:53248
    v_mfma_f32_16x16x32_bf16 v[136:139], v[216:219], v[120:123], v[136:139]
    s_barrier
    ds_read_b64_tr_b16 v[216:217], v245 offset:57344
    ds_read_b64_tr_b16 v[218:219], v245 offset:61440
    s_waitcnt lgkmcnt(12)
    v_mfma_f32_16x16x32_bf16 v[140:143], v[188:191], v[120:123], v[140:143]
    ds_read_b64_tr_b16 v[188:189], v246 offset:57344
    ds_read_b64_tr_b16 v[190:191], v246 offset:61440
    v_mfma_f32_16x16x32_bf16 v[144:147], v[192:195], v[120:123], v[144:147]
    ds_read_b64_tr_b16 v[192:193], v247 offset:57344
    ds_read_b64_tr_b16 v[194:195], v247 offset:61440
    s_waitcnt lgkmcnt(12)
    v_mfma_f32_16x16x32_bf16 v[148:151], v[196:199], v[120:123], v[148:151]
    ds_read_b64_tr_b16 v[196:197], v248 offset:57344
    ds_read_b64_tr_b16 v[198:199], v248 offset:61440
    v_mfma_f32_16x16x32_bf16 v[152:155], v[200:203], v[120:123], v[152:155]
    ds_read_b64_tr_b16 v[200:201], v249 offset:57344
    ds_read_b64_tr_b16 v[202:203], v249 offset:61440
    s_waitcnt lgkmcnt(12)
    v_mfma_f32_16x16x32_bf16 v[156:159], v[204:207], v[120:123], v[156:159]
    ds_read_b64_tr_b16 v[204:205], v250 offset:0
    ds_read_b64_tr_b16 v[206:207], v250 offset:4096
    v_mfma_f32_16x16x32_bf16 v[160:163], v[208:211], v[120:123], v[160:163]
    ds_read_b64_tr_b16 v[208:209], v251 offset:0
    ds_read_b64_tr_b16 v[210:211], v251 offset:4096
    s_waitcnt lgkmcnt(12)
    v_mfma_f32_16x16x32_bf16 v[164:167], v[212:215], v[120:123], v[164:167]
    ds_read_b64_tr_b16 v[212:213], v252 offset:0
    ds_read_b64_tr_b16 v[214:215], v252 offset:4096
    v_mfma_f32_16x16x32_bf16 v[168:171], v[216:219], v[124:127], v[168:171]
    ds_read_b64_tr_b16 v[216:217], v253 offset:0
    ds_read_b64_tr_b16 v[218:219], v253 offset:4096
    s_waitcnt lgkmcnt(12)
    v_mfma_f32_16x16x32_bf16 v[172:175], v[188:191], v[124:127], v[172:175]
    ds_read_b64_tr_b16 v[188:189], v254 offset:0
    ds_read_b64_tr_b16 v[190:191], v254 offset:4096
    v_mfma_f32_16x16x32_bf16 v[176:179], v[192:195], v[124:127], v[176:179]
    ds_read_b64_tr_b16 v[192:193], v250 offset:8192
    ds_read_b64_tr_b16 v[194:195], v250 offset:12288
    s_waitcnt lgkmcnt(12)
    v_mfma_f32_16x16x32_bf16 v[180:183], v[196:199], v[124:127], v[180:183]
    ds_read_b64_tr_b16 v[196:197], v251 offset:8192
    ds_read_b64_tr_b16 v[198:199], v251 offset:12288
    v_mfma_f32_16x16x32_bf16 v[184:187], v[200:203], v[124:127], v[184:187]
    ds_read_b64_tr_b16 v[200:201], v252 offset:8192
    ds_read_b64_tr_b16 v[202:203], v252 offset:12288
    s_waitcnt lgkmcnt(12)
    v_mfma_f32_16x16x32_bf16 v[128:131], v[204:207], v[124:127], v[128:131]
    ds_read_b64_tr_b16 v[204:205], v253 offset:8192
    ds_read_b64_tr_b16 v[206:207], v253 offset:12288
    v_mfma_f32_16x16x32_bf16 v[132:135], v[208:211], v[124:127], v[132:135]
    ds_read_b64_tr_b16 v[208:209], v254 offset:8192
    ds_read_b64_tr_b16 v[210:211], v254 offset:12288
    s_waitcnt lgkmcnt(12)
    v_mfma_f32_16x16x32_bf16 v[136:139], v[212:215], v[124:127], v[136:139]
    v_mfma_f32_16x16x32_bf16 v[140:143], v[216:219], v[124:127], v[140:143]
    s_waitcnt lgkmcnt(8)
    v_mfma_f32_16x16x32_bf16 v[144:147], v[188:191], v[124:127], v[144:147]
    v_mfma_f32_16x16x32_bf16 v[148:151], v[192:195], v[124:127], v[148:151]
    s_waitcnt lgkmcnt(4)
    v_mfma_f32_16x16x32_bf16 v[152:155], v[196:199], v[124:127], v[152:155]
    v_mfma_f32_16x16x32_bf16 v[156:159], v[200:203], v[124:127], v[156:159]
    s_waitcnt lgkmcnt(0)
    v_mfma_f32_16x16x32_bf16 v[160:163], v[204:207], v[124:127], v[160:163]
    v_mfma_f32_16x16x32_bf16 v[164:167], v[208:211], v[124:127], v[164:167]
    ds_read_b64_tr_b16 v[56:57], v8 offset:0
    ds_read_b64_tr_b16 v[58:59], v8 offset:160
    ds_read_b64_tr_b16 v[60:61], v8 offset:320
    ds_read_b64_tr_b16 v[62:63], v8 offset:480
    ds_read_b64_tr_b16 v[64:65], v8 offset:640
    ds_read_b64_tr_b16 v[66:67], v8 offset:8
    ds_read_b64_tr_b16 v[68:69], v8 offset:168
    ds_read_b64_tr_b16 v[70:71], v8 offset:328
    ds_read_b64_tr_b16 v[72:73], v8 offset:488
    ds_read_b64_tr_b16 v[74:75], v8 offset:648
    ds_read_b64_tr_b16 v[76:77], v8 offset:16
    ds_read_b64_tr_b16 v[78:79], v8 offset:176
    ds_read_b64_tr_b16 v[80:81], v8 offset:336
    ds_read_b64_tr_b16 v[82:83], v8 offset:496
    ds_read_b64_tr_b16 v[84:85], v8 offset:656
    ds_read_b64_tr_b16 v[86:87], v8 offset:24
    ds_read_b64_tr_b16 v[88:89], v8 offset:184
    ds_read_b64_tr_b16 v[90:91], v8 offset:344
    ds_read_b64_tr_b16 v[92:93], v8 offset:504
    ds_read_b64_tr_b16 v[94:95], v8 offset:664
    ds_read_b64_tr_b16 v[96:97], v8 offset:32
    ds_read_b64_tr_b16 v[98:99], v8 offset:192
    ds_read_b64_tr_b16 v[100:101], v8 offset:352
    ds_read_b64_tr_b16 v[102:103], v8 offset:512
    ds_read_b64_tr_b16 v[104:105], v8 offset:672
    v_cvt_pk_bf16_f32 v208, v168, v169
    v_cvt_pk_bf16_f32 v209, v170, v171
    v_cvt_pk_bf16_f32 v210, v172, v173
    v_cvt_pk_bf16_f32 v211, v174, v175
    v_cvt_pk_bf16_f32 v212, v176, v177
    v_cvt_pk_bf16_f32 v213, v178, v179
    v_cvt_pk_bf16_f32 v214, v180, v181
    v_cvt_pk_bf16_f32 v215, v182, v183
    v_cvt_pk_bf16_f32 v216, v184, v185
    v_cvt_pk_bf16_f32 v217, v186, v187
    ds_write_b128 v50, v[208:211]
    ds_write_b128 v50, v[212:215] offset:1024
    ds_write_b64 v51, v[216:217] offset:2048
    v_cvt_pk_bf16_f32 v168, v128, v129
    v_cvt_pk_bf16_f32 v169, v130, v131
    v_cvt_pk_bf16_f32 v170, v132, v133
    v_cvt_pk_bf16_f32 v171, v134, v135
    v_cvt_pk_bf16_f32 v172, v136, v137
    v_cvt_pk_bf16_f32 v173, v138, v139
    v_cvt_pk_bf16_f32 v174, v140, v141
    v_cvt_pk_bf16_f32 v175, v142, v143
    v_cvt_pk_bf16_f32 v176, v144, v145
    v_cvt_pk_bf16_f32 v177, v146, v147
    s_waitcnt lgkmcnt(0)
    v_mfma_f32_16x16x32_bf16 v[108:111], v[56:59], v[168:171], 0
    v_mfma_f32_16x16x32_bf16 v[112:115], v[66:69], v[168:171], 0
    v_mfma_f32_16x16x32_bf16 v[116:119], v[76:79], v[168:171], 0
    v_mfma_f32_16x16x32_bf16 v[120:123], v[86:89], v[168:171], 0
    v_mfma_f32_16x16x32_bf16 v[124:127], v[96:99], v[168:171], 0
    v_mfma_f32_16x16x32_bf16 v[108:111], v[60:63], v[172:175], v[108:111]
    v_mfma_f32_16x16x32_bf16 v[112:115], v[70:73], v[172:175], v[112:115]
    v_mfma_f32_16x16x32_bf16 v[116:119], v[80:83], v[172:175], v[116:119]
    v_mfma_f32_16x16x32_bf16 v[120:123], v[90:93], v[172:175], v[120:123]
    v_mfma_f32_16x16x32_bf16 v[124:127], v[100:103], v[172:175], v[124:127]
    v_mfma_f32_16x16x16_bf16 v[108:111], v[64:65], v[176:177], v[108:111]
    v_mfma_f32_16x16x16_bf16 v[112:115], v[74:75], v[176:177], v[112:115]
    v_mfma_f32_16x16x16_bf16 v[116:119], v[84:85], v[176:177], v[116:119]
    v_mfma_f32_16x16x16_bf16 v[120:123], v[94:95], v[176:177], v[120:123]
    v_mfma_f32_16x16x16_bf16 v[124:127], v[104:105], v[176:177], v[124:127]
    ds_write_b32 v4, v12
    v_cvt_pk_bf16_f32 v34, v148, v149
    v_cvt_pk_bf16_f32 v35, v150, v151
    v_cvt_pk_bf16_f32 v36, v152, v153
    v_cvt_pk_bf16_f32 v37, v154, v155
    v_cvt_pk_bf16_f32 v38, v156, v157
    v_cvt_pk_bf16_f32 v39, v158, v159
    v_cvt_pk_bf16_f32 v40, v160, v161
    v_cvt_pk_bf16_f32 v41, v162, v163
    v_cvt_pk_bf16_f32 v42, v164, v165
    v_cvt_pk_bf16_f32 v43, v166, v167
    ds_write_b128 v9, v[36:39] offset:80
    ds_write_b128 v9, v[40:43] offset:96
    ds_write_b128 v9, v[44:47] offset:112
    v_max3_f32 v220, v108, v109, v110
    v_min3_f32 v222, v108, v109, v110
    v_max3_f32 v220, v220, v111, v112
    v_min3_f32 v222, v222, v111, v112
    v_max3_f32 v220, v220, v113, v114
    v_min3_f32 v222, v222, v113, v114
    v_max3_f32 v220, v220, v115, v116
    v_min3_f32 v222, v222, v115, v116
    v_max3_f32 v220, v220, v117, v118
    v_min3_f32 v222, v222, v117, v118
    v_max3_f32 v220, v220, v119, v120
    v_min3_f32 v222, v222, v119, v120
    v_max3_f32 v220, v220, v121, v122
    v_min3_f32 v222, v222, v121, v122
    v_max3_f32 v220, v220, v123, v124
    v_min3_f32 v222, v222, v123, v124
    v_max_f32 v220, v220, v125
    v_min_f32 v222, v222, v125
    v_mov_b32 v224, 1069066811
    v_mov_b32 v225, 1069066811
    v_mov_b32 v226, 3216550459
    v_mov_b32 v227, 3216550459
    v_mul_f32 v220, v220, v226
    v_mul_f32 v222, v222, v224
    v_mov_b32 v221, v220
    v_mov_b32 v223, v222
    v_pk_fma_f32 v[56:57], v[108:109], v[224:225], v[220:221]
    v_pk_fma_f32 v[74:75], v[108:109], v[226:227], v[222:223]
    v_pk_fma_f32 v[58:59], v[110:111], v[224:225], v[220:221]
    v_pk_fma_f32 v[76:77], v[110:111], v[226:227], v[222:223]
    v_pk_fma_f32 v[60:61], v[112:113], v[224:225], v[220:221]
    v_pk_fma_f32 v[78:79], v[112:113], v[226:227], v[222:223]
    v_pk_fma_f32 v[62:63], v[114:115], v[224:225], v[220:221]
    v_pk_fma_f32 v[80:81], v[114:115], v[226:227], v[222:223]
    v_pk_fma_f32 v[64:65], v[116:117], v[224:225], v[220:221]
    v_pk_fma_f32 v[82:83], v[116:117], v[226:227], v[222:223]
    v_pk_fma_f32 v[66:67], v[118:119], v[224:225], v[220:221]
    v_pk_fma_f32 v[84:85], v[118:119], v[226:227], v[222:223]
    v_pk_fma_f32 v[68:69], v[120:121], v[224:225], v[220:221]
    v_pk_fma_f32 v[86:87], v[120:121], v[226:227], v[222:223]
    v_pk_fma_f32 v[70:71], v[122:123], v[224:225], v[220:221]
    v_pk_fma_f32 v[88:89], v[122:123], v[226:227], v[222:223]
    v_pk_fma_f32 v[72:73], v[124:125], v[224:225], v[220:221]
    v_pk_fma_f32 v[90:91], v[124:125], v[226:227], v[222:223]
    v_exp_f32 v56, v56
    v_exp_f32 v57, v57
    v_exp_f32 v58, v58
    v_exp_f32 v59, v59
    v_exp_f32 v60, v60
    v_exp_f32 v61, v61
    v_exp_f32 v62, v62
    v_exp_f32 v63, v63
    v_exp_f32 v64, v64
    v_exp_f32 v65, v65
    v_exp_f32 v66, v66
    v_exp_f32 v67, v67
    v_exp_f32 v68, v68
    v_exp_f32 v69, v69
    v_exp_f32 v70, v70
    v_exp_f32 v71, v71
    v_exp_f32 v72, v72
    v_exp_f32 v73, v73
    v_exp_f32 v74, v74
    v_exp_f32 v75, v75
    v_exp_f32 v76, v76
    v_exp_f32 v77, v77
    v_exp_f32 v78, v78
    v_exp_f32 v79, v79
    v_exp_f32 v80, v80
    v_exp_f32 v81, v81
    v_exp_f32 v82, v82
    v_exp_f32 v83, v83
    v_exp_f32 v84, v84
    v_exp_f32 v85, v85
    v_exp_f32 v86, v86
    v_exp_f32 v87, v87
    v_exp_f32 v88, v88
    v_exp_f32 v89, v89
    v_exp_f32 v90, v90
    v_exp_f32 v91, v91
    v_pk_add_f32 v[220:221], v[56:57], v[58:59]
    v_pk_add_f32 v[222:223], v[74:75], v[76:77]
    v_pk_add_f32 v[220:221], v[220:221], v[60:61]
    v_pk_add_f32 v[222:223], v[222:223], v[78:79]
    v_pk_add_f32 v[220:221], v[220:221], v[62:63]
    v_pk_add_f32 v[222:223], v[222:223], v[80:81]
    v_pk_add_f32 v[220:221], v[220:221], v[64:65]
    v_pk_add_f32 v[222:223], v[222:223], v[82:83]
    v_pk_add_f32 v[220:221], v[220:221], v[66:67]
    v_pk_add_f32 v[222:223], v[222:223], v[84:85]
    v_pk_add_f32 v[220:221], v[220:221], v[68:69]
    v_pk_add_f32 v[222:223], v[222:223], v[86:87]
    v_pk_add_f32 v[220:221], v[220:221], v[70:71]
    v_pk_add_f32 v[222:223], v[222:223], v[88:89]
    v_pk_add_f32 v[220:221], v[220:221], v[72:73]
    v_pk_add_f32 v[222:223], v[222:223], v[90:91]
    v_add_f32 v220, v220, v221
    v_add_f32 v222, v222, v223
    v_rcp_f32 v220, v220
    v_rcp_f32 v222, v222
    s_nop 0
    v_mov_b32 v221, v220
    v_mov_b32 v223, v222
    v_pk_mul_f32 v[56:57], v[56:57], v[220:221]
    v_pk_mul_f32 v[74:75], v[74:75], v[222:223]
    v_pk_mul_f32 v[58:59], v[58:59], v[220:221]
    v_pk_mul_f32 v[76:77], v[76:77], v[222:223]
    v_pk_mul_f32 v[60:61], v[60:61], v[220:221]
    v_pk_mul_f32 v[78:79], v[78:79], v[222:223]
    v_pk_mul_f32 v[62:63], v[62:63], v[220:221]
    v_pk_mul_f32 v[80:81], v[80:81], v[222:223]
    v_pk_mul_f32 v[64:65], v[64:65], v[220:221]
    v_pk_mul_f32 v[82:83], v[82:83], v[222:223]
    v_pk_mul_f32 v[66:67], v[66:67], v[220:221]
    v_pk_mul_f32 v[84:85], v[84:85], v[222:223]
    v_pk_mul_f32 v[68:69], v[68:69], v[220:221]
    v_pk_mul_f32 v[86:87], v[86:87], v[222:223]
    v_pk_mul_f32 v[70:71], v[70:71], v[220:221]
    v_pk_mul_f32 v[88:89], v[88:89], v[222:223]
    v_pk_mul_f32 v[72:73], v[72:73], v[220:221]
    v_pk_mul_f32 v[90:91], v[90:91], v[222:223]
    v_cvt_pk_bf16_f32 v16, v56, v57
    v_cvt_pk_bf16_f32 v17, v58, v59
    v_cvt_pk_bf16_f32 v18, v60, v61
    v_cvt_pk_bf16_f32 v19, v62, v63
    v_cvt_pk_bf16_f32 v20, v64, v65
    v_cvt_pk_bf16_f32 v21, v66, v67
    v_cvt_pk_bf16_f32 v22, v68, v69
    v_cvt_pk_bf16_f32 v23, v70, v71
    v_cvt_pk_bf16_f32 v24, v72, v73
    v_cvt_pk_bf16_f32 v25, v74, v75
    v_cvt_pk_bf16_f32 v26, v76, v77
    v_cvt_pk_bf16_f32 v27, v78, v79
    v_cvt_pk_bf16_f32 v28, v80, v81
    v_cvt_pk_bf16_f32 v29, v82, v83
    v_cvt_pk_bf16_f32 v30, v84, v85
    v_cvt_pk_bf16_f32 v31, v86, v87
    v_cvt_pk_bf16_f32 v32, v88, v89
    v_cvt_pk_bf16_f32 v33, v90, v91
    ds_write_b128 v9, v[16:19] offset:0
    ds_write_b128 v9, v[20:23] offset:16
    ds_write_b128 v9, v[24:27] offset:32
    ds_write_b128 v9, v[28:31] offset:48
    ds_write_b128 v9, v[32:35] offset:64
    s_waitcnt lgkmcnt(0)
    s_mov_b64 exec, 1
    ds_add_u32 v11, v12
sequential_preLN__linear_kernel_hedgehog__mixer_token_mlp__prompt_kernel_sb:
    ds_read_b32 v232, v11
    s_waitcnt lgkmcnt(0)
    v_readfirstlane_b32 s46, v232
    s_cmp_lt_u32 s46, 4
    s_cbranch_scc1 sequential_preLN__linear_kernel_hedgehog__mixer_token_mlp__prompt_kernel_sb
    s_mov_b64 exec, -1
    ds_read_b64_tr_b16 v[56:57], v10 offset:0
    ds_read_b64_tr_b16 v[58:59], v10 offset:8704
    ds_read_b64_tr_b16 v[60:61], v10 offset:32
    ds_read_b64_tr_b16 v[62:63], v10 offset:8736
    ds_read_b64_tr_b16 v[64:65], v10 offset:64
    ds_read_b64_tr_b16 v[66:67], v10 offset:8768
    ds_read_b64_tr_b16 v[68:69], v10 offset:72
    ds_read_b64_tr_b16 v[70:71], v10 offset:8776
    ds_read_b64_tr_b16 v[72:73], v10 offset:104
    ds_read_b64_tr_b16 v[74:75], v10 offset:8808
    ds_read_b64_tr_b16 v[76:77], v10 offset:17408
    ds_read_b64_tr_b16 v[78:79], v10 offset:26112
    ds_read_b64_tr_b16 v[80:81], v10 offset:17440
    ds_read_b64_tr_b16 v[82:83], v10 offset:26144
    ds_read_b64_tr_b16 v[84:85], v10 offset:17472
    ds_read_b64_tr_b16 v[86:87], v10 offset:26176
    ds_read_b64_tr_b16 v[88:89], v10 offset:17480
    ds_read_b64_tr_b16 v[90:91], v10 offset:26184
    ds_read_b64_tr_b16 v[92:93], v10 offset:17512
    ds_read_b64_tr_b16 v[94:95], v10 offset:26216
    s_waitcnt lgkmcnt(10)
    v_mfma_f32_16x16x32_bf16 v[128:131], v[56:59], v[68:71], 0
    v_mfma_f32_16x16x32_bf16 v[132:135], v[56:59], v[72:75], 0
    v_mfma_f32_16x16x32_bf16 v[136:139], v[60:63], v[68:71], 0
    v_mfma_f32_16x16x32_bf16 v[140:143], v[60:63], v[72:75], 0
    v_mfma_f32_16x16x32_bf16 v[144:147], v[64:67], v[68:71], 0
    v_mfma_f32_16x16x32_bf16 v[148:151], v[64:67], v[72:75], 0
    s_waitcnt lgkmcnt(0)
    v_mfma_f32_16x16x32_bf16 v[128:131], v[76:79], v[88:91], v[128:131]
    v_mfma_f32_16x16x32_bf16 v[132:135], v[76:79], v[92:95], v[132:135]
    v_mfma_f32_16x16x32_bf16 v[136:139], v[80:83], v[88:91], v[136:139]
    v_mfma_f32_16x16x32_bf16 v[140:143], v[80:83], v[92:95], v[140:143]
    v_mfma_f32_16x16x32_bf16 v[144:147], v[84:87], v[88:91], v[144:147]
    v_mfma_f32_16x16x32_bf16 v[148:151], v[84:87], v[92:95], v[148:151]
    s_nop 3
    v_cvt_pk_bf16_f32 v188, v128, v129
    v_cvt_pk_bf16_f32 v189, v130, v131
    buffer_store_dwordx2 v[188:189], v13, s[28:31], s52 offen sc1
    v_cvt_pk_bf16_f32 v190, v132, v133
    v_cvt_pk_bf16_f32 v191, v134, v135
    buffer_store_dwordx2 v[190:191], v14, s[28:31], s52 offen sc1
    v_cvt_pk_bf16_f32 v192, v136, v137
    v_cvt_pk_bf16_f32 v193, v138, v139
    buffer_store_dwordx2 v[192:193], v13, s[28:31], s53 offen sc1
    v_cvt_pk_bf16_f32 v194, v140, v141
    v_cvt_pk_bf16_f32 v195, v142, v143
    buffer_store_dwordx2 v[194:195], v14, s[28:31], s53 offen sc1
    s_mov_b64 exec, 0xffff
    v_cvt_pk_bf16_f32 v196, v144, v145
    v_cvt_pk_bf16_f32 v197, v146, v147
    buffer_store_dwordx2 v[196:197], v13, s[28:31], s54 offen sc1
    v_cvt_pk_bf16_f32 v198, v148, v149
    v_cvt_pk_bf16_f32 v199, v150, v151
    buffer_store_dwordx2 v[198:199], v14, s[28:31], s54 offen sc1
    s_mov_b64 exec, -1
    s_waitcnt vmcnt(0)
sequential_preLN__linear_kernel_hedgehog__mixer_token_mlp__prompt_kernel_npa:
    v_cmp_ne_u32 vcc, 0, v49
    s_cbranch_vccnz sequential_preLN__linear_kernel_hedgehog__mixer_token_mlp__prompt_kernel_oka
    buffer_load_dword v49, v48, s[24:27], 0 offen sc1
    s_waitcnt vmcnt(0)
    s_branch sequential_preLN__linear_kernel_hedgehog__mixer_token_mlp__prompt_kernel_npa
sequential_preLN__linear_kernel_hedgehog__mixer_token_mlp__prompt_kernel_oka:
    s_mov_b64 exec, 1
    ds_add_rtn_u32 v52, v5, v12
    s_waitcnt lgkmcnt(0)
    v_readfirstlane_b32 s47, v52
    s_cmp_lg_u32 s47, 3
    s_cbranch_scc1 sequential_preLN__linear_kernel_hedgehog__mixer_token_mlp__prompt_kernel_nfa
    s_mov_b64 exec, 0xff
    buffer_store_dword v49, v15, s[32:35], s55 offen sc1
sequential_preLN__linear_kernel_hedgehog__mixer_token_mlp__prompt_kernel_nfa:
    s_mov_b64 exec, -1
    s_mov_b64 exec, -1
    s_branch k2_phase
sequential_preLN__linear_kernel_hedgehog__mixer_token_mlp__prompt_kernel_end:
    s_endpgm
k2_phase:
    s_load_dwordx2 s[90:91], s[0:1], 80
    v_lshrrev_b32 v1, 6, v0
    v_and_b32 v2, 63, v0
    s_load_dwordx2 s[8:9], s[0:1], 88
    v_readfirstlane_b32 s12, v1
    s_and_b32 s3, s2, 7
    s_lshr_b32 s10, s2, 3
    s_cmp_ge_u32 s2, 192
    s_cbranch_scc1 k2_phase_extra
    s_load_dwordx2 s[4:5], s[0:1], 0
    s_load_dwordx2 s[6:7], s[0:1], 24
    s_mul_i32 s14, s10, 43691
    s_lshr_b32 s14, s14, 17
    s_mul_i32 s13, s14, 3
    s_sub_u32 s13, s10, s13
    s_lshl_b32 s3, s3, 3
    s_add_u32 s14, s14, s3
    v_lshrrev_b32 v1, 4, v2
    v_and_b32 v3, 15, v2
    s_mov_b32 s45, 0xffff0000
    s_and_b32 s58, s12, 3
    s_lshr_b32 s59, s12, 2
    v_lshlrev_b32 v4, 4, v2
    v_lshlrev_b32 v5, 3, v2
    s_lshl_b32 s46, s14, 4
    s_add_u32 s46, s46, s12
    s_mul_i32 s46, s46, 4608
    s_waitcnt lgkmcnt(0)
    s_mov_b32 s16, s4
    s_mov_b32 s17, s5
    s_mov_b32 s18, 2359296
    s_mov_b32 s19, 0x00020000
    s_sub_u32 s20, s6, 4096
    s_subb_u32 s21, s7, 0
    s_mov_b32 s22, 667648
    s_mov_b32 s23, 0x00020000
    s_add_u32 s28, s8, 65536000
    s_addc_u32 s29, s9, 0
    s_mov_b32 s30, 51200
    s_mov_b32 s31, 0x00020000
    s_add_u32 s32, s8, 12582912
    s_addc_u32 s33, s9, 0
    s_mov_b32 s34, 2359296
    s_mov_b32 s35, 0x00020000
    s_add_u32 s36, s8, 66060288
    s_addc_u32 s37, s9, 0
    s_mov_b32 s38, 65536
    s_mov_b32 s39, 0x00020000
    s_mov_b32 s40, s8
    s_mov_b32 s41, s9
    s_mov_b32 s42, 2359296
    s_mov_b32 s43, 0x00020000
    v_add_u32 v216, 0, v2
    v_mul_u32_u24 v217, 2731, v216
    v_lshrrev_b32 v217, 16, v217
    v_mul_u32_u24 v218, 24, v217
    v_sub_u32 v218, v216, v218
    v_and_b32 v219, 6, v217
    v_xor_b32 v218, v218, v219
    v_lshlrev_b32 v218, 4, v218
    v_add_u32 v218, 4096, v218
    v_lshrrev_b32 v219, 2, v217
    v_mul_u32_u24 v219, 18, v219
    v_and_b32 v220, 3, v217
    v_add_u32 v219, v219, v220
    v_mul_u32_u24 v219, 1152, v219
    v_add_u32 v8, v219, v218
    v_add_u32 v216, 64, v2
    v_mul_u32_u24 v217, 2731, v216
    v_lshrrev_b32 v217, 16, v217
    v_mul_u32_u24 v218, 24, v217
    v_sub_u32 v218, v216, v218
    v_and_b32 v219, 6, v217
    v_xor_b32 v218, v218, v219
    v_lshlrev_b32 v218, 4, v218
    v_add_u32 v218, 3072, v218
    v_lshrrev_b32 v219, 2, v217
    v_mul_u32_u24 v219, 18, v219
    v_and_b32 v220, 3, v217
    v_add_u32 v219, v219, v220
    v_mul_u32_u24 v219, 1152, v219
    v_add_u32 v9, v219, v218
    v_add_u32 v216, 128, v2
    v_mul_u32_u24 v217, 2731, v216
    v_lshrrev_b32 v217, 16, v217
    v_mul_u32_u24 v218, 24, v217
    v_sub_u32 v218, v216, v218
    v_and_b32 v219, 6, v217
    v_xor_b32 v218, v218, v219
    v_lshlrev_b32 v218, 4, v218
    v_add_u32 v218, 2048, v218
    v_lshrrev_b32 v219, 2, v217
    v_mul_u32_u24 v219, 18, v219
    v_and_b32 v220, 3, v217
    v_add_u32 v219, v219, v220
    v_mul_u32_u24 v219, 1152, v219
    v_add_u32 v10, v219, v218
    s_lshl_b32 s47, s12, 6
    v_add_u32 v216, s47, v2
    v_mul_u32_u24 v217, 2731, v216
    v_lshrrev_b32 v217, 16, v217
    v_mul_u32_u24 v218, 24, v217
    v_sub_u32 v218, v216, v218
    v_and_b32 v219, 6, v217
    v_xor_b32 v218, v218, v219
    v_lshlrev_b32 v218, 4, v218
    v_add_u32 v218, 4096, v218
    v_lshrrev_b32 v219, 1, v217
    v_mul_u32_u24 v219, 18, v219
    v_and_b32 v220, 1, v217
    v_add3_u32 v219, v219, v220, 16
    v_mul_u32_u24 v219, 1152, v219
    v_add_u32 v11, v219, v218
    s_and_b32 s47, s58, 1
    s_mul_i32 s47, s47, 36
    s_lshr_b32 s48, s58, 1
    s_lshl_b32 s48, s48, 2
    s_add_u32 s47, s47, s48
    s_lshl_b32 s48, s59, 3
    s_add_u32 s47, s47, s48
    s_mul_i32 s47, s47, 1152
    s_mul_i32 s51, s13, 384
    s_add_u32 s50, s47, s51
    s_mul_i32 s52, s12, 3072
    s_lshl_b32 s53, s12, 10
    s_add_u32 s53, s53, 24576
    s_lshl_b32 s47, s14, 5
    s_lshl_b32 s48, s59, 4
    s_add_u32 s55, s47, s48
    v_add_u32 v14, s55, v3
    v_lshlrev_b32 v15, 5, v14
    v_add_u32 v216, 0, v2
    v_mul_u32_u24 v217, 2731, v216
    v_lshrrev_b32 v217, 16, v217
    v_mul_u32_u24 v217, 768, v217
    v_lshl_add_u32 v16, v216, 4, v217
    v_add_u32 v216, 64, v2
    v_mul_u32_u24 v217, 2731, v216
    v_lshrrev_b32 v217, 16, v217
    v_mul_u32_u24 v217, 768, v217
    v_lshl_add_u32 v17, v216, 4, v217
    v_subrev_u32 v17, 1024, v17
    v_add_u32 v216, 128, v2
    v_mul_u32_u24 v217, 2731, v216
    v_lshrrev_b32 v217, 16, v217
    v_mul_u32_u24 v217, 768, v217
    v_lshl_add_u32 v18, v216, 4, v217
    v_subrev_u32 v18, 2048, v18
    s_lshl_b32 s48, s58, 3
    s_add_u32 s47, s47, s48
    s_mul_i32 s47, s47, 1152
    s_mul_i32 s93, s13, 384
    s_add_u32 s93, s93, s47
    s_lshl_b32 s48, s59, 4
    v_add_u32 v14, s48, v3
    v_mul_u32_u24 v14, 384, v14
    v_lshl_add_u32 v14, v1, 3, v14
    s_lshl_b32 s47, s58, 5
    v_add_u32 v14, s47, v14
    s_lshl_b32 s56, s14, 1
    s_add_u32 s56, s56, s59
    s_mul_i32 s56, s56, 36
    s_mul_i32 s47, s13, 12
    s_add_u32 s56, s56, s47
    s_add_u32 s56, s56, s58
    s_lshl_b32 s56, s56, 9
    s_add_u32 s92, s56, 4096
    s_mul_i32 s57, s12, 6400
    s_add_u32 s44, s57, 110592
    v_lshlrev_b32 v6, 4, v3
    v_add_u32 v6, s44, v6
    v_pk_mov_b32 v[60:61], 0, 0
    v_pk_mov_b32 v[62:63], 0, 0
    v_pk_mov_b32 v[64:65], 0, 0
    v_pk_mov_b32 v[66:67], 0, 0
    v_pk_mov_b32 v[68:69], 0, 0
    v_pk_mov_b32 v[70:71], 0, 0
    v_pk_mov_b32 v[72:73], 0, 0
    v_pk_mov_b32 v[74:75], 0, 0
    v_pk_mov_b32 v[76:77], 0, 0
    v_pk_mov_b32 v[78:79], 0, 0
    v_pk_mov_b32 v[80:81], 0, 0
    v_pk_mov_b32 v[82:83], 0, 0
    v_pk_mov_b32 v[84:85], 0, 0
    v_pk_mov_b32 v[86:87], 0, 0
    v_pk_mov_b32 v[88:89], 0, 0
    v_pk_mov_b32 v[90:91], 0, 0
    v_pk_mov_b32 v[92:93], 0, 0
    v_pk_mov_b32 v[94:95], 0, 0
    v_pk_mov_b32 v[96:97], 0, 0
    v_pk_mov_b32 v[98:99], 0, 0
    v_pk_mov_b32 v[100:101], 0, 0
    v_pk_mov_b32 v[102:103], 0, 0
    v_pk_mov_b32 v[104:105], 0, 0
    v_pk_mov_b32 v[106:107], 0, 0
    v_pk_mov_b32 v[108:109], 0, 0
    v_pk_mov_b32 v[110:111], 0, 0
    v_pk_mov_b32 v[112:113], 0, 0
    v_pk_mov_b32 v[114:115], 0, 0
    v_pk_mov_b32 v[116:117], 0, 0
    v_pk_mov_b32 v[118:119], 0, 0
    v_pk_mov_b32 v[120:121], 0, 0
    v_pk_mov_b32 v[122:123], 0, 0
    v_pk_mov_b32 v[124:125], 0, 0
    v_pk_mov_b32 v[126:127], 0, 0
    v_pk_mov_b32 v[128:129], 0, 0
    v_pk_mov_b32 v[130:131], 0, 0
    v_pk_mov_b32 v[132:133], 0, 0
    v_pk_mov_b32 v[134:135], 0, 0
    v_pk_mov_b32 v[136:137], 0, 0
    v_pk_mov_b32 v[138:139], 0, 0
    v_pk_mov_b32 v[140:141], 0, 0
    v_pk_mov_b32 v[142:143], 0, 0
    v_pk_mov_b32 v[144:145], 0, 0
    v_pk_mov_b32 v[146:147], 0, 0
    v_pk_mov_b32 v[148:149], 0, 0
    s_mov_b32 s94, 0x00f0000f
    s_mov_b32 s95, 0xf0000f00
    v_lshrrev_b32 v216, 2, v2
    v_and_b32 v217, 6, v216
    v_lshlrev_b32 v217, 4, v217
    v_and_b32 v218, 3, v2
    v_lshl_add_u32 v217, v218, 3, v217
    v_mul_u32_u24 v219, 384, v216
    v_and_b32 v220, 1, v216
    v_lshl_add_u32 v220, v1, 1, v220
    v_and_b32 v221, 6, v220
    v_lshlrev_b32 v221, 4, v221
    v_lshl_add_u32 v221, v218, 3, v221
    v_mul_u32_u24 v220, 384, v220
    s_lshl_b32 s47, s58, 5
    v_xor_b32 v12, s47, v217
    v_add_u32 v12, v12, v219
    v_xor_b32 v13, s47, v221
    v_add_u32 v13, v13, v220
    v_add_u32 v22, 55296, v12
    v_add_u32 v23, 55296, v13
    s_barrier
    s_add_u32 m0, s52, 0
    s_add_u32 s47, s50, 0
    buffer_load_dwordx4 v8, s[20:23], s47 offen lds
    buffer_load_dwordx4 v9, s[20:23], s47 offen offset:1024 lds
    buffer_load_dwordx4 v10, s[20:23], s47 offen offset:2048 lds
    s_add_u32 m0, s53, 0
    s_add_u32 s47, s51, 0
    s_cmp_ge_u32 s12, 3
    s_cbranch_scc1 k2_phase_d_1
    buffer_load_dwordx4 v11, s[20:23], s47 offen lds
k2_phase_d_1:
    s_add_u32 m0, s52, 27648
    s_add_u32 s47, s50, 82944
    buffer_load_dwordx4 v8, s[20:23], s47 offen lds
    buffer_load_dwordx4 v9, s[20:23], s47 offen offset:1024 lds
    buffer_load_dwordx4 v10, s[20:23], s47 offen offset:2048 lds
    s_add_u32 m0, s53, 27648
    s_add_u32 s47, s51, 82944
    s_cmp_ge_u32 s12, 3
    s_cbranch_scc1 k2_phase_d_2
    buffer_load_dwordx4 v11, s[20:23], s47 offen lds
k2_phase_d_2:
    s_add_u32 m0, s52, 55296
    s_add_u32 s47, s50, 165888
    buffer_load_dwordx4 v8, s[20:23], s47 offen lds
    buffer_load_dwordx4 v9, s[20:23], s47 offen offset:1024 lds
    buffer_load_dwordx4 v10, s[20:23], s47 offen offset:2048 lds
    s_add_u32 m0, s53, 55296
    s_add_u32 s47, s51, 165888
    s_cmp_ge_u32 s12, 3
    s_cbranch_scc1 k2_phase_d_3
    buffer_load_dwordx4 v11, s[20:23], s47 offen lds
k2_phase_d_3:
    s_add_u32 m0, s52, 82944
    s_add_u32 s47, s50, 248832
    buffer_load_dwordx4 v8, s[20:23], s47 offen lds
    buffer_load_dwordx4 v9, s[20:23], s47 offen offset:1024 lds
    buffer_load_dwordx4 v10, s[20:23], s47 offen offset:2048 lds
    s_add_u32 m0, s53, 82944
    s_add_u32 s47, s51, 248832
    s_cmp_ge_u32 s12, 3
    s_cbranch_scc1 k2_phase_d_4
    buffer_load_dwordx4 v11, s[20:23], s47 offen lds
k2_phase_d_4:
    s_add_u32 s60, s8, 67239936
    s_addc_u32 s61, s9, 0
    s_mov_b32 s62, 24576
    s_mov_b32 s63, 0x00020000
    s_mov_b32 s84, s90
    s_mov_b32 s85, s91
    s_mov_b32 s86, 256
    s_mov_b32 s87, 0x00020000
    v_mov_b32 v216, 0
    v_lshlrev_b32 v217, 2, v2
    s_and_b32 s88, s2, 7
    s_lshl_b32 s88, s88, 3
    s_add_u32 s88, s88, s12
    s_lshl_b32 s88, s88, 7
    s_add_u32 s88, s88, 16384
    s_mov_b64 exec, 0xffffffff
k2_phase_f1:
    buffer_load_dword v218, v216, s[84:87], 0 offen sc1
    buffer_load_dword v219, v217, s[60:63], s88 offen sc1
    s_waitcnt vmcnt(0)
    v_cmp_ne_u32 vcc, v218, v219
    s_nop 0
    s_cbranch_vccnz k2_phase_f1s
    v_cmp_ne_u32 vcc, 0, v218
    s_cbranch_vccnz k2_phase_f1d
k2_phase_f1s:
    s_sleep 4
    s_branch k2_phase_f1
k2_phase_f1d:
    s_mov_b64 exec, -1
    s_add_u32 s24, s8, 50331648
    s_addc_u32 s25, s9, 0
    s_mov_b32 s26, 4718592
    s_mov_b32 s27, 0x00020000
    s_add_u32 s47, s46, 0
    s_add_u32 s48, s47, 4096
    buffer_load_dwordx4 v[24:27], v4, s[24:27], s47 offen offset:0 sc1
    buffer_load_dwordx4 v[28:31], v4, s[24:27], s47 offen offset:1024 sc1
    buffer_load_dwordx4 v[32:35], v4, s[24:27], s47 offen offset:2048 sc1
    buffer_load_dwordx4 v[36:39], v4, s[24:27], s47 offen offset:3072 sc1
    buffer_load_dwordx2 v[40:41], v5, s[24:27], s48 offen sc1
    s_add_u32 s47, s46, 36864
    s_add_u32 s48, s47, 4096
    buffer_load_dwordx4 v[42:45], v4, s[24:27], s47 offen offset:0 sc1
    buffer_load_dwordx4 v[46:49], v4, s[24:27], s47 offen offset:1024 sc1
    buffer_load_dwordx4 v[50:53], v4, s[24:27], s47 offen offset:2048 sc1
    buffer_load_dwordx4 v[54:57], v4, s[24:27], s47 offen offset:3072 sc1
    buffer_load_dwordx2 v[58:59], v5, s[24:27], s48 offen sc1
    s_add_u32 m0, s44, 0
    s_add_u32 s47, s57, 0
    buffer_load_dwordx4 v4, s[28:31], s47 offen offset:0 sc1 lds
    buffer_load_dwordx4 v4, s[28:31], s47 offen offset:1024 sc1 lds
    buffer_load_dwordx4 v4, s[28:31], s47 offen offset:2048 sc1 lds
    buffer_load_dwordx4 v4, s[28:31], s47 offen offset:3072 sc1 lds
    s_add_u32 m0, s44, 4096
    s_add_u32 s47, s57, 4096
    buffer_load_dwordx4 v4, s[28:31], s47 offen offset:0 sc1 lds
    buffer_load_dwordx4 v4, s[28:31], s47 offen offset:1024 sc1 lds
    s_mov_b64 exec, 0xffff
    buffer_load_dwordx4 v4, s[28:31], s47 offen offset:2048 sc1 lds
    s_mov_b64 exec, -1
    v_mov_b32 v201, 0
    v_mov_b32 v213, 0
    s_waitcnt vmcnt(0)
k2_phase_rp:
    s_mov_b64 exec, s[94:95]
    ds_read_b128 v[60:63], v6 offset:0
    ds_read_b128 v[78:81], v6 offset:1280
    ds_read_b128 v[96:99], v6 offset:2560
    ds_read_b128 v[114:117], v6 offset:3840
    ds_read_b128 v[132:135], v6 offset:5120
    ds_read_b128 v[64:67], v6 offset:256
    ds_read_b128 v[82:85], v6 offset:1536
    ds_read_b128 v[100:103], v6 offset:2816
    ds_read_b128 v[118:121], v6 offset:4096
    ds_read_b128 v[136:139], v6 offset:5376
    ds_read_b128 v[68:71], v6 offset:512
    ds_read_b128 v[86:89], v6 offset:1792
    ds_read_b128 v[104:107], v6 offset:3072
    ds_read_b128 v[122:125], v6 offset:4352
    ds_read_b128 v[140:143], v6 offset:5632
    ds_read_b128 v[72:75], v6 offset:768
    ds_read_b128 v[90:93], v6 offset:2048
    ds_read_b128 v[108:111], v6 offset:3328
    ds_read_b128 v[126:129], v6 offset:4608
    ds_read_b128 v[144:147], v6 offset:5888
    ds_read_b64 v[76:77], v6 offset:1024
    ds_read_b64 v[94:95], v6 offset:2304
    ds_read_b64 v[112:113], v6 offset:3584
    ds_read_b64 v[130:131], v6 offset:4864
    ds_read_b64 v[148:149], v6 offset:6144
    s_mov_b64 exec, -1
    s_waitcnt lgkmcnt(10)
    v_max3_u32 v216, v60, v61, v62
    v_max3_u32 v217, v63, v78, v79
    v_max3_u32 v216, v216, v80, v81
    v_max3_u32 v217, v217, v96, v97
    v_max3_u32 v216, v216, v98, v99
    v_max3_u32 v217, v217, v114, v115
    v_max3_u32 v216, v216, v116, v117
    v_max3_u32 v217, v217, v132, v133
    v_max3_u32 v216, v216, v134, v135
    v_max3_u32 v217, v217, v64, v65
    v_max3_u32 v216, v216, v66, v67
    v_max3_u32 v217, v217, v82, v83
    v_max3_u32 v216, v216, v84, v85
    v_max3_u32 v217, v217, v100, v101
    v_max3_u32 v216, v216, v102, v103
    v_max3_u32 v217, v217, v118, v119
    v_max3_u32 v216, v216, v120, v121
    v_max3_u32 v217, v217, v136, v137
    v_max3_u32 v216, v216, v138, v139
    v_max3_u32 v217, v217, v68, v69
    v_max3_u32 v216, v216, v70, v71
    v_max3_u32 v217, v217, v86, v87
    v_max3_u32 v216, v216, v88, v89
    v_max3_u32 v217, v217, v104, v105
    v_max3_u32 v216, v216, v106, v107
    v_max3_u32 v217, v217, v122, v123
    v_max3_u32 v216, v216, v124, v125
    v_max3_u32 v217, v217, v140, v141
    v_max3_u32 v216, v216, v142, v143
    s_waitcnt lgkmcnt(0)
    v_max3_u32 v217, v217, v72, v73
    v_max3_u32 v216, v216, v74, v75
    v_max3_u32 v217, v217, v90, v91
    v_max3_u32 v216, v216, v92, v93
    v_max3_u32 v217, v217, v108, v109
    v_max3_u32 v216, v216, v110, v111
    v_max3_u32 v217, v217, v126, v127
    v_max3_u32 v216, v216, v128, v129
    v_max3_u32 v217, v217, v144, v145
    v_max3_u32 v216, v216, v146, v147
    v_max3_u32 v217, v217, v76, v77
    v_max3_u32 v216, v216, v94, v95
    v_max3_u32 v217, v217, v112, v113
    v_max3_u32 v216, v216, v130, v131
    v_max3_u32 v217, v217, v148, v149
    v_max_u32 v216, v216, v217
    v_cmp_eq_u32 vcc, -1, v216
    s_cbranch_vccz k2_phase_rd
    s_sleep 2
    s_add_u32 m0, s44, 0
    s_add_u32 s47, s57, 0
    buffer_load_dwordx4 v4, s[28:31], s47 offen offset:0 sc1 lds
    buffer_load_dwordx4 v4, s[28:31], s47 offen offset:1024 sc1 lds
    buffer_load_dwordx4 v4, s[28:31], s47 offen offset:2048 sc1 lds
    buffer_load_dwordx4 v4, s[28:31], s47 offen offset:3072 sc1 lds
    s_add_u32 m0, s44, 4096
    s_add_u32 s47, s57, 4096
    buffer_load_dwordx4 v4, s[28:31], s47 offen offset:0 sc1 lds
    buffer_load_dwordx4 v4, s[28:31], s47 offen offset:1024 sc1 lds
    s_mov_b64 exec, 0xffff
    buffer_load_dwordx4 v4, s[28:31], s47 offen offset:2048 sc1 lds
    s_mov_b64 exec, -1
    s_waitcnt vmcnt(0)
    s_branch k2_phase_rp
k2_phase_rd:
    v_mfma_f32_16x16x32_bf16 v[152:155], v[60:63], v[24:27], 0
    v_mfma_f32_16x16x32_bf16 v[172:175], v[60:63], v[42:45], 0
    v_mfma_f32_16x16x32_bf16 v[156:159], v[78:81], v[24:27], 0
    v_mfma_f32_16x16x32_bf16 v[176:179], v[78:81], v[42:45], 0
    v_mfma_f32_16x16x32_bf16 v[160:163], v[96:99], v[24:27], 0
    v_mfma_f32_16x16x32_bf16 v[180:183], v[96:99], v[42:45], 0
    v_mfma_f32_16x16x32_bf16 v[164:167], v[114:117], v[24:27], 0
    v_mfma_f32_16x16x32_bf16 v[184:187], v[114:117], v[42:45], 0
    v_mfma_f32_16x16x32_bf16 v[168:171], v[132:135], v[24:27], 0
    v_mfma_f32_16x16x32_bf16 v[188:191], v[132:135], v[42:45], 0
    v_mfma_f32_16x16x32_bf16 v[152:155], v[64:67], v[28:31], v[152:155]
    v_mfma_f32_16x16x32_bf16 v[172:175], v[64:67], v[46:49], v[172:175]
    v_mfma_f32_16x16x32_bf16 v[156:159], v[82:85], v[28:31], v[156:159]
    v_mfma_f32_16x16x32_bf16 v[176:179], v[82:85], v[46:49], v[176:179]
    v_mfma_f32_16x16x32_bf16 v[160:163], v[100:103], v[28:31], v[160:163]
    v_mfma_f32_16x16x32_bf16 v[180:183], v[100:103], v[46:49], v[180:183]
    v_mfma_f32_16x16x32_bf16 v[164:167], v[118:121], v[28:31], v[164:167]
    v_mfma_f32_16x16x32_bf16 v[184:187], v[118:121], v[46:49], v[184:187]
    v_mfma_f32_16x16x32_bf16 v[168:171], v[136:139], v[28:31], v[168:171]
    v_mfma_f32_16x16x32_bf16 v[188:191], v[136:139], v[46:49], v[188:191]
    v_mfma_f32_16x16x32_bf16 v[152:155], v[68:71], v[32:35], v[152:155]
    v_mfma_f32_16x16x32_bf16 v[172:175], v[68:71], v[50:53], v[172:175]
    v_mfma_f32_16x16x32_bf16 v[156:159], v[86:89], v[32:35], v[156:159]
    v_mfma_f32_16x16x32_bf16 v[176:179], v[86:89], v[50:53], v[176:179]
    v_mfma_f32_16x16x32_bf16 v[160:163], v[104:107], v[32:35], v[160:163]
    v_mfma_f32_16x16x32_bf16 v[180:183], v[104:107], v[50:53], v[180:183]
    v_mfma_f32_16x16x32_bf16 v[164:167], v[122:125], v[32:35], v[164:167]
    v_mfma_f32_16x16x32_bf16 v[184:187], v[122:125], v[50:53], v[184:187]
    v_mfma_f32_16x16x32_bf16 v[168:171], v[140:143], v[32:35], v[168:171]
    v_mfma_f32_16x16x32_bf16 v[188:191], v[140:143], v[50:53], v[188:191]
    v_mfma_f32_16x16x32_bf16 v[152:155], v[72:75], v[36:39], v[152:155]
    v_mfma_f32_16x16x32_bf16 v[172:175], v[72:75], v[54:57], v[172:175]
    v_mfma_f32_16x16x32_bf16 v[156:159], v[90:93], v[36:39], v[156:159]
    v_mfma_f32_16x16x32_bf16 v[176:179], v[90:93], v[54:57], v[176:179]
    v_mfma_f32_16x16x32_bf16 v[160:163], v[108:111], v[36:39], v[160:163]
    v_mfma_f32_16x16x32_bf16 v[180:183], v[108:111], v[54:57], v[180:183]
    v_mfma_f32_16x16x32_bf16 v[164:167], v[126:129], v[36:39], v[164:167]
    v_mfma_f32_16x16x32_bf16 v[184:187], v[126:129], v[54:57], v[184:187]
    v_mfma_f32_16x16x32_bf16 v[168:171], v[144:147], v[36:39], v[168:171]
    v_mfma_f32_16x16x32_bf16 v[188:191], v[144:147], v[54:57], v[188:191]
    v_mfma_f32_16x16x16_bf16 v[152:155], v[76:77], v[40:41], v[152:155]
    v_mfma_f32_16x16x16_bf16 v[172:175], v[76:77], v[58:59], v[172:175]
    v_mfma_f32_16x16x16_bf16 v[156:159], v[94:95], v[40:41], v[156:159]
    v_mfma_f32_16x16x16_bf16 v[176:179], v[94:95], v[58:59], v[176:179]
    v_mfma_f32_16x16x16_bf16 v[160:163], v[112:113], v[40:41], v[160:163]
    v_mfma_f32_16x16x16_bf16 v[180:183], v[112:113], v[58:59], v[180:183]
    v_mfma_f32_16x16x16_bf16 v[164:167], v[130:131], v[40:41], v[164:167]
    v_mfma_f32_16x16x16_bf16 v[184:187], v[130:131], v[58:59], v[184:187]
    v_mfma_f32_16x16x16_bf16 v[168:171], v[148:149], v[40:41], v[168:171]
    v_mfma_f32_16x16x16_bf16 v[188:191], v[148:149], v[58:59], v[188:191]
    v_add_u32 v228, s44, v4
    v_add_u32 v229, s44, v5
    s_nop 1
    s_mul_i32 s47, s59, 2560
    s_add_u32 s47, s47, 110592
    v_add_u32 v230, s47, v4
    v_add_u32 v231, s47, v5
    v_add_f32 v170, 897988541, v170
    v_rcp_f32 v170, v170
    s_nop 0
    v_mov_b32 v171, v170
    v_pk_mul_f32 v[152:153], v[152:153], v[170:171]
    v_pk_mul_f32 v[154:155], v[154:155], v[170:171]
    v_pk_mul_f32 v[156:157], v[156:157], v[170:171]
    v_pk_mul_f32 v[158:159], v[158:159], v[170:171]
    v_pk_mul_f32 v[160:161], v[160:161], v[170:171]
    v_pk_mul_f32 v[162:163], v[162:163], v[170:171]
    v_pk_mul_f32 v[164:165], v[164:165], v[170:171]
    v_pk_mul_f32 v[166:167], v[166:167], v[170:171]
    v_pk_mul_f32 v[168:169], v[168:169], v[170:171]
    v_cvt_pk_bf16_f32 v192, v152, v153
    v_cvt_pk_bf16_f32 v193, v154, v155
    v_cvt_pk_bf16_f32 v194, v156, v157
    v_cvt_pk_bf16_f32 v195, v158, v159
    v_cvt_pk_bf16_f32 v196, v160, v161
    v_cvt_pk_bf16_f32 v197, v162, v163
    v_cvt_pk_bf16_f32 v198, v164, v165
    v_cvt_pk_bf16_f32 v199, v166, v167
    v_cvt_pk_bf16_f32 v200, v168, v169
    ds_write_b128 v228, v[192:195] offset:0
    ds_write_b128 v228, v[196:199] offset:1024
    ds_write_b64 v229, v[200:201] offset:2048
    v_add_f32 v190, 897988541, v190
    v_rcp_f32 v190, v190
    s_nop 0
    v_mov_b32 v191, v190
    v_pk_mul_f32 v[172:173], v[172:173], v[190:191]
    v_pk_mul_f32 v[174:175], v[174:175], v[190:191]
    v_pk_mul_f32 v[176:177], v[176:177], v[190:191]
    v_pk_mul_f32 v[178:179], v[178:179], v[190:191]
    v_pk_mul_f32 v[180:181], v[180:181], v[190:191]
    v_pk_mul_f32 v[182:183], v[182:183], v[190:191]
    v_pk_mul_f32 v[184:185], v[184:185], v[190:191]
    v_pk_mul_f32 v[186:187], v[186:187], v[190:191]
    v_pk_mul_f32 v[188:189], v[188:189], v[190:191]
    v_cvt_pk_bf16_f32 v204, v172, v173
    v_cvt_pk_bf16_f32 v205, v174, v175
    v_cvt_pk_bf16_f32 v206, v176, v177
    v_cvt_pk_bf16_f32 v207, v178, v179
    v_cvt_pk_bf16_f32 v208, v180, v181
    v_cvt_pk_bf16_f32 v209, v182, v183
    v_cvt_pk_bf16_f32 v210, v184, v185
    v_cvt_pk_bf16_f32 v211, v186, v187
    v_cvt_pk_bf16_f32 v212, v188, v189
    ds_write_b128 v228, v[204:207] offset:2560
    ds_write_b128 v228, v[208:211] offset:3584
    ds_write_b64 v229, v[212:213] offset:4608
    v_mov_b32 v24, 0
    v_mov_b32 v25, 0
    v_mov_b32 v26, 0
    v_mov_b32 v27, 0
    v_mov_b32 v28, 0
    v_mov_b32 v29, 0
    v_mov_b32 v30, 0
    v_mov_b32 v31, 0
    v_mov_b32 v32, 0
    v_mov_b32 v33, 0
    v_mov_b32 v34, 0
    v_mov_b32 v35, 0
    s_waitcnt vmcnt(0) lgkmcnt(0)
    s_barrier
    ds_read_b128 v[60:63], v230 offset:0
    ds_read_b128 v[64:67], v230 offset:1024
    ds_read_b64 v[68:69], v231 offset:2048
    ds_read_b64_tr_b16 v[72:73], v12 offset:0
    ds_read_b64_tr_b16 v[74:75], v12 offset:6144
    ds_read_b64_tr_b16 v[76:77], v12 offset:128
    ds_read_b64_tr_b16 v[78:79], v12 offset:6272
    ds_read_b64_tr_b16 v[80:81], v12 offset:256
    ds_read_b64_tr_b16 v[82:83], v12 offset:6400
    ds_read_b64_tr_b16 v[84:85], v12 offset:12288
    ds_read_b64_tr_b16 v[86:87], v12 offset:18432
    ds_read_b64_tr_b16 v[88:89], v12 offset:12416
    ds_read_b64_tr_b16 v[90:91], v12 offset:18560
    ds_read_b64_tr_b16 v[92:93], v12 offset:12544
    ds_read_b64_tr_b16 v[94:95], v12 offset:18688
    ds_read_b64_tr_b16 v[96:97], v13 offset:24576
    ds_read_b64_tr_b16 v[98:99], v13 offset:24704
    ds_read_b64_tr_b16 v[100:101], v13 offset:24832
    s_waitcnt lgkmcnt(0)
    v_mfma_f32_16x16x32_bf16 v[24:27], v[72:75], v[60:63], v[24:27]
    ds_read_b128 v[104:107], v230 offset:6400
    ds_read_b128 v[108:111], v230 offset:7424
    ds_read_b64 v[112:113], v231 offset:8448
    v_mfma_f32_16x16x32_bf16 v[28:31], v[76:79], v[60:63], v[28:31]
    ds_read_b64_tr_b16 v[116:117], v12 offset:27648
    ds_read_b64_tr_b16 v[118:119], v12 offset:33792
    ds_read_b64_tr_b16 v[120:121], v12 offset:27776
    v_mfma_f32_16x16x32_bf16 v[32:35], v[80:83], v[60:63], v[32:35]
    ds_read_b64_tr_b16 v[122:123], v12 offset:33920
    ds_read_b64_tr_b16 v[124:125], v12 offset:27904
    ds_read_b64_tr_b16 v[126:127], v12 offset:34048
    v_mfma_f32_16x16x32_bf16 v[24:27], v[84:87], v[64:67], v[24:27]
    ds_read_b64_tr_b16 v[128:129], v12 offset:39936
    ds_read_b64_tr_b16 v[130:131], v12 offset:46080
    ds_read_b64_tr_b16 v[132:133], v12 offset:40064
    v_mfma_f32_16x16x32_bf16 v[28:31], v[88:91], v[64:67], v[28:31]
    ds_read_b64_tr_b16 v[134:135], v12 offset:46208
    ds_read_b64_tr_b16 v[136:137], v12 offset:40192
    ds_read_b64_tr_b16 v[138:139], v12 offset:46336
    v_mfma_f32_16x16x32_bf16 v[32:35], v[92:95], v[64:67], v[32:35]
    ds_read_b64_tr_b16 v[140:141], v13 offset:52224
    ds_read_b64_tr_b16 v[142:143], v13 offset:52352
    ds_read_b64_tr_b16 v[144:145], v13 offset:52480
    v_mfma_f32_16x16x16_bf16 v[24:27], v[96:97], v[68:69], v[24:27]
    v_mfma_f32_16x16x16_bf16 v[28:31], v[98:99], v[68:69], v[28:31]
    v_mfma_f32_16x16x16_bf16 v[32:35], v[100:101], v[68:69], v[32:35]
    s_waitcnt lgkmcnt(0)
    s_barrier
    v_mfma_f32_16x16x32_bf16 v[24:27], v[116:119], v[104:107], v[24:27]
    ds_read_b128 v[60:63], v230 offset:12800
    ds_read_b128 v[64:67], v230 offset:13824
    ds_read_b64 v[68:69], v231 offset:14848
    v_mfma_f32_16x16x32_bf16 v[28:31], v[120:123], v[104:107], v[28:31]
    ds_read_b64_tr_b16 v[72:73], v22 offset:0
    ds_read_b64_tr_b16 v[74:75], v22 offset:6144
    ds_read_b64_tr_b16 v[76:77], v22 offset:128
    v_mfma_f32_16x16x32_bf16 v[32:35], v[124:127], v[104:107], v[32:35]
    ds_read_b64_tr_b16 v[78:79], v22 offset:6272
    ds_read_b64_tr_b16 v[80:81], v22 offset:256
    ds_read_b64_tr_b16 v[82:83], v22 offset:6400
    v_mfma_f32_16x16x32_bf16 v[24:27], v[128:131], v[108:111], v[24:27]
    ds_read_b64_tr_b16 v[84:85], v22 offset:12288
    ds_read_b64_tr_b16 v[86:87], v22 offset:18432
    ds_read_b64_tr_b16 v[88:89], v22 offset:12416
    v_mfma_f32_16x16x32_bf16 v[28:31], v[132:135], v[108:111], v[28:31]
    ds_read_b64_tr_b16 v[90:91], v22 offset:18560
    ds_read_b64_tr_b16 v[92:93], v22 offset:12544
    ds_read_b64_tr_b16 v[94:95], v22 offset:18688
    v_mfma_f32_16x16x32_bf16 v[32:35], v[136:139], v[108:111], v[32:35]
    ds_read_b64_tr_b16 v[96:97], v23 offset:24576
    ds_read_b64_tr_b16 v[98:99], v23 offset:24704
    ds_read_b64_tr_b16 v[100:101], v23 offset:24832
    v_mfma_f32_16x16x16_bf16 v[24:27], v[140:141], v[112:113], v[24:27]
    s_add_u32 m0, s52, 0
    s_add_u32 s47, s50, 331776
    buffer_load_dwordx4 v8, s[20:23], s47 offen lds
    buffer_load_dwordx4 v9, s[20:23], s47 offen offset:1024 lds
    buffer_load_dwordx4 v10, s[20:23], s47 offen offset:2048 lds
    v_mfma_f32_16x16x16_bf16 v[28:31], v[142:143], v[112:113], v[28:31]
    s_add_u32 m0, s53, 0
    s_add_u32 s47, s51, 331776
    s_cmp_ge_u32 s12, 3
    s_cbranch_scc1 k2_phase_d_5
    buffer_load_dwordx4 v11, s[20:23], s47 offen lds
k2_phase_d_5:
    s_add_u32 m0, s52, 27648
    s_add_u32 s47, s50, 414720
    buffer_load_dwordx4 v8, s[20:23], s47 offen lds
    buffer_load_dwordx4 v9, s[20:23], s47 offen offset:1024 lds
    v_mfma_f32_16x16x16_bf16 v[32:35], v[144:145], v[112:113], v[32:35]
    buffer_load_dwordx4 v10, s[20:23], s47 offen offset:2048 lds
    s_add_u32 m0, s53, 27648
    s_add_u32 s47, s51, 414720
    s_cmp_ge_u32 s12, 3
    s_cbranch_scc1 k2_phase_d_6
    buffer_load_dwordx4 v11, s[20:23], s47 offen lds
k2_phase_d_6:
    s_waitcnt lgkmcnt(0)
    v_mfma_f32_16x16x32_bf16 v[24:27], v[72:75], v[60:63], v[24:27]
    ds_read_b128 v[104:107], v230 offset:19200
    ds_read_b128 v[108:111], v230 offset:20224
    ds_read_b64 v[112:113], v231 offset:21248
    v_mfma_f32_16x16x32_bf16 v[28:31], v[76:79], v[60:63], v[28:31]
    ds_read_b64_tr_b16 v[116:117], v22 offset:27648
    ds_read_b64_tr_b16 v[118:119], v22 offset:33792
    ds_read_b64_tr_b16 v[120:121], v22 offset:27776
    v_mfma_f32_16x16x32_bf16 v[32:35], v[80:83], v[60:63], v[32:35]
    ds_read_b64_tr_b16 v[122:123], v22 offset:33920
    ds_read_b64_tr_b16 v[124:125], v22 offset:27904
    ds_read_b64_tr_b16 v[126:127], v22 offset:34048
    v_mfma_f32_16x16x32_bf16 v[24:27], v[84:87], v[64:67], v[24:27]
    ds_read_b64_tr_b16 v[128:129], v22 offset:39936
    ds_read_b64_tr_b16 v[130:131], v22 offset:46080
    ds_read_b64_tr_b16 v[132:133], v22 offset:40064
    v_mfma_f32_16x16x32_bf16 v[28:31], v[88:91], v[64:67], v[28:31]
    ds_read_b64_tr_b16 v[134:135], v22 offset:46208
    ds_read_b64_tr_b16 v[136:137], v22 offset:40192
    ds_read_b64_tr_b16 v[138:139], v22 offset:46336
    v_mfma_f32_16x16x32_bf16 v[32:35], v[92:95], v[64:67], v[32:35]
    ds_read_b64_tr_b16 v[140:141], v23 offset:52224
    ds_read_b64_tr_b16 v[142:143], v23 offset:52352
    ds_read_b64_tr_b16 v[144:145], v23 offset:52480
    v_mfma_f32_16x16x16_bf16 v[24:27], v[96:97], v[68:69], v[24:27]
    v_mfma_f32_16x16x16_bf16 v[28:31], v[98:99], v[68:69], v[28:31]
    v_mfma_f32_16x16x16_bf16 v[32:35], v[100:101], v[68:69], v[32:35]
    s_waitcnt lgkmcnt(0) vmcnt(0)
    s_barrier
    v_mfma_f32_16x16x32_bf16 v[24:27], v[116:119], v[104:107], v[24:27]
    ds_read_b128 v[60:63], v230 offset:25600
    ds_read_b128 v[64:67], v230 offset:26624
    ds_read_b64 v[68:69], v231 offset:27648
    v_mfma_f32_16x16x32_bf16 v[28:31], v[120:123], v[104:107], v[28:31]
    ds_read_b64_tr_b16 v[72:73], v12 offset:0
    ds_read_b64_tr_b16 v[74:75], v12 offset:6144
    ds_read_b64_tr_b16 v[76:77], v12 offset:128
    v_mfma_f32_16x16x32_bf16 v[32:35], v[124:127], v[104:107], v[32:35]
    ds_read_b64_tr_b16 v[78:79], v12 offset:6272
    ds_read_b64_tr_b16 v[80:81], v12 offset:256
    ds_read_b64_tr_b16 v[82:83], v12 offset:6400
    v_mfma_f32_16x16x32_bf16 v[24:27], v[128:131], v[108:111], v[24:27]
    ds_read_b64_tr_b16 v[84:85], v12 offset:12288
    ds_read_b64_tr_b16 v[86:87], v12 offset:18432
    ds_read_b64_tr_b16 v[88:89], v12 offset:12416
    v_mfma_f32_16x16x32_bf16 v[28:31], v[132:135], v[108:111], v[28:31]
    ds_read_b64_tr_b16 v[90:91], v12 offset:18560
    ds_read_b64_tr_b16 v[92:93], v12 offset:12544
    ds_read_b64_tr_b16 v[94:95], v12 offset:18688
    v_mfma_f32_16x16x32_bf16 v[32:35], v[136:139], v[108:111], v[32:35]
    ds_read_b64_tr_b16 v[96:97], v13 offset:24576
    ds_read_b64_tr_b16 v[98:99], v13 offset:24704
    ds_read_b64_tr_b16 v[100:101], v13 offset:24832
    v_mfma_f32_16x16x16_bf16 v[24:27], v[140:141], v[112:113], v[24:27]
    s_add_u32 m0, s52, 55296
    s_add_u32 s47, s50, 497664
    buffer_load_dwordx4 v8, s[20:23], s47 offen lds
    buffer_load_dwordx4 v9, s[20:23], s47 offen offset:1024 lds
    buffer_load_dwordx4 v10, s[20:23], s47 offen offset:2048 lds
    v_mfma_f32_16x16x16_bf16 v[28:31], v[142:143], v[112:113], v[28:31]
    s_add_u32 m0, s53, 55296
    s_add_u32 s47, s51, 497664
    s_cmp_ge_u32 s12, 3
    s_cbranch_scc1 k2_phase_d_7
    buffer_load_dwordx4 v11, s[20:23], s47 offen lds
k2_phase_d_7:
    s_add_u32 m0, s52, 82944
    s_add_u32 s47, s50, 580608
    buffer_load_dwordx4 v8, s[20:23], s47 offen lds
    buffer_load_dwordx4 v9, s[20:23], s47 offen offset:1024 lds
    v_mfma_f32_16x16x16_bf16 v[32:35], v[144:145], v[112:113], v[32:35]
    buffer_load_dwordx4 v10, s[20:23], s47 offen offset:2048 lds
    s_add_u32 m0, s53, 82944
    s_add_u32 s47, s51, 580608
    s_cmp_ge_u32 s12, 3
    s_cbranch_scc1 k2_phase_d_8
    buffer_load_dwordx4 v11, s[20:23], s47 offen lds
k2_phase_d_8:
    s_waitcnt lgkmcnt(0)
    v_mfma_f32_16x16x32_bf16 v[24:27], v[72:75], v[60:63], v[24:27]
    ds_read_b128 v[104:107], v230 offset:32000
    ds_read_b128 v[108:111], v230 offset:33024
    ds_read_b64 v[112:113], v231 offset:34048
    v_mfma_f32_16x16x32_bf16 v[28:31], v[76:79], v[60:63], v[28:31]
    ds_read_b64_tr_b16 v[116:117], v12 offset:27648
    ds_read_b64_tr_b16 v[118:119], v12 offset:33792
    ds_read_b64_tr_b16 v[120:121], v12 offset:27776
    v_mfma_f32_16x16x32_bf16 v[32:35], v[80:83], v[60:63], v[32:35]
    ds_read_b64_tr_b16 v[122:123], v12 offset:33920
    ds_read_b64_tr_b16 v[124:125], v12 offset:27904
    ds_read_b64_tr_b16 v[126:127], v12 offset:34048
    v_mfma_f32_16x16x32_bf16 v[24:27], v[84:87], v[64:67], v[24:27]
    ds_read_b64_tr_b16 v[128:129], v12 offset:39936
    ds_read_b64_tr_b16 v[130:131], v12 offset:46080
    ds_read_b64_tr_b16 v[132:133], v12 offset:40064
    v_mfma_f32_16x16x32_bf16 v[28:31], v[88:91], v[64:67], v[28:31]
    ds_read_b64_tr_b16 v[134:135], v12 offset:46208
    ds_read_b64_tr_b16 v[136:137], v12 offset:40192
    ds_read_b64_tr_b16 v[138:139], v12 offset:46336
    v_mfma_f32_16x16x32_bf16 v[32:35], v[92:95], v[64:67], v[32:35]
    ds_read_b64_tr_b16 v[140:141], v13 offset:52224
    ds_read_b64_tr_b16 v[142:143], v13 offset:52352
    ds_read_b64_tr_b16 v[144:145], v13 offset:52480
    v_mfma_f32_16x16x16_bf16 v[24:27], v[96:97], v[68:69], v[24:27]
    v_mfma_f32_16x16x16_bf16 v[28:31], v[98:99], v[68:69], v[28:31]
    v_mfma_f32_16x16x16_bf16 v[32:35], v[100:101], v[68:69], v[32:35]
    s_waitcnt lgkmcnt(0) vmcnt(0)
    s_barrier
    s_cmp_ge_u32 s12, 4
    s_cbranch_scc1 k2_phase_x_9
    s_mov_b32 m0, s52
    s_nop 0
    buffer_load_dwordx4 v16, s[16:19], s93 offen offset:0 lds
    buffer_load_dwordx4 v17, s[16:19], s93 offen offset:1024 lds
    buffer_load_dwordx4 v18, s[16:19], s93 offen offset:2048 lds
k2_phase_x_9:
    v_mfma_f32_16x16x32_bf16 v[24:27], v[116:119], v[104:107], v[24:27]
    ds_read_b128 v[60:63], v230 offset:38400
    ds_read_b128 v[64:67], v230 offset:39424
    ds_read_b64 v[68:69], v231 offset:40448
    v_mfma_f32_16x16x32_bf16 v[28:31], v[120:123], v[104:107], v[28:31]
    ds_read_b64_tr_b16 v[72:73], v22 offset:0
    ds_read_b64_tr_b16 v[74:75], v22 offset:6144
    ds_read_b64_tr_b16 v[76:77], v22 offset:128
    v_mfma_f32_16x16x32_bf16 v[32:35], v[124:127], v[104:107], v[32:35]
    ds_read_b64_tr_b16 v[78:79], v22 offset:6272
    ds_read_b64_tr_b16 v[80:81], v22 offset:256
    ds_read_b64_tr_b16 v[82:83], v22 offset:6400
    v_mfma_f32_16x16x32_bf16 v[24:27], v[128:131], v[108:111], v[24:27]
    ds_read_b64_tr_b16 v[84:85], v22 offset:12288
    ds_read_b64_tr_b16 v[86:87], v22 offset:18432
    ds_read_b64_tr_b16 v[88:89], v22 offset:12416
    v_mfma_f32_16x16x32_bf16 v[28:31], v[132:135], v[108:111], v[28:31]
    ds_read_b64_tr_b16 v[90:91], v22 offset:18560
    ds_read_b64_tr_b16 v[92:93], v22 offset:12544
    ds_read_b64_tr_b16 v[94:95], v22 offset:18688
    v_mfma_f32_16x16x32_bf16 v[32:35], v[136:139], v[108:111], v[32:35]
    ds_read_b64_tr_b16 v[96:97], v23 offset:24576
    ds_read_b64_tr_b16 v[98:99], v23 offset:24704
    ds_read_b64_tr_b16 v[100:101], v23 offset:24832
    v_mfma_f32_16x16x16_bf16 v[24:27], v[140:141], v[112:113], v[24:27]
    v_mfma_f32_16x16x16_bf16 v[28:31], v[142:143], v[112:113], v[28:31]
    v_mfma_f32_16x16x16_bf16 v[32:35], v[144:145], v[112:113], v[32:35]
    s_waitcnt lgkmcnt(0)
    v_mfma_f32_16x16x32_bf16 v[24:27], v[72:75], v[60:63], v[24:27]
    ds_read_b128 v[104:107], v230 offset:44800
    ds_read_b128 v[108:111], v230 offset:45824
    ds_read_b64 v[112:113], v231 offset:46848
    v_mfma_f32_16x16x32_bf16 v[28:31], v[76:79], v[60:63], v[28:31]
    ds_read_b64_tr_b16 v[116:117], v22 offset:27648
    ds_read_b64_tr_b16 v[118:119], v22 offset:33792
    ds_read_b64_tr_b16 v[120:121], v22 offset:27776
    v_mfma_f32_16x16x32_bf16 v[32:35], v[80:83], v[60:63], v[32:35]
    ds_read_b64_tr_b16 v[122:123], v22 offset:33920
    ds_read_b64_tr_b16 v[124:125], v22 offset:27904
    ds_read_b64_tr_b16 v[126:127], v22 offset:34048
    v_mfma_f32_16x16x32_bf16 v[24:27], v[84:87], v[64:67], v[24:27]
    ds_read_b64_tr_b16 v[128:129], v22 offset:39936
    ds_read_b64_tr_b16 v[130:131], v22 offset:46080
    ds_read_b64_tr_b16 v[132:133], v22 offset:40064
    v_mfma_f32_16x16x32_bf16 v[28:31], v[88:91], v[64:67], v[28:31]
    ds_read_b64_tr_b16 v[134:135], v22 offset:46208
    ds_read_b64_tr_b16 v[136:137], v22 offset:40192
    ds_read_b64_tr_b16 v[138:139], v22 offset:46336
    v_mfma_f32_16x16x32_bf16 v[32:35], v[92:95], v[64:67], v[32:35]
    ds_read_b64_tr_b16 v[140:141], v23 offset:52224
    ds_read_b64_tr_b16 v[142:143], v23 offset:52352
    ds_read_b64_tr_b16 v[144:145], v23 offset:52480
    v_mfma_f32_16x16x16_bf16 v[24:27], v[96:97], v[68:69], v[24:27]
    v_mfma_f32_16x16x16_bf16 v[28:31], v[98:99], v[68:69], v[28:31]
    v_mfma_f32_16x16x16_bf16 v[32:35], v[100:101], v[68:69], v[32:35]
    s_waitcnt lgkmcnt(0) vmcnt(0)
    s_barrier
    v_mfma_f32_16x16x32_bf16 v[24:27], v[116:119], v[104:107], v[24:27]
    ds_read_b64 v[16:17], v14 offset:0
    ds_read_b64 v[18:19], v14 offset:128
    ds_read_b64 v[20:21], v14 offset:256
    v_mfma_f32_16x16x32_bf16 v[28:31], v[120:123], v[104:107], v[28:31]
    v_mfma_f32_16x16x32_bf16 v[32:35], v[124:127], v[104:107], v[32:35]
    v_mfma_f32_16x16x32_bf16 v[24:27], v[128:131], v[108:111], v[24:27]
    v_mfma_f32_16x16x32_bf16 v[28:31], v[132:135], v[108:111], v[28:31]
    v_mfma_f32_16x16x32_bf16 v[32:35], v[136:139], v[108:111], v[32:35]
    v_mfma_f32_16x16x16_bf16 v[24:27], v[140:141], v[112:113], v[24:27]
    v_mfma_f32_16x16x16_bf16 v[28:31], v[142:143], v[112:113], v[28:31]
    v_mfma_f32_16x16x16_bf16 v[32:35], v[144:145], v[112:113], v[32:35]
    s_waitcnt lgkmcnt(0)
    v_lshlrev_b32 v216, 16, v16
    v_and_b32 v217, s45, v16
    v_lshlrev_b32 v218, 16, v17
    v_and_b32 v219, s45, v17
    v_lshlrev_b32 v220, 16, v18
    v_and_b32 v221, s45, v18
    v_lshlrev_b32 v222, 16, v19
    v_and_b32 v223, s45, v19
    v_lshlrev_b32 v224, 16, v20
    v_and_b32 v225, s45, v20
    v_lshlrev_b32 v226, 16, v21
    v_and_b32 v227, s45, v21
    v_pk_add_f32 v[24:25], v[24:25], v[216:217]
    v_pk_add_f32 v[26:27], v[26:27], v[218:219]
    v_pk_add_f32 v[28:29], v[28:29], v[220:221]
    v_pk_add_f32 v[30:31], v[30:31], v[222:223]
    v_pk_add_f32 v[32:33], v[32:33], v[224:225]
    v_pk_add_f32 v[34:35], v[34:35], v[226:227]
    v_cvt_pk_bf16_f32 v36, v24, v25
    v_cvt_pk_bf16_f32 v37, v26, v27
    v_cvt_pk_bf16_f32 v38, v28, v29
    v_cvt_pk_bf16_f32 v39, v30, v31
    v_cvt_pk_bf16_f32 v40, v32, v33
    v_cvt_pk_bf16_f32 v41, v34, v35
    v_lshlrev_b32 v24, 16, v36
    v_and_b32 v25, s45, v36
    v_lshlrev_b32 v26, 16, v37
    v_and_b32 v27, s45, v37
    v_lshlrev_b32 v28, 16, v38
    v_and_b32 v29, s45, v38
    v_lshlrev_b32 v30, 16, v39
    v_and_b32 v31, s45, v39
    v_lshlrev_b32 v32, 16, v40
    v_and_b32 v33, s45, v40
    v_lshlrev_b32 v34, 16, v41
    v_and_b32 v35, s45, v41
    v_pk_add_f32 v[44:45], v[24:25], v[26:27]
    v_pk_mul_f32 v[46:47], v[24:25], v[24:25]
    v_pk_fma_f32 v[46:47], v[26:27], v[26:27], v[46:47]
    v_pk_add_f32 v[44:45], v[44:45], v[28:29]
    v_pk_fma_f32 v[46:47], v[28:29], v[28:29], v[46:47]
    v_pk_add_f32 v[44:45], v[44:45], v[30:31]
    v_pk_fma_f32 v[46:47], v[30:31], v[30:31], v[46:47]
    v_pk_add_f32 v[44:45], v[44:45], v[32:33]
    v_pk_fma_f32 v[46:47], v[32:33], v[32:33], v[46:47]
    v_pk_add_f32 v[44:45], v[44:45], v[34:35]
    v_pk_fma_f32 v[46:47], v[34:35], v[34:35], v[46:47]
    v_add_f32 v44, v44, v45
    v_add_f32 v45, v46, v47
    v_mov_b32 v46, v44
    v_mov_b32 v47, v45
    s_nop 1
    v_permlane32_swap_b32 v44, v46
    v_permlane32_swap_b32 v45, v47
    s_nop 1
    v_pk_add_f32 v[44:45], v[44:45], v[46:47]
    v_mov_b32 v46, v44
    v_mov_b32 v47, v45
    s_nop 1
    v_permlane16_swap_b32 v44, v46
    v_permlane16_swap_b32 v45, v47
    s_nop 1
    v_pk_add_f32 v[44:45], v[44:45], v[46:47]
    v_lshlrev_b32 v216, 5, v3
    s_lshl_b32 s47, s59, 9
    s_add_u32 s47, s47, 162048
    v_add_u32 v216, s47, v216
    s_lshl_b32 s47, s58, 3
    v_add_u32 v217, s47, v216
    s_mov_b64 exec, 0xffff
    ds_write_b64 v217, v[44:45]
    s_mov_b64 exec, -1
    buffer_store_dwordx2 v[36:37], v5, s[32:35], s56 offen offset:0 sc1
    buffer_store_dwordx2 v[38:39], v5, s[32:35], s56 offen offset:2048 sc1
    buffer_store_dwordx2 v[40:41], v5, s[32:35], s92 offen offset:0 sc1
    s_waitcnt lgkmcnt(0)
    s_barrier
    s_cmp_lg_u32 s58, 0
    s_cbranch_scc1 k2_phase_np
    ds_read_b128 v[60:63], v216
    ds_read_b128 v[64:67], v216 offset:16
    s_lshl_b32 s48, s13, 3
    s_waitcnt lgkmcnt(0)
    v_pk_add_f32 v[60:61], v[60:61], v[62:63]
    v_pk_add_f32 v[64:65], v[64:65], v[66:67]
    v_pk_add_f32 v[60:61], v[60:61], v[64:65]
    v_or_b32 v61, 1, v61
    s_mov_b64 exec, 0xffff
    buffer_store_dwordx2 v[60:61], v15, s[36:39], s48 offen sc1
    s_mov_b64 exec, -1
k2_phase_np:
    v_lshlrev_b32 v222, 2, v1
    v_sub_u32 v222, v3, v222
    v_mov_b32 v223, 0x3f80
    v_mov_b32 v224, 0x3f800000
    v_cmp_eq_u32 vcc, 0, v222
    v_cmp_eq_u32 s[50:51], 1, v222
    s_nop 1
    v_cndmask_b32 v220, 0, v223, vcc
    v_cndmask_b32 v220, v220, v224, s[50:51]
    v_cmp_eq_u32 vcc, 2, v222
    v_cmp_eq_u32 s[50:51], 3, v222
    s_nop 1
    v_cndmask_b32 v221, 0, v223, vcc
    v_cndmask_b32 v221, v221, v224, s[50:51]
    s_mul_i32 s47, s13, 12
    s_add_u32 s47, s47, s58
    s_add_u32 s47, s47, 0
    s_mul_i32 s48, s47, 10923
    s_lshr_b32 s48, s48, 16
    s_mul_i32 s48, s48, 378
    s_add_u32 s47, s47, s48
    s_mul_i32 s48, s14, 6
    s_add_u32 s47, s47, s48
    s_lshl_b32 s52, s47, 10
    s_mul_i32 s47, s13, 12
    s_add_u32 s47, s47, s58
    s_add_u32 s47, s47, 4
    s_mul_i32 s48, s47, 10923
    s_lshr_b32 s48, s48, 16
    s_mul_i32 s48, s48, 378
    s_add_u32 s47, s47, s48
    s_mul_i32 s48, s14, 6
    s_add_u32 s47, s47, s48
    s_lshl_b32 s53, s47, 10
    s_mul_i32 s47, s13, 12
    s_add_u32 s47, s47, s58
    s_add_u32 s47, s47, 8
    s_mul_i32 s48, s47, 10923
    s_lshr_b32 s48, s48, 16
    s_mul_i32 s48, s48, 378
    s_add_u32 s47, s47, s48
    s_mul_i32 s48, s14, 6
    s_add_u32 s47, s47, s48
    s_lshl_b32 s54, s47, 10
k2_phase_poll:
    buffer_load_dwordx4 v[68:71], v15, s[36:39], 0 offen sc1
    buffer_load_dwordx2 v[72:73], v15, s[36:39], 0 offen offset:16 sc1
    s_waitcnt vmcnt(0)
    v_and_b32 v74, v69, v71
    v_and_b32 v74, v74, v73
    v_and_b32 v74, 1, v74
    v_cmp_eq_u32 vcc, 0, v74
    s_cbranch_vccz k2_phase_pd
    s_sleep 1
    s_branch k2_phase_poll
k2_phase_pd:
    v_pk_add_f32 v[68:69], v[68:69], v[70:71]
    v_pk_add_f32 v[68:69], v[68:69], v[72:73]
    v_mul_f32 v68, 987991609, v68
    v_mul_f32 v69, 987991609, v69
    v_fma_f32 v69, -v68, v68, v69
    v_max_f32 v69, 0, v69
    v_mov_b32 v70, v68
    v_mov_b32 v71, v69
    v_add_f32 v71, 925353388, v71
    v_sqrt_f32 v71, v71
    s_nop 0
    v_rcp_f32 v78, v71
    v_sub_f32 v76, 0, v70
    v_mov_b32 v77, v76
    v_mov_b32 v79, v78
    v_sub_f32 v72, v68, v70
    v_mul_f32 v72, v72, v78
    v_mul_f32 v73, v69, v78
    v_mul_f32 v73, v73, v78
    v_add_f32 v73, 925353388, v73
    v_sqrt_f32 v73, v73
    s_nop 0
    v_rcp_f32 v82, v73
    v_sub_f32 v80, 0, v72
    v_mov_b32 v81, v80
    v_mov_b32 v83, v82
    v_mul_f32 v78, v78, v82
    v_mov_b32 v79, v78
    v_pk_add_f32 v[24:25], v[24:25], v[76:77]
    v_pk_add_f32 v[26:27], v[26:27], v[76:77]
    v_pk_add_f32 v[28:29], v[28:29], v[76:77]
    v_pk_add_f32 v[30:31], v[30:31], v[76:77]
    v_pk_add_f32 v[32:33], v[32:33], v[76:77]
    v_pk_add_f32 v[34:35], v[34:35], v[76:77]
    v_pk_mul_f32 v[24:25], v[24:25], v[78:79]
    v_pk_mul_f32 v[26:27], v[26:27], v[78:79]
    v_pk_mul_f32 v[28:29], v[28:29], v[78:79]
    v_pk_mul_f32 v[30:31], v[30:31], v[78:79]
    v_pk_mul_f32 v[32:33], v[32:33], v[78:79]
    v_pk_mul_f32 v[34:35], v[34:35], v[78:79]
    v_cvt_pk_bf16_f32 v152, v24, v25
    v_cvt_pk_bf16_f32 v153, v26, v27
    v_cvt_pk_bf16_f32 v154, v28, v29
    v_cvt_pk_bf16_f32 v155, v30, v31
    v_cvt_pk_bf16_f32 v156, v32, v33
    v_cvt_pk_bf16_f32 v157, v34, v35
    s_nop 1
    v_mfma_f32_16x16x16_bf16 v[160:163], v[152:153], v[220:221], 0
    v_mfma_f32_16x16x16_bf16 v[164:167], v[154:155], v[220:221], 0
    v_mfma_f32_16x16x16_bf16 v[168:171], v[156:157], v[220:221], 0
    s_mul_i32 s47, s58, 3072
    s_lshl_b32 s48, s59, 3
    s_add_u32 s48, s48, s47
    v_add_u32 v218, s48, v4
    v_add_u32 v219, s47, v4
    s_nop 0
    v_cvt_pk_bf16_f32 v176, v160, v161
    v_cvt_pk_bf16_f32 v177, v162, v163
    ds_write_b64 v218, v[176:177] offset:16384
    v_cvt_pk_bf16_f32 v178, v164, v165
    v_cvt_pk_bf16_f32 v179, v166, v167
    ds_write_b64 v218, v[178:179] offset:17408
    v_cvt_pk_bf16_f32 v180, v168, v169
    v_cvt_pk_bf16_f32 v181, v170, v171
    ds_write_b64 v218, v[180:181] offset:18432
    s_waitcnt lgkmcnt(0)
    s_barrier
    s_cmp_lg_u32 s59, 0
    s_cbranch_scc1 k2_phase_h1
    ds_read_b128 v[152:155], v219 offset:16384
    ds_read_b128 v[156:159], v219 offset:17408
    s_waitcnt lgkmcnt(1)
    buffer_store_dwordx4 v[152:155], v4, s[40:43], s52 offen sc1
    s_waitcnt lgkmcnt(0)
    buffer_store_dwordx4 v[156:159], v4, s[40:43], s53 offen sc1
    s_branch k2_phase_h2
k2_phase_h1:
    ds_read_b128 v[152:155], v219 offset:18432
    s_waitcnt lgkmcnt(0)
    buffer_store_dwordx4 v[152:155], v4, s[40:43], s54 offen sc1
k2_phase_h2:
    s_add_u32 s28, s8, 67108864
    s_addc_u32 s29, s9, 0
    s_mov_b32 s30, 65536
    s_mov_b32 s31, 0x00020000
    v_lshlrev_b32 v216, 7, v2
    v_mov_b32 v217, 1
    s_lshl_b32 s47, s13, 10
    s_waitcnt vmcnt(0)
    s_barrier
    s_cmp_lg_u32 s12, 0
    s_cbranch_scc1 k2_phase_ns
    s_mov_b64 exec, 0xff
    buffer_atomic_add v217, v216, s[28:31], s47 offen offset:0
    s_mov_b64 exec, -1
k2_phase_ns:
    s_mov_b64 exec, -1
    s_branch g1_phase
k2_phase_extra:
    s_sub_u32 s10, s10, 24
    s_lshl_b32 s11, s10, 2
    s_add_u32 s11, s11, s12
    s_cmp_ge_u32 s12, 4
    s_cselect_b32 s11, 99, s11
    s_waitcnt lgkmcnt(0)
    s_cmp_ge_u32 s11, 25
    s_cbranch_scc1 k2_phase_nor
    s_add_u32 s24, s8, 58720256
    s_addc_u32 s25, s9, 0
    s_mov_b32 s26, 3276800
    s_mov_b32 s27, 0x00020000
    s_add_u32 s28, s8, 65536000
    s_addc_u32 s29, s9, 0
    s_mov_b32 s30, 51200
    s_mov_b32 s31, 0x00020000
    s_add_u32 s32, s8, 67108864
    s_addc_u32 s33, s9, 0
    s_mov_b32 s34, 65536
    s_mov_b32 s35, 0x00020000
    s_mul_i32 s15, s11, 52
    s_lshr_b32 s15, s15, 8
    s_mul_i32 s16, s15, 5
    s_sub_u32 s16, s11, s16
    v_and_b32 v4, 3, v2
    v_lshlrev_b32 v9, 4, v2
    s_cmp_eq_u32 s15, 4
    s_cselect_b32 s17, 3, 4
    v_cmp_ne_u32 vcc, s17, v4
    v_mov_b32 v10, 0x40000000
    s_mul_i32 s19, s3, 25
    s_add_u32 s19, s19, s11
    v_cndmask_b32 v9, v10, v9, vcc
    s_lshl_b32 s18, s19, 13
    s_add_u32 s17, s18, 4096
    s_lshl_b32 s19, s19, 8
    s_mov_b32 s45, 0xffff0000
    s_cmp_eq_u32 s16, 4
    s_cselect_b32 s16, 0, -1
    s_add_u32 s60, s8, 67239936
    s_addc_u32 s61, s9, 0
    s_mov_b32 s62, 24576
    s_mov_b32 s63, 0x00020000
    s_mov_b32 s84, s90
    s_mov_b32 s85, s91
    s_mov_b32 s86, 256
    s_mov_b32 s87, 0x00020000
    v_mov_b32 v12, 0
    v_lshlrev_b32 v13, 2, v2
    s_and_b32 s88, s2, 7
    s_lshl_b32 s88, s88, 3
    s_add_u32 s88, s88, s3
    s_lshl_b32 s88, s88, 7
    s_mov_b64 exec, 0xffffffff
k2_phase_r_f1:
    buffer_load_dword v14, v12, s[84:87], 0 offen sc1
    buffer_load_dword v15, v13, s[60:63], s88 offen sc1
    s_waitcnt vmcnt(0)
    v_cmp_ne_u32 vcc, v14, v15
    s_nop 0
    s_cbranch_vccnz k2_phase_r_f1s
    v_cmp_ne_u32 vcc, 0, v14
    s_cbranch_vccnz k2_phase_r_f1d
k2_phase_r_f1s:
    s_sleep 2
    s_branch k2_phase_r_f1
k2_phase_r_f1d:
    s_mov_b64 exec, -1
    buffer_load_dwordx4 v[16:19], v9, s[24:27], s18 offen offset:0 sc1
    buffer_load_dwordx4 v[20:23], v9, s[24:27], s18 offen offset:1024 sc1
    buffer_load_dwordx4 v[24:27], v9, s[24:27], s18 offen offset:2048 sc1
    buffer_load_dwordx4 v[28:31], v9, s[24:27], s18 offen offset:3072 sc1
    buffer_load_dwordx4 v[32:35], v9, s[24:27], s17 offen offset:0 sc1
    buffer_load_dwordx4 v[36:39], v9, s[24:27], s17 offen offset:1024 sc1
    buffer_load_dwordx4 v[40:43], v9, s[24:27], s17 offen offset:2048 sc1
    buffer_load_dwordx4 v[44:47], v9, s[24:27], s17 offen offset:3072 sc1
    v_lshlrev_b32 v8, 4, v2
    s_waitcnt vmcnt(7)
    v_lshlrev_b32 v48, 16, v16
    v_and_b32 v49, s45, v16
    v_lshlrev_b32 v50, 16, v17
    v_and_b32 v51, s45, v17
    v_and_b32 v18, s16, v18
    v_lshlrev_b32 v52, 16, v18
    v_and_b32 v53, s45, v18
    v_and_b32 v19, s16, v19
    v_lshlrev_b32 v54, 16, v19
    v_and_b32 v55, s45, v19
    s_waitcnt vmcnt(6)
    v_lshlrev_b32 v56, 16, v20
    v_and_b32 v57, s45, v20
    v_lshlrev_b32 v58, 16, v21
    v_and_b32 v59, s45, v21
    v_and_b32 v22, s16, v22
    v_lshlrev_b32 v60, 16, v22
    v_and_b32 v61, s45, v22
    v_and_b32 v23, s16, v23
    v_lshlrev_b32 v62, 16, v23
    v_and_b32 v63, s45, v23
    v_pk_add_f32 v[48:49], v[48:49], v[56:57]
    v_pk_add_f32 v[50:51], v[50:51], v[58:59]
    v_pk_add_f32 v[52:53], v[52:53], v[60:61]
    v_pk_add_f32 v[54:55], v[54:55], v[62:63]
    s_waitcnt vmcnt(5)
    v_lshlrev_b32 v56, 16, v24
    v_and_b32 v57, s45, v24
    v_lshlrev_b32 v58, 16, v25
    v_and_b32 v59, s45, v25
    v_and_b32 v26, s16, v26
    v_lshlrev_b32 v60, 16, v26
    v_and_b32 v61, s45, v26
    v_and_b32 v27, s16, v27
    v_lshlrev_b32 v62, 16, v27
    v_and_b32 v63, s45, v27
    v_pk_add_f32 v[48:49], v[48:49], v[56:57]
    v_pk_add_f32 v[50:51], v[50:51], v[58:59]
    v_pk_add_f32 v[52:53], v[52:53], v[60:61]
    v_pk_add_f32 v[54:55], v[54:55], v[62:63]
    s_waitcnt vmcnt(4)
    v_lshlrev_b32 v56, 16, v28
    v_and_b32 v57, s45, v28
    v_lshlrev_b32 v58, 16, v29
    v_and_b32 v59, s45, v29
    v_and_b32 v30, s16, v30
    v_lshlrev_b32 v60, 16, v30
    v_and_b32 v61, s45, v30
    v_and_b32 v31, s16, v31
    v_lshlrev_b32 v62, 16, v31
    v_and_b32 v63, s45, v31
    v_pk_add_f32 v[48:49], v[48:49], v[56:57]
    v_pk_add_f32 v[50:51], v[50:51], v[58:59]
    v_pk_add_f32 v[52:53], v[52:53], v[60:61]
    v_pk_add_f32 v[54:55], v[54:55], v[62:63]
    s_waitcnt vmcnt(3)
    v_lshlrev_b32 v56, 16, v32
    v_and_b32 v57, s45, v32
    v_lshlrev_b32 v58, 16, v33
    v_and_b32 v59, s45, v33
    v_and_b32 v34, s16, v34
    v_lshlrev_b32 v60, 16, v34
    v_and_b32 v61, s45, v34
    v_and_b32 v35, s16, v35
    v_lshlrev_b32 v62, 16, v35
    v_and_b32 v63, s45, v35
    v_pk_add_f32 v[48:49], v[48:49], v[56:57]
    v_pk_add_f32 v[50:51], v[50:51], v[58:59]
    v_pk_add_f32 v[52:53], v[52:53], v[60:61]
    v_pk_add_f32 v[54:55], v[54:55], v[62:63]
    s_waitcnt vmcnt(2)
    v_lshlrev_b32 v56, 16, v36
    v_and_b32 v57, s45, v36
    v_lshlrev_b32 v58, 16, v37
    v_and_b32 v59, s45, v37
    v_and_b32 v38, s16, v38
    v_lshlrev_b32 v60, 16, v38
    v_and_b32 v61, s45, v38
    v_and_b32 v39, s16, v39
    v_lshlrev_b32 v62, 16, v39
    v_and_b32 v63, s45, v39
    v_pk_add_f32 v[48:49], v[48:49], v[56:57]
    v_pk_add_f32 v[50:51], v[50:51], v[58:59]
    v_pk_add_f32 v[52:53], v[52:53], v[60:61]
    v_pk_add_f32 v[54:55], v[54:55], v[62:63]
    s_waitcnt vmcnt(1)
    v_lshlrev_b32 v56, 16, v40
    v_and_b32 v57, s45, v40
    v_lshlrev_b32 v58, 16, v41
    v_and_b32 v59, s45, v41
    v_and_b32 v42, s16, v42
    v_lshlrev_b32 v60, 16, v42
    v_and_b32 v61, s45, v42
    v_and_b32 v43, s16, v43
    v_lshlrev_b32 v62, 16, v43
    v_and_b32 v63, s45, v43
    v_pk_add_f32 v[48:49], v[48:49], v[56:57]
    v_pk_add_f32 v[50:51], v[50:51], v[58:59]
    v_pk_add_f32 v[52:53], v[52:53], v[60:61]
    v_pk_add_f32 v[54:55], v[54:55], v[62:63]
    s_waitcnt vmcnt(0)
    v_lshlrev_b32 v56, 16, v44
    v_and_b32 v57, s45, v44
    v_lshlrev_b32 v58, 16, v45
    v_and_b32 v59, s45, v45
    v_and_b32 v46, s16, v46
    v_lshlrev_b32 v60, 16, v46
    v_and_b32 v61, s45, v46
    v_and_b32 v47, s16, v47
    v_lshlrev_b32 v62, 16, v47
    v_and_b32 v63, s45, v47
    v_pk_add_f32 v[48:49], v[48:49], v[56:57]
    v_pk_add_f32 v[50:51], v[50:51], v[58:59]
    v_pk_add_f32 v[52:53], v[52:53], v[60:61]
    v_pk_add_f32 v[54:55], v[54:55], v[62:63]
    v_mov_b32 v56, v48
    v_mov_b32 v57, v49
    v_mov_b32 v58, v50
    v_mov_b32 v59, v51
    v_mov_b32 v60, v52
    v_mov_b32 v61, v53
    v_mov_b32 v62, v54
    v_mov_b32 v63, v55
    s_nop 1
    v_permlane32_swap_b32 v48, v56
    v_permlane32_swap_b32 v49, v57
    v_permlane32_swap_b32 v50, v58
    v_permlane32_swap_b32 v51, v59
    v_permlane32_swap_b32 v52, v60
    v_permlane32_swap_b32 v53, v61
    v_permlane32_swap_b32 v54, v62
    v_permlane32_swap_b32 v55, v63
    s_nop 1
    v_pk_add_f32 v[48:49], v[48:49], v[56:57]
    v_pk_add_f32 v[50:51], v[50:51], v[58:59]
    v_pk_add_f32 v[52:53], v[52:53], v[60:61]
    v_pk_add_f32 v[54:55], v[54:55], v[62:63]
    v_mov_b32 v56, v48
    v_mov_b32 v57, v49
    v_mov_b32 v58, v50
    v_mov_b32 v59, v51
    v_mov_b32 v60, v52
    v_mov_b32 v61, v53
    v_mov_b32 v62, v54
    v_mov_b32 v63, v55
    s_nop 1
    v_permlane16_swap_b32 v48, v56
    v_permlane16_swap_b32 v49, v57
    v_permlane16_swap_b32 v50, v58
    v_permlane16_swap_b32 v51, v59
    v_permlane16_swap_b32 v52, v60
    v_permlane16_swap_b32 v53, v61
    v_permlane16_swap_b32 v54, v62
    v_permlane16_swap_b32 v55, v63
    s_nop 1
    v_pk_add_f32 v[48:49], v[48:49], v[56:57]
    v_pk_add_f32 v[50:51], v[50:51], v[58:59]
    v_pk_add_f32 v[52:53], v[52:53], v[60:61]
    v_pk_add_f32 v[54:55], v[54:55], v[62:63]
    v_cvt_pk_bf16_f32 v16, v48, v49
    v_cvt_pk_bf16_f32 v17, v50, v51
    v_cvt_pk_bf16_f32 v18, v52, v53
    v_cvt_pk_bf16_f32 v19, v54, v55
    v_min_u32 v16, -2, v16
    v_min_u32 v17, -2, v17
    v_min_u32 v18, -2, v18
    v_min_u32 v19, -2, v19
    s_mov_b64 exec, 0xffff
    buffer_store_dwordx4 v[16:19], v8, s[28:31], s19 offen sc1
    s_mov_b64 exec, -1
    s_mov_b64 exec, -1
k2_phase_nor:
    s_add_u32 s60, s8, 67239936
    s_addc_u32 s61, s9, 0
    s_mov_b32 s62, 24576
    s_mov_b32 s63, 0x00020000
    s_mov_b32 s84, s90
    s_mov_b32 s85, s91
    s_mov_b32 s86, 256
    s_mov_b32 s87, 0x00020000
    v_mov_b32 v12, 0
    v_lshlrev_b32 v13, 2, v2
    s_and_b32 s88, s2, 7
    s_lshl_b32 s88, s88, 3
    s_add_u32 s88, s88, s12
    s_lshl_b32 s88, s88, 7
    s_add_u32 s88, s88, 16384
    s_mov_b64 exec, 0xffffffff
k2_phase_x_f1:
    buffer_load_dword v14, v12, s[84:87], 0 offen sc1
    buffer_load_dword v15, v13, s[60:63], s88 offen sc1
    s_waitcnt vmcnt(0)
    v_cmp_ne_u32 vcc, v14, v15
    s_nop 0
    s_cbranch_vccnz k2_phase_x_f1s
    v_cmp_ne_u32 vcc, 0, v14
    s_cbranch_vccnz k2_phase_x_f1d
k2_phase_x_f1s:
    s_sleep 8
    s_branch k2_phase_x_f1
k2_phase_x_f1d:
    s_mov_b64 exec, -1
    s_barrier
    s_cmp_ge_u32 s2, 216
    s_cbranch_scc1 k2_phase_x2
    s_cmp_ge_u32 s2, 216
    s_cbranch_scc1 .Lpf_k2w1a_done
    v_lshrrev_b32 v1, 6, v0
    v_and_b32 v2, 63, v0
    s_nop 0
    v_readfirstlane_b32 s12, v1
    s_load_dwordx2 s[4:5], s[0:1], 40
    s_and_b32 s3, s2, 7
    s_sub_u32 s10, s2, 192
    s_lshr_b32 s10, s10, 3
    s_mul_i32 s10, s10, 8
    s_add_u32 s10, s10, s12
    s_mul_i32 s10, s10, 221184
    s_add_u32 s10, s10, 0
    s_mul_i32 s11, s3, 9
    s_lshr_b32 s11, s11, 1
    s_lshl_b32 s11, s11, 8
    v_add_u32 v13, 0, v2
    v_mul_u32_u24 v14, 820, v13
    v_lshrrev_b32 v14, 16, v14
    v_mul_u32_u24 v15, 80, v14
    v_sub_u32 v15, v13, v15
    v_mul_u32_u24 v14, 9216, v14
    v_lshl_add_u32 v8, v15, 4, v14
    v_add_u32 v13, 64, v2
    v_mul_u32_u24 v14, 820, v13
    v_lshrrev_b32 v14, 16, v14
    v_mul_u32_u24 v15, 80, v14
    v_sub_u32 v15, v13, v15
    v_mul_u32_u24 v14, 9216, v14
    v_lshl_add_u32 v9, v15, 4, v14
    v_add_u32 v13, 128, v2
    v_mul_u32_u24 v14, 820, v13
    v_lshrrev_b32 v14, 16, v14
    v_mul_u32_u24 v15, 80, v14
    v_sub_u32 v15, v13, v15
    v_mul_u32_u24 v14, 9216, v14
    v_lshl_add_u32 v10, v15, 4, v14
    v_add_u32 v13, 192, v2
    v_mul_u32_u24 v14, 820, v13
    v_lshrrev_b32 v14, 16, v14
    v_mul_u32_u24 v15, 80, v14
    v_sub_u32 v15, v13, v15
    v_mul_u32_u24 v14, 9216, v14
    v_lshl_add_u32 v11, v15, 4, v14
    v_add_u32 v13, 256, v2
    v_mul_u32_u24 v14, 820, v13
    v_lshrrev_b32 v14, 16, v14
    v_mul_u32_u24 v15, 80, v14
    v_sub_u32 v15, v13, v15
    v_mul_u32_u24 v14, 9216, v14
    v_lshl_add_u32 v12, v15, 4, v14
    s_add_u32 s31, s11, 4718592
    s_add_u32 s10, s10, s11
    s_mov_b32 s30, 6
    s_waitcnt lgkmcnt(0)
    s_mov_b32 s16, s4
    s_mov_b32 s17, s5
    s_mov_b32 s18, 18874368
    s_mov_b32 s19, 0x00020000
.Lpf_k2w1a_loop:
    s_cmp_ge_u32 s10, s31
    s_cbranch_scc1 .Lpf_k2w1a_done
    buffer_load_dwordx4 v[16:19], v8, s[16:19], s10 offen offset:0
    buffer_load_dwordx4 v[24:27], v9, s[16:19], s10 offen offset:0
    buffer_load_dwordx4 v[32:35], v10, s[16:19], s10 offen offset:0
    buffer_load_dwordx4 v[40:43], v11, s[16:19], s10 offen offset:0
    buffer_load_dwordx4 v[48:51], v12, s[16:19], s10 offen offset:0
    s_waitcnt vmcnt(12)
    s_add_u32 s10, s10, 36864
    s_sub_u32 s30, s30, 1
    s_cmp_lg_u32 s30, 0
    s_cbranch_scc1 .Lpf_k2w1a_loop
.Lpf_k2w1a_done:
    s_waitcnt vmcnt(0)
    s_branch g1_phase
k2_phase_x2:
    s_cmp_ge_u32 s2, 256
    s_cbranch_scc1 .Lpf_k2w1b_done
    v_lshrrev_b32 v1, 6, v0
    v_and_b32 v2, 63, v0
    s_nop 0
    v_readfirstlane_b32 s12, v1
    s_load_dwordx2 s[4:5], s[0:1], 40
    s_and_b32 s3, s2, 7
    s_sub_u32 s10, s2, 216
    s_lshr_b32 s10, s10, 3
    s_mul_i32 s10, s10, 8
    s_add_u32 s10, s10, s12
    s_mul_i32 s10, s10, 368640
    s_add_u32 s10, s10, 4718592
    s_mul_i32 s11, s3, 9
    s_lshr_b32 s11, s11, 1
    s_lshl_b32 s11, s11, 8
    v_add_u32 v13, 0, v2
    v_mul_u32_u24 v14, 820, v13
    v_lshrrev_b32 v14, 16, v14
    v_mul_u32_u24 v15, 80, v14
    v_sub_u32 v15, v13, v15
    v_mul_u32_u24 v14, 9216, v14
    v_lshl_add_u32 v8, v15, 4, v14
    v_add_u32 v13, 64, v2
    v_mul_u32_u24 v14, 820, v13
    v_lshrrev_b32 v14, 16, v14
    v_mul_u32_u24 v15, 80, v14
    v_sub_u32 v15, v13, v15
    v_mul_u32_u24 v14, 9216, v14
    v_lshl_add_u32 v9, v15, 4, v14
    v_add_u32 v13, 128, v2
    v_mul_u32_u24 v14, 820, v13
    v_lshrrev_b32 v14, 16, v14
    v_mul_u32_u24 v15, 80, v14
    v_sub_u32 v15, v13, v15
    v_mul_u32_u24 v14, 9216, v14
    v_lshl_add_u32 v10, v15, 4, v14
    v_add_u32 v13, 192, v2
    v_mul_u32_u24 v14, 820, v13
    v_lshrrev_b32 v14, 16, v14
    v_mul_u32_u24 v15, 80, v14
    v_sub_u32 v15, v13, v15
    v_mul_u32_u24 v14, 9216, v14
    v_lshl_add_u32 v11, v15, 4, v14
    v_add_u32 v13, 256, v2
    v_mul_u32_u24 v14, 820, v13
    v_lshrrev_b32 v14, 16, v14
    v_mul_u32_u24 v15, 80, v14
    v_sub_u32 v15, v13, v15
    v_mul_u32_u24 v14, 9216, v14
    v_lshl_add_u32 v12, v15, 4, v14
    s_add_u32 s31, s11, 18874368
    s_add_u32 s10, s10, s11
    s_mov_b32 s30, 10
    s_waitcnt lgkmcnt(0)
    s_mov_b32 s16, s4
    s_mov_b32 s17, s5
    s_mov_b32 s18, 18874368
    s_mov_b32 s19, 0x00020000
.Lpf_k2w1b_loop:
    s_cmp_ge_u32 s10, s31
    s_cbranch_scc1 .Lpf_k2w1b_done
    buffer_load_dwordx4 v[16:19], v8, s[16:19], s10 offen offset:0
    buffer_load_dwordx4 v[24:27], v9, s[16:19], s10 offen offset:0
    buffer_load_dwordx4 v[32:35], v10, s[16:19], s10 offen offset:0
    buffer_load_dwordx4 v[40:43], v11, s[16:19], s10 offen offset:0
    buffer_load_dwordx4 v[48:51], v12, s[16:19], s10 offen offset:0
    s_waitcnt vmcnt(12)
    s_add_u32 s10, s10, 36864
    s_sub_u32 s30, s30, 1
    s_cmp_lg_u32 s30, 0
    s_cbranch_scc1 .Lpf_k2w1b_loop
.Lpf_k2w1b_done:
    s_cmp_ge_u32 s2, 256
    s_cbranch_scc1 .Lpf_g1w2_done
    v_lshrrev_b32 v1, 6, v0
    v_and_b32 v2, 63, v0
    s_nop 0
    v_readfirstlane_b32 s12, v1
    s_load_dwordx2 s[4:5], s[0:1], 56
    s_and_b32 s3, s2, 7
    s_sub_u32 s10, s2, 216
    s_lshr_b32 s10, s10, 3
    s_mul_i32 s10, s10, 8
    s_add_u32 s10, s10, s12
    s_mul_i32 s10, s10, 118784
    s_add_u32 s10, s10, 0
    s_and_b32 s11, s3, 3
    s_mul_i32 s11, s11, 4718592
    s_lshr_b32 s3, s3, 2
    s_lshl_b32 s3, s3, 11
    s_add_u32 s11, s11, s3
    v_lshlrev_b32 v8, 4, v2
    s_add_u32 s31, s11, 4718592
    s_add_u32 s10, s10, s11
    s_mov_b32 s30, 29
    s_waitcnt lgkmcnt(0)
    s_mov_b32 s16, s4
    s_mov_b32 s17, s5
    s_mov_b32 s18, 18874368
    s_mov_b32 s19, 0x00020000
.Lpf_g1w2_loop:
    s_cmp_ge_u32 s10, s31
    s_cbranch_scc1 .Lpf_g1w2_done
    buffer_load_dwordx4 v[16:19], v8, s[16:19], s10 offen offset:0
    buffer_load_dwordx4 v[24:27], v8, s[16:19], s10 offen offset:1024
    s_waitcnt vmcnt(12)
    s_add_u32 s10, s10, 4096
    s_sub_u32 s30, s30, 1
    s_cmp_lg_u32 s30, 0
    s_cbranch_scc1 .Lpf_g1w2_loop
.Lpf_g1w2_done:
    s_waitcnt vmcnt(0)
    s_branch g2_phase
g1_phase:
    s_load_dwordx2 s[4:5], s[0:1], 40
    s_load_dwordx2 s[8:9], s[0:1], 88
    v_lshrrev_b32 v1, 6, v0
    v_and_b32 v2, 63, v0
    s_and_b32 s3, s2, 7
    v_readfirstlane_b32 s58, v1
    s_lshr_b32 s14, s2, 3
    s_mul_i32 s3, s3, 27
    s_add_u32 s3, s3, s14
    s_mul_i32 s10, s3, 43691
    s_lshr_b32 s10, s10, 18
    s_mul_i32 s11, s10, 6
    s_sub_u32 s11, s3, s11
    s_mov_b32 s46, 0
    v_lshrrev_b32 v1, 4, v2
    v_and_b32 v7, 15, v2
    v_lshlrev_b32 v3, 4, v2
    s_and_b32 s12, s58, 3
    s_cmp_lt_u32 s58, 4
    s_cbranch_scc1 g1_phase_cons
    s_setprio 0
    s_mul_i32 s51, s11, 1
    s_mul_i32 s52, s10, 1
    s_add_u32 s51, s51, s52
    s_mul_i32 s52, s51, 16385
    s_lshr_b32 s52, s52, 16
    s_mul_i32 s52, s52, 4
    s_sub_u32 s51, s51, s52
    s_mov_b32 s37, 0
    s_mul_i32 s52, s46, 32
    s_add_u32 s52, s52, s51
    v_lshlrev_b32 v8, 1, v1
    v_xor_b32 v8, v7, v8
    v_xor_b32 v9, 8, v8
    v_mul_u32_u24 v10, 9216, v1
    v_lshl_add_u32 v4, v8, 4, v10
    v_lshl_add_u32 v5, v9, 4, v10
    s_lshl_b32 s14, s52, 2
    s_add_u32 s14, s14, s12
    s_mul_i32 s14, s14, 147456
    s_lshl_b32 s15, s10, 8
    s_add_u32 s14, s14, s15
    v_add_u32 v4, s14, v4
    v_add_u32 v5, s14, v5
    s_mov_b32 s32, 0
    s_mov_b32 s33, 35840
    s_mov_b32 s34, 71680
    s_mov_b32 s35, 107520
    s_lshl_b32 s43, s12, 12
    s_add_u32 s43, s43, 12288
    s_mul_i32 s13, s11, 32
    s_add_u32 s13, s13, s52
    s_mul_i32 s13, s13, 12288
    s_mul_i32 s40, s12, 3072
    s_add_u32 s13, s13, s40
    s_mov_b32 s53, 589824
    s_mov_b32 s36, 0
    s_mov_b32 s18, 0x1200000
    s_mov_b32 s19, 0x00020000
    s_mov_b32 s22, 2359296
    s_mov_b32 s23, 0x00020000
    s_waitcnt lgkmcnt(0)
    s_mov_b32 s16, s4
    s_mov_b32 s17, s5
    s_add_u32 s20, s8, 0
    s_addc_u32 s21, s9, 0
    s_add_u32 s24, s8, 67108864
    s_addc_u32 s25, s9, 0
    s_mov_b32 s26, 65536
    s_mov_b32 s27, 0x00020000
    s_add_u32 m0, s43, s36
    s_add_u32 s15, s40, s36
    buffer_load_dwordx4 v4, s[16:19], s32 offen lds
    buffer_load_dwordx4 v5, s[16:19], s33 offen offset:1024 lds
    buffer_load_dwordx4 v4, s[16:19], s34 offen offset:2048 lds
    buffer_load_dwordx4 v5, s[16:19], s35 offen offset:3072 lds
    s_mov_b32 s84, s13
    s_add_u32 s51, s51, 1
    s_cmp_lg_u32 s51, 4
    s_cselect_b32 s44, 1, -3
    s_cselect_b32 s51, s51, 0
    s_add_u32 s37, s37, 1
    s_cmp_lg_u32 s37, 4
    s_cselect_b32 s52, 0, 4
    s_cselect_b32 s37, s37, 0
    s_add_u32 s44, s44, s52
    s_mul_i32 s52, s44, 12288
    s_mul_i32 s44, s44, s53
    v_add_u32 v4, s44, v4
    v_add_u32 v5, s44, v5
    s_add_u32 s13, s13, s52
    s_add_u32 s36, s36, 28672
    s_cmp_lg_u32 s36, 143360
    s_cselect_b32 s36, s36, 0
    s_add_u32 m0, s43, s36
    s_add_u32 s15, s40, s36
    buffer_load_dwordx4 v4, s[16:19], s32 offen lds
    buffer_load_dwordx4 v5, s[16:19], s33 offen offset:1024 lds
    buffer_load_dwordx4 v4, s[16:19], s34 offen offset:2048 lds
    buffer_load_dwordx4 v5, s[16:19], s35 offen offset:3072 lds
    s_mov_b32 s85, s13
    s_add_u32 s51, s51, 1
    s_cmp_lg_u32 s51, 4
    s_cselect_b32 s44, 1, -3
    s_cselect_b32 s51, s51, 0
    s_add_u32 s37, s37, 1
    s_cmp_lg_u32 s37, 4
    s_cselect_b32 s52, 0, 4
    s_cselect_b32 s37, s37, 0
    s_add_u32 s44, s44, s52
    s_mul_i32 s52, s44, 12288
    s_mul_i32 s44, s44, s53
    v_add_u32 v4, s44, v4
    v_add_u32 v5, s44, v5
    s_add_u32 s13, s13, s52
    s_add_u32 s36, s36, 28672
    s_cmp_lg_u32 s36, 143360
    s_cselect_b32 s36, s36, 0
    s_add_u32 m0, s43, s36
    s_add_u32 s15, s40, s36
    buffer_load_dwordx4 v4, s[16:19], s32 offen lds
    buffer_load_dwordx4 v5, s[16:19], s33 offen offset:1024 lds
    buffer_load_dwordx4 v4, s[16:19], s34 offen offset:2048 lds
    buffer_load_dwordx4 v5, s[16:19], s35 offen offset:3072 lds
    s_mov_b32 s86, s13
    s_add_u32 s51, s51, 1
    s_cmp_lg_u32 s51, 4
    s_cselect_b32 s44, 1, -3
    s_cselect_b32 s51, s51, 0
    s_add_u32 s37, s37, 1
    s_cmp_lg_u32 s37, 4
    s_cselect_b32 s52, 0, 4
    s_cselect_b32 s37, s37, 0
    s_add_u32 s44, s44, s52
    s_mul_i32 s52, s44, 12288
    s_mul_i32 s44, s44, s53
    v_add_u32 v4, s44, v4
    v_add_u32 v5, s44, v5
    s_add_u32 s13, s13, s52
    s_add_u32 s36, s36, 28672
    s_cmp_lg_u32 s36, 143360
    s_cselect_b32 s36, s36, 0
    s_add_u32 m0, s43, s36
    s_add_u32 s15, s40, s36
    buffer_load_dwordx4 v4, s[16:19], s32 offen lds
    buffer_load_dwordx4 v5, s[16:19], s33 offen offset:1024 lds
    buffer_load_dwordx4 v4, s[16:19], s34 offen offset:2048 lds
    buffer_load_dwordx4 v5, s[16:19], s35 offen offset:3072 lds
    s_mov_b32 s87, s13
    s_add_u32 s51, s51, 1
    s_cmp_lg_u32 s51, 4
    s_cselect_b32 s44, 1, -3
    s_cselect_b32 s51, s51, 0
    s_add_u32 s37, s37, 1
    s_cmp_lg_u32 s37, 4
    s_cselect_b32 s52, 0, 4
    s_cselect_b32 s37, s37, 0
    s_add_u32 s44, s44, s52
    s_mul_i32 s52, s44, 12288
    s_mul_i32 s44, s44, s53
    v_add_u32 v4, s44, v4
    v_add_u32 v5, s44, v5
    s_add_u32 s13, s13, s52
    s_add_u32 s36, s36, 28672
    s_cmp_lg_u32 s36, 143360
    s_cselect_b32 s36, s36, 0
    s_add_u32 m0, s43, s36
    s_add_u32 s15, s40, s36
    buffer_load_dwordx4 v4, s[16:19], s32 offen lds
    buffer_load_dwordx4 v5, s[16:19], s33 offen offset:1024 lds
    buffer_load_dwordx4 v4, s[16:19], s34 offen offset:2048 lds
    buffer_load_dwordx4 v5, s[16:19], s35 offen offset:3072 lds
    s_mov_b32 s88, s13
    s_add_u32 s51, s51, 1
    s_cmp_lg_u32 s51, 4
    s_cselect_b32 s44, 1, -3
    s_cselect_b32 s51, s51, 0
    s_add_u32 s37, s37, 1
    s_cmp_lg_u32 s37, 4
    s_cselect_b32 s52, 0, 4
    s_cselect_b32 s37, s37, 0
    s_add_u32 s44, s44, s52
    s_mul_i32 s52, s44, 12288
    s_mul_i32 s44, s44, s53
    v_add_u32 v4, s44, v4
    v_add_u32 v5, s44, v5
    s_add_u32 s13, s13, s52
    s_add_u32 s36, s36, 28672
    s_cmp_lg_u32 s36, 143360
    s_cselect_b32 s36, s36, 0
    s_and_b32 s3, s2, 7
    s_lshr_b32 s14, s11, 1
    s_lshl_b32 s14, s14, 3
    s_add_u32 s14, s14, s3
    s_lshl_b32 s14, s14, 7
    s_add_u32 s14, s14, 0
    v_mov_b32 v8, 0
    s_mov_b64 exec, 3
g1_phase_dp_10:
    buffer_load_dword v9, v8, s[24:27], s14 offen sc1
    s_waitcnt vmcnt(0)
    v_cmp_gt_u32 vcc, 64, v9
    s_cbranch_vccz g1_phase_dd_11
    s_sleep 2
    s_branch g1_phase_dp_10
g1_phase_dd_11:
    s_mov_b64 exec, -1
    s_add_u32 m0, s40, 0
    s_nop 0
    buffer_load_dwordx4 v3, s[20:23], s84 offen offset:0 sc1 lds
    buffer_load_dwordx4 v3, s[20:23], s84 offen offset:1024 sc1 lds
    buffer_load_dwordx4 v3, s[20:23], s84 offen offset:2048 sc1 lds
    s_add_u32 m0, s40, 28672
    s_nop 0
    buffer_load_dwordx4 v3, s[20:23], s85 offen offset:0 sc1 lds
    buffer_load_dwordx4 v3, s[20:23], s85 offen offset:1024 sc1 lds
    buffer_load_dwordx4 v3, s[20:23], s85 offen offset:2048 sc1 lds
    s_waitcnt vmcnt(3)
    s_barrier
    s_add_u32 m0, s40, 57344
    s_nop 0
    buffer_load_dwordx4 v3, s[20:23], s86 offen offset:0 sc1 lds
    buffer_load_dwordx4 v3, s[20:23], s86 offen offset:1024 sc1 lds
    buffer_load_dwordx4 v3, s[20:23], s86 offen offset:2048 sc1 lds
    s_add_u32 m0, s40, 86016
    s_nop 0
    buffer_load_dwordx4 v3, s[20:23], s87 offen offset:0 sc1 lds
    buffer_load_dwordx4 v3, s[20:23], s87 offen offset:1024 sc1 lds
    buffer_load_dwordx4 v3, s[20:23], s87 offen offset:2048 sc1 lds
    s_add_u32 m0, s40, 114688
    s_nop 0
    buffer_load_dwordx4 v3, s[20:23], s88 offen offset:0 sc1 lds
    buffer_load_dwordx4 v3, s[20:23], s88 offen offset:1024 sc1 lds
    buffer_load_dwordx4 v3, s[20:23], s88 offen offset:2048 sc1 lds
    s_waitcnt vmcnt(9)
    s_barrier
    s_add_u32 m0, s43, s36
    s_add_u32 s15, s40, s36
    buffer_load_dwordx4 v4, s[16:19], s32 offen lds
    buffer_load_dwordx4 v5, s[16:19], s33 offen offset:1024 lds
    buffer_load_dwordx4 v4, s[16:19], s34 offen offset:2048 lds
    buffer_load_dwordx4 v5, s[16:19], s35 offen offset:3072 lds
    s_mov_b32 m0, s15
    s_nop 0
    buffer_load_dwordx4 v3, s[20:23], s13 offen offset:0 sc1 lds
    buffer_load_dwordx4 v3, s[20:23], s13 offen offset:1024 sc1 lds
    buffer_load_dwordx4 v3, s[20:23], s13 offen offset:2048 sc1 lds
    s_add_u32 s51, s51, 1
    s_cmp_lg_u32 s51, 4
    s_cselect_b32 s44, 1, -3
    s_cselect_b32 s51, s51, 0
    s_add_u32 s37, s37, 1
    s_cmp_lg_u32 s37, 4
    s_cselect_b32 s52, 0, 4
    s_cselect_b32 s37, s37, 0
    s_add_u32 s44, s44, s52
    s_mul_i32 s52, s44, 12288
    s_mul_i32 s44, s44, s53
    v_add_u32 v4, s44, v4
    v_add_u32 v5, s44, v5
    s_add_u32 s13, s13, s52
    s_add_u32 s36, s36, 28672
    s_cmp_lg_u32 s36, 143360
    s_cselect_b32 s36, s36, 0
    s_waitcnt vmcnt(13)
    s_barrier
    s_add_u32 m0, s43, s36
    s_add_u32 s15, s40, s36
    buffer_load_dwordx4 v4, s[16:19], s32 offen lds
    buffer_load_dwordx4 v5, s[16:19], s33 offen offset:1024 lds
    buffer_load_dwordx4 v4, s[16:19], s34 offen offset:2048 lds
    buffer_load_dwordx4 v5, s[16:19], s35 offen offset:3072 lds
    s_mov_b32 m0, s15
    s_nop 0
    buffer_load_dwordx4 v3, s[20:23], s13 offen offset:0 sc1 lds
    buffer_load_dwordx4 v3, s[20:23], s13 offen offset:1024 sc1 lds
    buffer_load_dwordx4 v3, s[20:23], s13 offen offset:2048 sc1 lds
    s_add_u32 s51, s51, 1
    s_cmp_lg_u32 s51, 4
    s_cselect_b32 s44, 1, -3
    s_cselect_b32 s51, s51, 0
    s_add_u32 s37, s37, 1
    s_cmp_lg_u32 s37, 4
    s_cselect_b32 s52, 0, 4
    s_cselect_b32 s37, s37, 0
    s_add_u32 s44, s44, s52
    s_mul_i32 s52, s44, 12288
    s_mul_i32 s44, s44, s53
    v_add_u32 v4, s44, v4
    v_add_u32 v5, s44, v5
    s_add_u32 s13, s13, s52
    s_add_u32 s36, s36, 28672
    s_cmp_lg_u32 s36, 143360
    s_cselect_b32 s36, s36, 0
    s_waitcnt vmcnt(17)
    s_barrier
    s_add_u32 m0, s43, s36
    s_add_u32 s15, s40, s36
    buffer_load_dwordx4 v4, s[16:19], s32 offen lds
    buffer_load_dwordx4 v5, s[16:19], s33 offen offset:1024 lds
    buffer_load_dwordx4 v4, s[16:19], s34 offen offset:2048 lds
    buffer_load_dwordx4 v5, s[16:19], s35 offen offset:3072 lds
    s_mov_b32 m0, s15
    s_nop 0
    buffer_load_dwordx4 v3, s[20:23], s13 offen offset:0 sc1 lds
    buffer_load_dwordx4 v3, s[20:23], s13 offen offset:1024 sc1 lds
    buffer_load_dwordx4 v3, s[20:23], s13 offen offset:2048 sc1 lds
    s_add_u32 s51, s51, 1
    s_cmp_lg_u32 s51, 4
    s_cselect_b32 s44, 1, -3
    s_cselect_b32 s51, s51, 0
    s_add_u32 s37, s37, 1
    s_cmp_lg_u32 s37, 4
    s_cselect_b32 s52, 0, 4
    s_cselect_b32 s37, s37, 0
    s_add_u32 s44, s44, s52
    s_mul_i32 s52, s44, 12288
    s_mul_i32 s44, s44, s53
    v_add_u32 v4, s44, v4
    v_add_u32 v5, s44, v5
    s_add_u32 s13, s13, s52
    s_add_u32 s36, s36, 28672
    s_cmp_lg_u32 s36, 143360
    s_cselect_b32 s36, s36, 0
    s_waitcnt vmcnt(21)
    s_barrier
    s_add_u32 m0, s43, s36
    s_add_u32 s15, s40, s36
    buffer_load_dwordx4 v4, s[16:19], s32 offen lds
    buffer_load_dwordx4 v5, s[16:19], s33 offen offset:1024 lds
    buffer_load_dwordx4 v4, s[16:19], s34 offen offset:2048 lds
    buffer_load_dwordx4 v5, s[16:19], s35 offen offset:3072 lds
    s_mov_b32 m0, s15
    s_nop 0
    buffer_load_dwordx4 v3, s[20:23], s13 offen offset:0 sc1 lds
    buffer_load_dwordx4 v3, s[20:23], s13 offen offset:1024 sc1 lds
    buffer_load_dwordx4 v3, s[20:23], s13 offen offset:2048 sc1 lds
    s_add_u32 s51, s51, 1
    s_cmp_lg_u32 s51, 4
    s_cselect_b32 s44, 1, -3
    s_cselect_b32 s51, s51, 0
    s_add_u32 s37, s37, 1
    s_cmp_lg_u32 s37, 4
    s_cselect_b32 s52, 0, 4
    s_cselect_b32 s37, s37, 0
    s_add_u32 s44, s44, s52
    s_mul_i32 s52, s44, 12288
    s_mul_i32 s44, s44, s53
    v_add_u32 v4, s44, v4
    v_add_u32 v5, s44, v5
    s_add_u32 s13, s13, s52
    s_add_u32 s36, s36, 28672
    s_cmp_lg_u32 s36, 143360
    s_cselect_b32 s36, s36, 0
    s_mov_b32 s45, 9
g1_phase_ll_12:
    s_waitcnt vmcnt(21)
    s_barrier
    s_add_u32 m0, s43, s36
    s_add_u32 s15, s40, s36
    buffer_load_dwordx4 v4, s[16:19], s32 offen lds
    buffer_load_dwordx4 v5, s[16:19], s33 offen offset:1024 lds
    buffer_load_dwordx4 v4, s[16:19], s34 offen offset:2048 lds
    buffer_load_dwordx4 v5, s[16:19], s35 offen offset:3072 lds
    s_mov_b32 m0, s15
    s_nop 0
    buffer_load_dwordx4 v3, s[20:23], s13 offen offset:0 sc1 lds
    buffer_load_dwordx4 v3, s[20:23], s13 offen offset:1024 sc1 lds
    buffer_load_dwordx4 v3, s[20:23], s13 offen offset:2048 sc1 lds
    s_add_u32 s51, s51, 1
    s_cmp_lg_u32 s51, 4
    s_cselect_b32 s44, 1, -3
    s_cselect_b32 s51, s51, 0
    s_add_u32 s37, s37, 1
    s_cmp_lg_u32 s37, 4
    s_cselect_b32 s52, 0, 4
    s_cselect_b32 s37, s37, 0
    s_add_u32 s44, s44, s52
    s_mul_i32 s52, s44, 12288
    s_mul_i32 s44, s44, s53
    v_add_u32 v4, s44, v4
    v_add_u32 v5, s44, v5
    s_add_u32 s13, s13, s52
    s_add_u32 s36, s36, 28672
    s_cmp_lg_u32 s36, 143360
    s_cselect_b32 s36, s36, 0
    s_add_u32 s45, s45, 1
    s_cmp_lt_u32 s45, 32
    s_cbranch_scc1 g1_phase_ll_12
    s_waitcnt vmcnt(21)
    s_barrier
    s_waitcnt vmcnt(14)
    s_barrier
    s_waitcnt vmcnt(7)
    s_barrier
    s_waitcnt vmcnt(0)
    s_barrier
    s_barrier
    s_mov_b64 exec, -1
    s_branch g2_phase
g1_phase_cons:
    s_setprio 0
    s_load_dwordx2 s[6:7], s[0:1], 48
    s_load_dwordx2 s[56:57], s[0:1], 72
    s_lshr_b32 s47, s12, 1
    s_and_b32 s48, s12, 1
    s_mul_i32 s14, s47, 3072
    v_add_u32 v6, s14, v3
    v_lshrrev_b32 v136, 2, v2
    v_and_b32 v137, 7, v136
    v_lshlrev_b32 v137, 5, v137
    v_lshl_add_u32 v137, v136, 8, v137
    v_and_b32 v138, 3, v2
    v_lshl_add_u32 v137, v138, 3, v137
    s_mul_i32 s14, s48, 4
    s_add_u32 s15, s14, 0
    s_lshl_b32 s15, s15, 5
    v_xor_b32 v8, s15, v137
    s_add_u32 s15, s14, 1
    s_lshl_b32 s15, s15, 5
    v_xor_b32 v9, s15, v137
    s_add_u32 s15, s14, 2
    s_lshl_b32 s15, s15, 5
    v_xor_b32 v10, s15, v137
    s_add_u32 s15, s14, 3
    s_lshl_b32 s15, s15, 5
    v_xor_b32 v11, s15, v137
    v_add_u32 v144, 65536, v6
    v_add_u32 v145, 65536, v8
    v_add_u32 v146, 65536, v9
    v_add_u32 v147, 65536, v10
    v_add_u32 v148, 65536, v11
    v_add_u32 v149, 131072, v6
    v_add_u32 v150, 131072, v8
    v_add_u32 v151, 131072, v9
    v_add_u32 v152, 131072, v10
    v_add_u32 v153, 131072, v11
    v_pk_mov_b32 v[88:89], 0, 0
    v_pk_mov_b32 v[90:91], 0, 0
    v_pk_mov_b32 v[92:93], 0, 0
    v_pk_mov_b32 v[94:95], 0, 0
    v_pk_mov_b32 v[96:97], 0, 0
    v_pk_mov_b32 v[98:99], 0, 0
    v_pk_mov_b32 v[100:101], 0, 0
    v_pk_mov_b32 v[102:103], 0, 0
    v_pk_mov_b32 v[104:105], 0, 0
    v_pk_mov_b32 v[106:107], 0, 0
    v_pk_mov_b32 v[108:109], 0, 0
    v_pk_mov_b32 v[110:111], 0, 0
    v_pk_mov_b32 v[112:113], 0, 0
    v_pk_mov_b32 v[114:115], 0, 0
    v_pk_mov_b32 v[116:117], 0, 0
    v_pk_mov_b32 v[118:119], 0, 0
    v_pk_mov_b32 v[120:121], 0, 0
    v_pk_mov_b32 v[122:123], 0, 0
    v_pk_mov_b32 v[124:125], 0, 0
    v_pk_mov_b32 v[126:127], 0, 0
    v_pk_mov_b32 v[128:129], 0, 0
    v_pk_mov_b32 v[130:131], 0, 0
    v_pk_mov_b32 v[132:133], 0, 0
    v_pk_mov_b32 v[134:135], 0, 0
    s_mov_b32 s45, 0xffff0000
    s_waitcnt lgkmcnt(0)
    s_mov_b32 s28, s6
    s_mov_b32 s29, s7
    s_mov_b32 s30, 9216
    s_mov_b32 s31, 0x00020000
    s_add_u32 s24, s8, 4194304
    s_addc_u32 s25, s9, 0
    s_mov_b32 s26, 5308416
    s_mov_b32 s27, 0x00020000
    v_lshlrev_b32 v136, 3, v1
    s_lshl_b32 s14, s10, 8
    s_lshl_b32 s15, s48, 7
    s_add_u32 s14, s14, s15
    buffer_load_dwordx2 v[12:13], v136, s[28:31], s14 offen offset:0
    buffer_load_dwordx2 v[14:15], v136, s[28:31], s14 offen offset:32
    buffer_load_dwordx2 v[16:17], v136, s[28:31], s14 offen offset:64
    buffer_load_dwordx2 v[18:19], v136, s[28:31], s14 offen offset:96
    s_lshl_b32 s15, s10, 2
    s_lshl_b32 s36, s48, 1
    s_add_u32 s15, s15, s36
    s_mul_i32 s36, s15, 9
    s_mul_i32 s14, s11, 6
    s_mul_i32 s15, s47, 3
    s_add_u32 s14, s14, s15
    s_add_u32 s37, s14, 0
    s_mul_i32 s15, s37, 7282
    s_lshr_b32 s15, s15, 16
    s_mul_i32 s15, s15, 1287
    s_add_u32 s37, s37, s15
    s_add_u32 s37, s37, s36
    s_lshl_b32 s32, s37, 10
    s_add_u32 s33, s32, 9216
    s_add_u32 s37, s14, 1
    s_mul_i32 s15, s37, 7282
    s_lshr_b32 s15, s15, 16
    s_mul_i32 s15, s15, 1287
    s_add_u32 s37, s37, s15
    s_add_u32 s37, s37, s36
    s_lshl_b32 s34, s37, 10
    s_add_u32 s35, s34, 9216
    s_add_u32 s37, s14, 2
    s_mul_i32 s15, s37, 7282
    s_lshr_b32 s15, s15, 16
    s_mul_i32 s15, s15, 1287
    s_add_u32 s37, s37, s15
    s_add_u32 s37, s37, s36
    s_lshl_b32 s36, s37, 10
    s_add_u32 s37, s36, 9216
    s_barrier
    ds_read_b64_tr_b16 v[44:45], v8 offset:12288
    ds_read_b64_tr_b16 v[46:47], v8 offset:16384
    ds_read_b128 v[32:35], v6 offset:0
    ds_read_b128 v[36:39], v6 offset:1024
    ds_read_b128 v[40:43], v6 offset:2048
    ds_read_b64_tr_b16 v[48:49], v9 offset:12288
    ds_read_b64_tr_b16 v[50:51], v9 offset:16384
    ds_read_b64_tr_b16 v[52:53], v10 offset:12288
    ds_read_b64_tr_b16 v[54:55], v10 offset:16384
    ds_read_b64_tr_b16 v[56:57], v11 offset:12288
    ds_read_b64_tr_b16 v[58:59], v11 offset:16384
    s_mov_b32 s59, 0
g1_phase_loop_13:
    s_waitcnt lgkmcnt(0)
    v_mfma_f32_16x16x32_bf16 v[88:91], v[44:47], v[32:35], v[88:91]
    ds_read_b64_tr_b16 v[72:73], v8 offset:20480
    ds_read_b64_tr_b16 v[74:75], v8 offset:24576
    v_mfma_f32_16x16x32_bf16 v[92:95], v[44:47], v[36:39], v[92:95]
    ds_read_b128 v[60:63], v6 offset:6144
    ds_read_b128 v[64:67], v6 offset:7168
    v_mfma_f32_16x16x32_bf16 v[96:99], v[44:47], v[40:43], v[96:99]
    ds_read_b128 v[68:71], v6 offset:8192
    ds_read_b64_tr_b16 v[76:77], v9 offset:20480
    v_mfma_f32_16x16x32_bf16 v[100:103], v[48:51], v[32:35], v[100:103]
    ds_read_b64_tr_b16 v[78:79], v9 offset:24576
    ds_read_b64_tr_b16 v[80:81], v10 offset:20480
    v_mfma_f32_16x16x32_bf16 v[104:107], v[48:51], v[36:39], v[104:107]
    ds_read_b64_tr_b16 v[82:83], v10 offset:24576
    ds_read_b64_tr_b16 v[84:85], v11 offset:20480
    v_mfma_f32_16x16x32_bf16 v[108:111], v[48:51], v[40:43], v[108:111]
    ds_read_b64_tr_b16 v[86:87], v11 offset:24576
    v_mfma_f32_16x16x32_bf16 v[112:115], v[52:55], v[32:35], v[112:115]
    v_mfma_f32_16x16x32_bf16 v[116:119], v[52:55], v[36:39], v[116:119]
    v_mfma_f32_16x16x32_bf16 v[120:123], v[52:55], v[40:43], v[120:123]
    v_mfma_f32_16x16x32_bf16 v[124:127], v[56:59], v[32:35], v[124:127]
    v_mfma_f32_16x16x32_bf16 v[128:131], v[56:59], v[36:39], v[128:131]
    v_mfma_f32_16x16x32_bf16 v[132:135], v[56:59], v[40:43], v[132:135]
    s_waitcnt lgkmcnt(0)
    s_barrier
    v_mfma_f32_16x16x32_bf16 v[88:91], v[72:75], v[60:63], v[88:91]
    ds_read_b64_tr_b16 v[44:45], v8 offset:40960
    ds_read_b64_tr_b16 v[46:47], v8 offset:45056
    v_mfma_f32_16x16x32_bf16 v[92:95], v[72:75], v[64:67], v[92:95]
    ds_read_b128 v[32:35], v6 offset:28672
    ds_read_b128 v[36:39], v6 offset:29696
    v_mfma_f32_16x16x32_bf16 v[96:99], v[72:75], v[68:71], v[96:99]
    ds_read_b128 v[40:43], v6 offset:30720
    ds_read_b64_tr_b16 v[48:49], v9 offset:40960
    v_mfma_f32_16x16x32_bf16 v[100:103], v[76:79], v[60:63], v[100:103]
    ds_read_b64_tr_b16 v[50:51], v9 offset:45056
    ds_read_b64_tr_b16 v[52:53], v10 offset:40960
    v_mfma_f32_16x16x32_bf16 v[104:107], v[76:79], v[64:67], v[104:107]
    ds_read_b64_tr_b16 v[54:55], v10 offset:45056
    ds_read_b64_tr_b16 v[56:57], v11 offset:40960
    v_mfma_f32_16x16x32_bf16 v[108:111], v[76:79], v[68:71], v[108:111]
    ds_read_b64_tr_b16 v[58:59], v11 offset:45056
    v_mfma_f32_16x16x32_bf16 v[112:115], v[80:83], v[60:63], v[112:115]
    v_mfma_f32_16x16x32_bf16 v[116:119], v[80:83], v[64:67], v[116:119]
    v_mfma_f32_16x16x32_bf16 v[120:123], v[80:83], v[68:71], v[120:123]
    v_mfma_f32_16x16x32_bf16 v[124:127], v[84:87], v[60:63], v[124:127]
    v_mfma_f32_16x16x32_bf16 v[128:131], v[84:87], v[64:67], v[128:131]
    v_mfma_f32_16x16x32_bf16 v[132:135], v[84:87], v[68:71], v[132:135]
    s_waitcnt lgkmcnt(0)
    v_mfma_f32_16x16x32_bf16 v[88:91], v[44:47], v[32:35], v[88:91]
    ds_read_b64_tr_b16 v[72:73], v8 offset:49152
    ds_read_b64_tr_b16 v[74:75], v8 offset:53248
    v_mfma_f32_16x16x32_bf16 v[92:95], v[44:47], v[36:39], v[92:95]
    ds_read_b128 v[60:63], v6 offset:34816
    ds_read_b128 v[64:67], v6 offset:35840
    v_mfma_f32_16x16x32_bf16 v[96:99], v[44:47], v[40:43], v[96:99]
    ds_read_b128 v[68:71], v6 offset:36864
    ds_read_b64_tr_b16 v[76:77], v9 offset:49152
    v_mfma_f32_16x16x32_bf16 v[100:103], v[48:51], v[32:35], v[100:103]
    ds_read_b64_tr_b16 v[78:79], v9 offset:53248
    ds_read_b64_tr_b16 v[80:81], v10 offset:49152
    v_mfma_f32_16x16x32_bf16 v[104:107], v[48:51], v[36:39], v[104:107]
    ds_read_b64_tr_b16 v[82:83], v10 offset:53248
    ds_read_b64_tr_b16 v[84:85], v11 offset:49152
    v_mfma_f32_16x16x32_bf16 v[108:111], v[48:51], v[40:43], v[108:111]
    ds_read_b64_tr_b16 v[86:87], v11 offset:53248
    v_mfma_f32_16x16x32_bf16 v[112:115], v[52:55], v[32:35], v[112:115]
    v_mfma_f32_16x16x32_bf16 v[116:119], v[52:55], v[36:39], v[116:119]
    v_mfma_f32_16x16x32_bf16 v[120:123], v[52:55], v[40:43], v[120:123]
    v_mfma_f32_16x16x32_bf16 v[124:127], v[56:59], v[32:35], v[124:127]
    v_mfma_f32_16x16x32_bf16 v[128:131], v[56:59], v[36:39], v[128:131]
    v_mfma_f32_16x16x32_bf16 v[132:135], v[56:59], v[40:43], v[132:135]
    s_waitcnt lgkmcnt(0)
    s_barrier
    v_mfma_f32_16x16x32_bf16 v[88:91], v[72:75], v[60:63], v[88:91]
    ds_read_b64_tr_b16 v[44:45], v145 offset:4096
    ds_read_b64_tr_b16 v[46:47], v145 offset:8192
    v_mfma_f32_16x16x32_bf16 v[92:95], v[72:75], v[64:67], v[92:95]
    ds_read_b128 v[32:35], v6 offset:57344
    ds_read_b128 v[36:39], v6 offset:58368
    v_mfma_f32_16x16x32_bf16 v[96:99], v[72:75], v[68:71], v[96:99]
    ds_read_b128 v[40:43], v6 offset:59392
    ds_read_b64_tr_b16 v[48:49], v146 offset:4096
    v_mfma_f32_16x16x32_bf16 v[100:103], v[76:79], v[60:63], v[100:103]
    ds_read_b64_tr_b16 v[50:51], v146 offset:8192
    ds_read_b64_tr_b16 v[52:53], v147 offset:4096
    v_mfma_f32_16x16x32_bf16 v[104:107], v[76:79], v[64:67], v[104:107]
    ds_read_b64_tr_b16 v[54:55], v147 offset:8192
    ds_read_b64_tr_b16 v[56:57], v148 offset:4096
    v_mfma_f32_16x16x32_bf16 v[108:111], v[76:79], v[68:71], v[108:111]
    ds_read_b64_tr_b16 v[58:59], v148 offset:8192
    v_mfma_f32_16x16x32_bf16 v[112:115], v[80:83], v[60:63], v[112:115]
    v_mfma_f32_16x16x32_bf16 v[116:119], v[80:83], v[64:67], v[116:119]
    v_mfma_f32_16x16x32_bf16 v[120:123], v[80:83], v[68:71], v[120:123]
    v_mfma_f32_16x16x32_bf16 v[124:127], v[84:87], v[60:63], v[124:127]
    v_mfma_f32_16x16x32_bf16 v[128:131], v[84:87], v[64:67], v[128:131]
    v_mfma_f32_16x16x32_bf16 v[132:135], v[84:87], v[68:71], v[132:135]
    s_waitcnt lgkmcnt(0)
    v_mfma_f32_16x16x32_bf16 v[88:91], v[44:47], v[32:35], v[88:91]
    ds_read_b64_tr_b16 v[72:73], v145 offset:12288
    ds_read_b64_tr_b16 v[74:75], v145 offset:16384
    v_mfma_f32_16x16x32_bf16 v[92:95], v[44:47], v[36:39], v[92:95]
    ds_read_b128 v[60:63], v6 offset:63488
    ds_read_b128 v[64:67], v6 offset:64512
    v_mfma_f32_16x16x32_bf16 v[96:99], v[44:47], v[40:43], v[96:99]
    ds_read_b128 v[68:71], v144 offset:0
    ds_read_b64_tr_b16 v[76:77], v146 offset:12288
    v_mfma_f32_16x16x32_bf16 v[100:103], v[48:51], v[32:35], v[100:103]
    ds_read_b64_tr_b16 v[78:79], v146 offset:16384
    ds_read_b64_tr_b16 v[80:81], v147 offset:12288
    v_mfma_f32_16x16x32_bf16 v[104:107], v[48:51], v[36:39], v[104:107]
    ds_read_b64_tr_b16 v[82:83], v147 offset:16384
    ds_read_b64_tr_b16 v[84:85], v148 offset:12288
    v_mfma_f32_16x16x32_bf16 v[108:111], v[48:51], v[40:43], v[108:111]
    ds_read_b64_tr_b16 v[86:87], v148 offset:16384
    v_mfma_f32_16x16x32_bf16 v[112:115], v[52:55], v[32:35], v[112:115]
    v_mfma_f32_16x16x32_bf16 v[116:119], v[52:55], v[36:39], v[116:119]
    v_mfma_f32_16x16x32_bf16 v[120:123], v[52:55], v[40:43], v[120:123]
    v_mfma_f32_16x16x32_bf16 v[124:127], v[56:59], v[32:35], v[124:127]
    v_mfma_f32_16x16x32_bf16 v[128:131], v[56:59], v[36:39], v[128:131]
    v_mfma_f32_16x16x32_bf16 v[132:135], v[56:59], v[40:43], v[132:135]
    s_waitcnt lgkmcnt(0)
    s_barrier
    v_mfma_f32_16x16x32_bf16 v[88:91], v[72:75], v[60:63], v[88:91]
    ds_read_b64_tr_b16 v[44:45], v145 offset:32768
    ds_read_b64_tr_b16 v[46:47], v145 offset:36864
    v_mfma_f32_16x16x32_bf16 v[92:95], v[72:75], v[64:67], v[92:95]
    ds_read_b128 v[32:35], v144 offset:20480
    ds_read_b128 v[36:39], v144 offset:21504
    v_mfma_f32_16x16x32_bf16 v[96:99], v[72:75], v[68:71], v[96:99]
    ds_read_b128 v[40:43], v144 offset:22528
    ds_read_b64_tr_b16 v[48:49], v146 offset:32768
    v_mfma_f32_16x16x32_bf16 v[100:103], v[76:79], v[60:63], v[100:103]
    ds_read_b64_tr_b16 v[50:51], v146 offset:36864
    ds_read_b64_tr_b16 v[52:53], v147 offset:32768
    v_mfma_f32_16x16x32_bf16 v[104:107], v[76:79], v[64:67], v[104:107]
    ds_read_b64_tr_b16 v[54:55], v147 offset:36864
    ds_read_b64_tr_b16 v[56:57], v148 offset:32768
    v_mfma_f32_16x16x32_bf16 v[108:111], v[76:79], v[68:71], v[108:111]
    ds_read_b64_tr_b16 v[58:59], v148 offset:36864
    v_mfma_f32_16x16x32_bf16 v[112:115], v[80:83], v[60:63], v[112:115]
    v_mfma_f32_16x16x32_bf16 v[116:119], v[80:83], v[64:67], v[116:119]
    v_mfma_f32_16x16x32_bf16 v[120:123], v[80:83], v[68:71], v[120:123]
    v_mfma_f32_16x16x32_bf16 v[124:127], v[84:87], v[60:63], v[124:127]
    v_mfma_f32_16x16x32_bf16 v[128:131], v[84:87], v[64:67], v[128:131]
    v_mfma_f32_16x16x32_bf16 v[132:135], v[84:87], v[68:71], v[132:135]
    s_waitcnt lgkmcnt(0)
    v_mfma_f32_16x16x32_bf16 v[88:91], v[44:47], v[32:35], v[88:91]
    ds_read_b64_tr_b16 v[72:73], v145 offset:40960
    ds_read_b64_tr_b16 v[74:75], v145 offset:45056
    v_mfma_f32_16x16x32_bf16 v[92:95], v[44:47], v[36:39], v[92:95]
    ds_read_b128 v[60:63], v144 offset:26624
    ds_read_b128 v[64:67], v144 offset:27648
    v_mfma_f32_16x16x32_bf16 v[96:99], v[44:47], v[40:43], v[96:99]
    ds_read_b128 v[68:71], v144 offset:28672
    ds_read_b64_tr_b16 v[76:77], v146 offset:40960
    v_mfma_f32_16x16x32_bf16 v[100:103], v[48:51], v[32:35], v[100:103]
    ds_read_b64_tr_b16 v[78:79], v146 offset:45056
    ds_read_b64_tr_b16 v[80:81], v147 offset:40960
    v_mfma_f32_16x16x32_bf16 v[104:107], v[48:51], v[36:39], v[104:107]
    ds_read_b64_tr_b16 v[82:83], v147 offset:45056
    ds_read_b64_tr_b16 v[84:85], v148 offset:40960
    v_mfma_f32_16x16x32_bf16 v[108:111], v[48:51], v[40:43], v[108:111]
    ds_read_b64_tr_b16 v[86:87], v148 offset:45056
    v_mfma_f32_16x16x32_bf16 v[112:115], v[52:55], v[32:35], v[112:115]
    v_mfma_f32_16x16x32_bf16 v[116:119], v[52:55], v[36:39], v[116:119]
    v_mfma_f32_16x16x32_bf16 v[120:123], v[52:55], v[40:43], v[120:123]
    v_mfma_f32_16x16x32_bf16 v[124:127], v[56:59], v[32:35], v[124:127]
    v_mfma_f32_16x16x32_bf16 v[128:131], v[56:59], v[36:39], v[128:131]
    v_mfma_f32_16x16x32_bf16 v[132:135], v[56:59], v[40:43], v[132:135]
    s_waitcnt lgkmcnt(0)
    s_barrier
    v_mfma_f32_16x16x32_bf16 v[88:91], v[72:75], v[60:63], v[88:91]
    ds_read_b64_tr_b16 v[44:45], v145 offset:61440
    ds_read_b64_tr_b16 v[46:47], v150 offset:0
    v_mfma_f32_16x16x32_bf16 v[92:95], v[72:75], v[64:67], v[92:95]
    ds_read_b128 v[32:35], v144 offset:49152
    ds_read_b128 v[36:39], v144 offset:50176
    v_mfma_f32_16x16x32_bf16 v[96:99], v[72:75], v[68:71], v[96:99]
    ds_read_b128 v[40:43], v144 offset:51200
    ds_read_b64_tr_b16 v[48:49], v146 offset:61440
    v_mfma_f32_16x16x32_bf16 v[100:103], v[76:79], v[60:63], v[100:103]
    ds_read_b64_tr_b16 v[50:51], v151 offset:0
    ds_read_b64_tr_b16 v[52:53], v147 offset:61440
    v_mfma_f32_16x16x32_bf16 v[104:107], v[76:79], v[64:67], v[104:107]
    ds_read_b64_tr_b16 v[54:55], v152 offset:0
    ds_read_b64_tr_b16 v[56:57], v148 offset:61440
    v_mfma_f32_16x16x32_bf16 v[108:111], v[76:79], v[68:71], v[108:111]
    ds_read_b64_tr_b16 v[58:59], v153 offset:0
    v_mfma_f32_16x16x32_bf16 v[112:115], v[80:83], v[60:63], v[112:115]
    v_mfma_f32_16x16x32_bf16 v[116:119], v[80:83], v[64:67], v[116:119]
    v_mfma_f32_16x16x32_bf16 v[120:123], v[80:83], v[68:71], v[120:123]
    v_mfma_f32_16x16x32_bf16 v[124:127], v[84:87], v[60:63], v[124:127]
    v_mfma_f32_16x16x32_bf16 v[128:131], v[84:87], v[64:67], v[128:131]
    v_mfma_f32_16x16x32_bf16 v[132:135], v[84:87], v[68:71], v[132:135]
    s_waitcnt lgkmcnt(0)
    v_mfma_f32_16x16x32_bf16 v[88:91], v[44:47], v[32:35], v[88:91]
    ds_read_b64_tr_b16 v[72:73], v150 offset:4096
    ds_read_b64_tr_b16 v[74:75], v150 offset:8192
    v_mfma_f32_16x16x32_bf16 v[92:95], v[44:47], v[36:39], v[92:95]
    ds_read_b128 v[60:63], v144 offset:55296
    ds_read_b128 v[64:67], v144 offset:56320
    v_mfma_f32_16x16x32_bf16 v[96:99], v[44:47], v[40:43], v[96:99]
    ds_read_b128 v[68:71], v144 offset:57344
    ds_read_b64_tr_b16 v[76:77], v151 offset:4096
    v_mfma_f32_16x16x32_bf16 v[100:103], v[48:51], v[32:35], v[100:103]
    ds_read_b64_tr_b16 v[78:79], v151 offset:8192
    ds_read_b64_tr_b16 v[80:81], v152 offset:4096
    v_mfma_f32_16x16x32_bf16 v[104:107], v[48:51], v[36:39], v[104:107]
    ds_read_b64_tr_b16 v[82:83], v152 offset:8192
    ds_read_b64_tr_b16 v[84:85], v153 offset:4096
    v_mfma_f32_16x16x32_bf16 v[108:111], v[48:51], v[40:43], v[108:111]
    ds_read_b64_tr_b16 v[86:87], v153 offset:8192
    v_mfma_f32_16x16x32_bf16 v[112:115], v[52:55], v[32:35], v[112:115]
    v_mfma_f32_16x16x32_bf16 v[116:119], v[52:55], v[36:39], v[116:119]
    v_mfma_f32_16x16x32_bf16 v[120:123], v[52:55], v[40:43], v[120:123]
    v_mfma_f32_16x16x32_bf16 v[124:127], v[56:59], v[32:35], v[124:127]
    v_mfma_f32_16x16x32_bf16 v[128:131], v[56:59], v[36:39], v[128:131]
    v_mfma_f32_16x16x32_bf16 v[132:135], v[56:59], v[40:43], v[132:135]
    s_waitcnt lgkmcnt(0)
    s_barrier
    v_mfma_f32_16x16x32_bf16 v[88:91], v[72:75], v[60:63], v[88:91]
    ds_read_b64_tr_b16 v[44:45], v8 offset:12288
    ds_read_b64_tr_b16 v[46:47], v8 offset:16384
    v_mfma_f32_16x16x32_bf16 v[92:95], v[72:75], v[64:67], v[92:95]
    ds_read_b128 v[32:35], v6 offset:0
    ds_read_b128 v[36:39], v6 offset:1024
    v_mfma_f32_16x16x32_bf16 v[96:99], v[72:75], v[68:71], v[96:99]
    ds_read_b128 v[40:43], v6 offset:2048
    ds_read_b64_tr_b16 v[48:49], v9 offset:12288
    v_mfma_f32_16x16x32_bf16 v[100:103], v[76:79], v[60:63], v[100:103]
    ds_read_b64_tr_b16 v[50:51], v9 offset:16384
    ds_read_b64_tr_b16 v[52:53], v10 offset:12288
    v_mfma_f32_16x16x32_bf16 v[104:107], v[76:79], v[64:67], v[104:107]
    ds_read_b64_tr_b16 v[54:55], v10 offset:16384
    ds_read_b64_tr_b16 v[56:57], v11 offset:12288
    v_mfma_f32_16x16x32_bf16 v[108:111], v[76:79], v[68:71], v[108:111]
    ds_read_b64_tr_b16 v[58:59], v11 offset:16384
    v_mfma_f32_16x16x32_bf16 v[112:115], v[80:83], v[60:63], v[112:115]
    v_mfma_f32_16x16x32_bf16 v[116:119], v[80:83], v[64:67], v[116:119]
    v_mfma_f32_16x16x32_bf16 v[120:123], v[80:83], v[68:71], v[120:123]
    v_mfma_f32_16x16x32_bf16 v[124:127], v[84:87], v[60:63], v[124:127]
    v_mfma_f32_16x16x32_bf16 v[128:131], v[84:87], v[64:67], v[128:131]
    v_mfma_f32_16x16x32_bf16 v[132:135], v[84:87], v[68:71], v[132:135]
    s_add_u32 s59, s59, 1
    s_cmp_lt_u32 s59, 6
    s_cbranch_scc1 g1_phase_loop_13
    s_waitcnt vmcnt(0)
    v_lshlrev_b32 v156, 16, v12
    v_and_b32 v157, s45, v12
    v_lshlrev_b32 v158, 16, v13
    v_and_b32 v159, s45, v13
    v_lshlrev_b32 v160, 16, v14
    v_and_b32 v161, s45, v14
    v_lshlrev_b32 v162, 16, v15
    v_and_b32 v163, s45, v15
    v_lshlrev_b32 v164, 16, v16
    v_and_b32 v165, s45, v16
    v_lshlrev_b32 v166, 16, v17
    v_and_b32 v167, s45, v17
    v_lshlrev_b32 v168, 16, v18
    v_and_b32 v169, s45, v18
    v_lshlrev_b32 v170, 16, v19
    v_and_b32 v171, s45, v19
    v_mov_b32 v172, 3222493025
    v_mov_b32 v173, 3222493025
    v_mov_b32 v174, 3184710632
    v_mov_b32 v175, 3184710632
    v_mov_b32 v176, 1.0
    v_mov_b32 v177, 1.0
    s_waitcnt lgkmcnt(0)
    v_mfma_f32_16x16x32_bf16 v[88:91], v[44:47], v[32:35], v[88:91]
    ds_read_b64_tr_b16 v[72:73], v8 offset:20480
    ds_read_b64_tr_b16 v[74:75], v8 offset:24576
    v_mfma_f32_16x16x32_bf16 v[92:95], v[44:47], v[36:39], v[92:95]
    ds_read_b128 v[60:63], v6 offset:6144
    ds_read_b128 v[64:67], v6 offset:7168
    v_mfma_f32_16x16x32_bf16 v[96:99], v[44:47], v[40:43], v[96:99]
    ds_read_b128 v[68:71], v6 offset:8192
    ds_read_b64_tr_b16 v[76:77], v9 offset:20480
    v_mfma_f32_16x16x32_bf16 v[100:103], v[48:51], v[32:35], v[100:103]
    ds_read_b64_tr_b16 v[78:79], v9 offset:24576
    ds_read_b64_tr_b16 v[80:81], v10 offset:20480
    v_mfma_f32_16x16x32_bf16 v[104:107], v[48:51], v[36:39], v[104:107]
    ds_read_b64_tr_b16 v[82:83], v10 offset:24576
    ds_read_b64_tr_b16 v[84:85], v11 offset:20480
    v_mfma_f32_16x16x32_bf16 v[108:111], v[48:51], v[40:43], v[108:111]
    ds_read_b64_tr_b16 v[86:87], v11 offset:24576
    v_mfma_f32_16x16x32_bf16 v[112:115], v[52:55], v[32:35], v[112:115]
    v_mfma_f32_16x16x32_bf16 v[116:119], v[52:55], v[36:39], v[116:119]
    v_mfma_f32_16x16x32_bf16 v[120:123], v[52:55], v[40:43], v[120:123]
    v_mfma_f32_16x16x32_bf16 v[124:127], v[56:59], v[32:35], v[124:127]
    v_mfma_f32_16x16x32_bf16 v[128:131], v[56:59], v[36:39], v[128:131]
    v_mfma_f32_16x16x32_bf16 v[132:135], v[56:59], v[40:43], v[132:135]
    s_waitcnt lgkmcnt(0)
    s_barrier
    v_mfma_f32_16x16x32_bf16 v[88:91], v[72:75], v[60:63], v[88:91]
    ds_read_b64_tr_b16 v[44:45], v8 offset:40960
    ds_read_b64_tr_b16 v[46:47], v8 offset:45056
    v_mfma_f32_16x16x32_bf16 v[92:95], v[72:75], v[64:67], v[92:95]
    ds_read_b128 v[32:35], v6 offset:28672
    ds_read_b128 v[36:39], v6 offset:29696
    v_mfma_f32_16x16x32_bf16 v[96:99], v[72:75], v[68:71], v[96:99]
    ds_read_b128 v[40:43], v6 offset:30720
    ds_read_b64_tr_b16 v[48:49], v9 offset:40960
    v_mfma_f32_16x16x32_bf16 v[100:103], v[76:79], v[60:63], v[100:103]
    ds_read_b64_tr_b16 v[50:51], v9 offset:45056
    ds_read_b64_tr_b16 v[52:53], v10 offset:40960
    v_mfma_f32_16x16x32_bf16 v[104:107], v[76:79], v[64:67], v[104:107]
    ds_read_b64_tr_b16 v[54:55], v10 offset:45056
    ds_read_b64_tr_b16 v[56:57], v11 offset:40960
    v_mfma_f32_16x16x32_bf16 v[108:111], v[76:79], v[68:71], v[108:111]
    ds_read_b64_tr_b16 v[58:59], v11 offset:45056
    v_mfma_f32_16x16x32_bf16 v[112:115], v[80:83], v[60:63], v[112:115]
    v_mfma_f32_16x16x32_bf16 v[116:119], v[80:83], v[64:67], v[116:119]
    v_mfma_f32_16x16x32_bf16 v[120:123], v[80:83], v[68:71], v[120:123]
    v_mfma_f32_16x16x32_bf16 v[124:127], v[84:87], v[60:63], v[124:127]
    v_mfma_f32_16x16x32_bf16 v[128:131], v[84:87], v[64:67], v[128:131]
    v_mfma_f32_16x16x32_bf16 v[132:135], v[84:87], v[68:71], v[132:135]
    s_waitcnt lgkmcnt(0)
    v_mfma_f32_16x16x32_bf16 v[88:91], v[44:47], v[32:35], v[88:91]
    ds_read_b64_tr_b16 v[72:73], v8 offset:49152
    ds_read_b64_tr_b16 v[74:75], v8 offset:53248
    v_mfma_f32_16x16x32_bf16 v[92:95], v[44:47], v[36:39], v[92:95]
    ds_read_b128 v[60:63], v6 offset:34816
    ds_read_b128 v[64:67], v6 offset:35840
    v_mfma_f32_16x16x32_bf16 v[96:99], v[44:47], v[40:43], v[96:99]
    ds_read_b128 v[68:71], v6 offset:36864
    ds_read_b64_tr_b16 v[76:77], v9 offset:49152
    v_mfma_f32_16x16x32_bf16 v[100:103], v[48:51], v[32:35], v[100:103]
    ds_read_b64_tr_b16 v[78:79], v9 offset:53248
    ds_read_b64_tr_b16 v[80:81], v10 offset:49152
    v_mfma_f32_16x16x32_bf16 v[104:107], v[48:51], v[36:39], v[104:107]
    ds_read_b64_tr_b16 v[82:83], v10 offset:53248
    ds_read_b64_tr_b16 v[84:85], v11 offset:49152
    v_mfma_f32_16x16x32_bf16 v[108:111], v[48:51], v[40:43], v[108:111]
    ds_read_b64_tr_b16 v[86:87], v11 offset:53248
    v_mfma_f32_16x16x32_bf16 v[112:115], v[52:55], v[32:35], v[112:115]
    v_mfma_f32_16x16x32_bf16 v[116:119], v[52:55], v[36:39], v[116:119]
    v_mfma_f32_16x16x32_bf16 v[120:123], v[52:55], v[40:43], v[120:123]
    v_mfma_f32_16x16x32_bf16 v[124:127], v[56:59], v[32:35], v[124:127]
    v_mfma_f32_16x16x32_bf16 v[128:131], v[56:59], v[36:39], v[128:131]
    v_mfma_f32_16x16x32_bf16 v[132:135], v[56:59], v[40:43], v[132:135]
    s_waitcnt lgkmcnt(0)
    v_mfma_f32_16x16x32_bf16 v[88:91], v[72:75], v[60:63], v[88:91]
    v_mfma_f32_16x16x32_bf16 v[92:95], v[72:75], v[64:67], v[92:95]
    v_mfma_f32_16x16x32_bf16 v[96:99], v[72:75], v[68:71], v[96:99]
    v_mfma_f32_16x16x32_bf16 v[100:103], v[76:79], v[60:63], v[100:103]
    v_mfma_f32_16x16x32_bf16 v[104:107], v[76:79], v[64:67], v[104:107]
    v_mfma_f32_16x16x32_bf16 v[108:111], v[76:79], v[68:71], v[108:111]
    v_mfma_f32_16x16x32_bf16 v[112:115], v[80:83], v[60:63], v[112:115]
    v_mfma_f32_16x16x32_bf16 v[116:119], v[80:83], v[64:67], v[116:119]
    v_mfma_f32_16x16x32_bf16 v[120:123], v[80:83], v[68:71], v[120:123]
    v_mfma_f32_16x16x32_bf16 v[124:127], v[84:87], v[60:63], v[124:127]
    v_mfma_f32_16x16x32_bf16 v[128:131], v[84:87], v[64:67], v[128:131]
    v_mfma_f32_16x16x32_bf16 v[132:135], v[84:87], v[68:71], v[132:135]
    v_pk_add_f32 v[88:89], v[88:89], v[156:157]
    v_pk_add_f32 v[90:91], v[90:91], v[158:159]
    v_pk_add_f32 v[100:101], v[100:101], v[160:161]
    v_pk_add_f32 v[102:103], v[102:103], v[162:163]
    v_pk_mul_f32 v[32:33], v[88:89], v[88:89]
    v_pk_mul_f32 v[34:35], v[90:91], v[90:91]
    v_pk_mul_f32 v[36:37], v[100:101], v[100:101]
    v_pk_mul_f32 v[38:39], v[102:103], v[102:103]
    v_pk_fma_f32 v[32:33], v[32:33], v[174:175], v[172:173]
    v_pk_fma_f32 v[34:35], v[34:35], v[174:175], v[172:173]
    v_pk_fma_f32 v[36:37], v[36:37], v[174:175], v[172:173]
    v_pk_fma_f32 v[38:39], v[38:39], v[174:175], v[172:173]
    v_pk_mul_f32 v[32:33], v[32:33], v[88:89]
    v_pk_mul_f32 v[34:35], v[34:35], v[90:91]
    v_pk_mul_f32 v[36:37], v[36:37], v[100:101]
    v_pk_mul_f32 v[38:39], v[38:39], v[102:103]
    v_exp_f32 v32, v32
    v_exp_f32 v33, v33
    v_exp_f32 v34, v34
    v_exp_f32 v35, v35
    v_exp_f32 v36, v36
    v_exp_f32 v37, v37
    v_exp_f32 v38, v38
    v_exp_f32 v39, v39
    v_pk_add_f32 v[32:33], v[32:33], v[176:177]
    v_pk_add_f32 v[34:35], v[34:35], v[176:177]
    v_pk_add_f32 v[36:37], v[36:37], v[176:177]
    v_pk_add_f32 v[38:39], v[38:39], v[176:177]
    v_rcp_f32 v32, v32
    v_rcp_f32 v33, v33
    v_rcp_f32 v34, v34
    v_rcp_f32 v35, v35
    v_rcp_f32 v36, v36
    v_rcp_f32 v37, v37
    v_rcp_f32 v38, v38
    v_rcp_f32 v39, v39
    v_pk_mul_f32 v[32:33], v[32:33], v[88:89]
    v_pk_mul_f32 v[34:35], v[34:35], v[90:91]
    v_pk_mul_f32 v[36:37], v[36:37], v[100:101]
    v_pk_mul_f32 v[38:39], v[38:39], v[102:103]
    v_cvt_pk_bf16_f32 v40, v32, v33
    v_cvt_pk_bf16_f32 v41, v34, v35
    v_cvt_pk_bf16_f32 v42, v36, v37
    v_cvt_pk_bf16_f32 v43, v38, v39
    buffer_store_dwordx4 v[40:43], v3, s[24:27], s32 offen sc1
    v_pk_add_f32 v[92:93], v[92:93], v[156:157]
    v_pk_add_f32 v[94:95], v[94:95], v[158:159]
    v_pk_add_f32 v[104:105], v[104:105], v[160:161]
    v_pk_add_f32 v[106:107], v[106:107], v[162:163]
    v_pk_mul_f32 v[44:45], v[92:93], v[92:93]
    v_pk_mul_f32 v[46:47], v[94:95], v[94:95]
    v_pk_mul_f32 v[48:49], v[104:105], v[104:105]
    v_pk_mul_f32 v[50:51], v[106:107], v[106:107]
    v_pk_fma_f32 v[44:45], v[44:45], v[174:175], v[172:173]
    v_pk_fma_f32 v[46:47], v[46:47], v[174:175], v[172:173]
    v_pk_fma_f32 v[48:49], v[48:49], v[174:175], v[172:173]
    v_pk_fma_f32 v[50:51], v[50:51], v[174:175], v[172:173]
    v_pk_mul_f32 v[44:45], v[44:45], v[92:93]
    v_pk_mul_f32 v[46:47], v[46:47], v[94:95]
    v_pk_mul_f32 v[48:49], v[48:49], v[104:105]
    v_pk_mul_f32 v[50:51], v[50:51], v[106:107]
    v_exp_f32 v44, v44
    v_exp_f32 v45, v45
    v_exp_f32 v46, v46
    v_exp_f32 v47, v47
    v_exp_f32 v48, v48
    v_exp_f32 v49, v49
    v_exp_f32 v50, v50
    v_exp_f32 v51, v51
    v_pk_add_f32 v[44:45], v[44:45], v[176:177]
    v_pk_add_f32 v[46:47], v[46:47], v[176:177]
    v_pk_add_f32 v[48:49], v[48:49], v[176:177]
    v_pk_add_f32 v[50:51], v[50:51], v[176:177]
    v_rcp_f32 v44, v44
    v_rcp_f32 v45, v45
    v_rcp_f32 v46, v46
    v_rcp_f32 v47, v47
    v_rcp_f32 v48, v48
    v_rcp_f32 v49, v49
    v_rcp_f32 v50, v50
    v_rcp_f32 v51, v51
    v_pk_mul_f32 v[44:45], v[44:45], v[92:93]
    v_pk_mul_f32 v[46:47], v[46:47], v[94:95]
    v_pk_mul_f32 v[48:49], v[48:49], v[104:105]
    v_pk_mul_f32 v[50:51], v[50:51], v[106:107]
    v_cvt_pk_bf16_f32 v52, v44, v45
    v_cvt_pk_bf16_f32 v53, v46, v47
    v_cvt_pk_bf16_f32 v54, v48, v49
    v_cvt_pk_bf16_f32 v55, v50, v51
    buffer_store_dwordx4 v[52:55], v3, s[24:27], s34 offen sc1
    v_pk_add_f32 v[96:97], v[96:97], v[156:157]
    v_pk_add_f32 v[98:99], v[98:99], v[158:159]
    v_pk_add_f32 v[108:109], v[108:109], v[160:161]
    v_pk_add_f32 v[110:111], v[110:111], v[162:163]
    v_pk_mul_f32 v[32:33], v[96:97], v[96:97]
    v_pk_mul_f32 v[34:35], v[98:99], v[98:99]
    v_pk_mul_f32 v[36:37], v[108:109], v[108:109]
    v_pk_mul_f32 v[38:39], v[110:111], v[110:111]
    v_pk_fma_f32 v[32:33], v[32:33], v[174:175], v[172:173]
    v_pk_fma_f32 v[34:35], v[34:35], v[174:175], v[172:173]
    v_pk_fma_f32 v[36:37], v[36:37], v[174:175], v[172:173]
    v_pk_fma_f32 v[38:39], v[38:39], v[174:175], v[172:173]
    v_pk_mul_f32 v[32:33], v[32:33], v[96:97]
    v_pk_mul_f32 v[34:35], v[34:35], v[98:99]
    v_pk_mul_f32 v[36:37], v[36:37], v[108:109]
    v_pk_mul_f32 v[38:39], v[38:39], v[110:111]
    v_exp_f32 v32, v32
    v_exp_f32 v33, v33
    v_exp_f32 v34, v34
    v_exp_f32 v35, v35
    v_exp_f32 v36, v36
    v_exp_f32 v37, v37
    v_exp_f32 v38, v38
    v_exp_f32 v39, v39
    v_pk_add_f32 v[32:33], v[32:33], v[176:177]
    v_pk_add_f32 v[34:35], v[34:35], v[176:177]
    v_pk_add_f32 v[36:37], v[36:37], v[176:177]
    v_pk_add_f32 v[38:39], v[38:39], v[176:177]
    v_rcp_f32 v32, v32
    v_rcp_f32 v33, v33
    v_rcp_f32 v34, v34
    v_rcp_f32 v35, v35
    v_rcp_f32 v36, v36
    v_rcp_f32 v37, v37
    v_rcp_f32 v38, v38
    v_rcp_f32 v39, v39
    v_pk_mul_f32 v[32:33], v[32:33], v[96:97]
    v_pk_mul_f32 v[34:35], v[34:35], v[98:99]
    v_pk_mul_f32 v[36:37], v[36:37], v[108:109]
    v_pk_mul_f32 v[38:39], v[38:39], v[110:111]
    v_cvt_pk_bf16_f32 v40, v32, v33
    v_cvt_pk_bf16_f32 v41, v34, v35
    v_cvt_pk_bf16_f32 v42, v36, v37
    v_cvt_pk_bf16_f32 v43, v38, v39
    buffer_store_dwordx4 v[40:43], v3, s[24:27], s36 offen sc1
    v_pk_add_f32 v[112:113], v[112:113], v[164:165]
    v_pk_add_f32 v[114:115], v[114:115], v[166:167]
    v_pk_add_f32 v[124:125], v[124:125], v[168:169]
    v_pk_add_f32 v[126:127], v[126:127], v[170:171]
    v_pk_mul_f32 v[44:45], v[112:113], v[112:113]
    v_pk_mul_f32 v[46:47], v[114:115], v[114:115]
    v_pk_mul_f32 v[48:49], v[124:125], v[124:125]
    v_pk_mul_f32 v[50:51], v[126:127], v[126:127]
    v_pk_fma_f32 v[44:45], v[44:45], v[174:175], v[172:173]
    v_pk_fma_f32 v[46:47], v[46:47], v[174:175], v[172:173]
    v_pk_fma_f32 v[48:49], v[48:49], v[174:175], v[172:173]
    v_pk_fma_f32 v[50:51], v[50:51], v[174:175], v[172:173]
    v_pk_mul_f32 v[44:45], v[44:45], v[112:113]
    v_pk_mul_f32 v[46:47], v[46:47], v[114:115]
    v_pk_mul_f32 v[48:49], v[48:49], v[124:125]
    v_pk_mul_f32 v[50:51], v[50:51], v[126:127]
    v_exp_f32 v44, v44
    v_exp_f32 v45, v45
    v_exp_f32 v46, v46
    v_exp_f32 v47, v47
    v_exp_f32 v48, v48
    v_exp_f32 v49, v49
    v_exp_f32 v50, v50
    v_exp_f32 v51, v51
    v_pk_add_f32 v[44:45], v[44:45], v[176:177]
    v_pk_add_f32 v[46:47], v[46:47], v[176:177]
    v_pk_add_f32 v[48:49], v[48:49], v[176:177]
    v_pk_add_f32 v[50:51], v[50:51], v[176:177]
    v_rcp_f32 v44, v44
    v_rcp_f32 v45, v45
    v_rcp_f32 v46, v46
    v_rcp_f32 v47, v47
    v_rcp_f32 v48, v48
    v_rcp_f32 v49, v49
    v_rcp_f32 v50, v50
    v_rcp_f32 v51, v51
    v_pk_mul_f32 v[44:45], v[44:45], v[112:113]
    v_pk_mul_f32 v[46:47], v[46:47], v[114:115]
    v_pk_mul_f32 v[48:49], v[48:49], v[124:125]
    v_pk_mul_f32 v[50:51], v[50:51], v[126:127]
    v_cvt_pk_bf16_f32 v52, v44, v45
    v_cvt_pk_bf16_f32 v53, v46, v47
    v_cvt_pk_bf16_f32 v54, v48, v49
    v_cvt_pk_bf16_f32 v55, v50, v51
    buffer_store_dwordx4 v[52:55], v3, s[24:27], s33 offen sc1
    v_pk_add_f32 v[116:117], v[116:117], v[164:165]
    v_pk_add_f32 v[118:119], v[118:119], v[166:167]
    v_pk_add_f32 v[128:129], v[128:129], v[168:169]
    v_pk_add_f32 v[130:131], v[130:131], v[170:171]
    v_pk_mul_f32 v[32:33], v[116:117], v[116:117]
    v_pk_mul_f32 v[34:35], v[118:119], v[118:119]
    v_pk_mul_f32 v[36:37], v[128:129], v[128:129]
    v_pk_mul_f32 v[38:39], v[130:131], v[130:131]
    v_pk_fma_f32 v[32:33], v[32:33], v[174:175], v[172:173]
    v_pk_fma_f32 v[34:35], v[34:35], v[174:175], v[172:173]
    v_pk_fma_f32 v[36:37], v[36:37], v[174:175], v[172:173]
    v_pk_fma_f32 v[38:39], v[38:39], v[174:175], v[172:173]
    v_pk_mul_f32 v[32:33], v[32:33], v[116:117]
    v_pk_mul_f32 v[34:35], v[34:35], v[118:119]
    v_pk_mul_f32 v[36:37], v[36:37], v[128:129]
    v_pk_mul_f32 v[38:39], v[38:39], v[130:131]
    v_exp_f32 v32, v32
    v_exp_f32 v33, v33
    v_exp_f32 v34, v34
    v_exp_f32 v35, v35
    v_exp_f32 v36, v36
    v_exp_f32 v37, v37
    v_exp_f32 v38, v38
    v_exp_f32 v39, v39
    v_pk_add_f32 v[32:33], v[32:33], v[176:177]
    v_pk_add_f32 v[34:35], v[34:35], v[176:177]
    v_pk_add_f32 v[36:37], v[36:37], v[176:177]
    v_pk_add_f32 v[38:39], v[38:39], v[176:177]
    v_rcp_f32 v32, v32
    v_rcp_f32 v33, v33
    v_rcp_f32 v34, v34
    v_rcp_f32 v35, v35
    v_rcp_f32 v36, v36
    v_rcp_f32 v37, v37
    v_rcp_f32 v38, v38
    v_rcp_f32 v39, v39
    v_pk_mul_f32 v[32:33], v[32:33], v[116:117]
    v_pk_mul_f32 v[34:35], v[34:35], v[118:119]
    v_pk_mul_f32 v[36:37], v[36:37], v[128:129]
    v_pk_mul_f32 v[38:39], v[38:39], v[130:131]
    v_cvt_pk_bf16_f32 v40, v32, v33
    v_cvt_pk_bf16_f32 v41, v34, v35
    v_cvt_pk_bf16_f32 v42, v36, v37
    v_cvt_pk_bf16_f32 v43, v38, v39
    buffer_store_dwordx4 v[40:43], v3, s[24:27], s35 offen sc1
    v_pk_add_f32 v[120:121], v[120:121], v[164:165]
    v_pk_add_f32 v[122:123], v[122:123], v[166:167]
    v_pk_add_f32 v[132:133], v[132:133], v[168:169]
    v_pk_add_f32 v[134:135], v[134:135], v[170:171]
    v_pk_mul_f32 v[44:45], v[120:121], v[120:121]
    v_pk_mul_f32 v[46:47], v[122:123], v[122:123]
    v_pk_mul_f32 v[48:49], v[132:133], v[132:133]
    v_pk_mul_f32 v[50:51], v[134:135], v[134:135]
    v_pk_fma_f32 v[44:45], v[44:45], v[174:175], v[172:173]
    v_pk_fma_f32 v[46:47], v[46:47], v[174:175], v[172:173]
    v_pk_fma_f32 v[48:49], v[48:49], v[174:175], v[172:173]
    v_pk_fma_f32 v[50:51], v[50:51], v[174:175], v[172:173]
    v_pk_mul_f32 v[44:45], v[44:45], v[120:121]
    v_pk_mul_f32 v[46:47], v[46:47], v[122:123]
    v_pk_mul_f32 v[48:49], v[48:49], v[132:133]
    v_pk_mul_f32 v[50:51], v[50:51], v[134:135]
    v_exp_f32 v44, v44
    v_exp_f32 v45, v45
    v_exp_f32 v46, v46
    v_exp_f32 v47, v47
    v_exp_f32 v48, v48
    v_exp_f32 v49, v49
    v_exp_f32 v50, v50
    v_exp_f32 v51, v51
    v_pk_add_f32 v[44:45], v[44:45], v[176:177]
    v_pk_add_f32 v[46:47], v[46:47], v[176:177]
    v_pk_add_f32 v[48:49], v[48:49], v[176:177]
    v_pk_add_f32 v[50:51], v[50:51], v[176:177]
    v_rcp_f32 v44, v44
    v_rcp_f32 v45, v45
    v_rcp_f32 v46, v46
    v_rcp_f32 v47, v47
    v_rcp_f32 v48, v48
    v_rcp_f32 v49, v49
    v_rcp_f32 v50, v50
    v_rcp_f32 v51, v51
    v_pk_mul_f32 v[44:45], v[44:45], v[120:121]
    v_pk_mul_f32 v[46:47], v[46:47], v[122:123]
    v_pk_mul_f32 v[48:49], v[48:49], v[132:133]
    v_pk_mul_f32 v[50:51], v[50:51], v[134:135]
    v_cvt_pk_bf16_f32 v52, v44, v45
    v_cvt_pk_bf16_f32 v53, v46, v47
    v_cvt_pk_bf16_f32 v54, v48, v49
    v_cvt_pk_bf16_f32 v55, v50, v51
    buffer_store_dwordx4 v[52:55], v3, s[24:27], s37 offen sc1
    s_add_u32 s28, s8, 67108864
    s_addc_u32 s29, s9, 0
    s_mov_b32 s30, 65536
    s_mov_b32 s31, 0x00020000
    s_mul_i32 s14, s10, 7282
    s_lshr_b32 s14, s14, 16
    s_lshl_b32 s15, s11, 2
    s_add_u32 s14, s14, s15
    s_lshl_b32 s14, s14, 10
    s_add_u32 s14, s14, 4096
    v_lshlrev_b32 v136, 7, v2
    v_mov_b32 v137, 1
    s_waitcnt vmcnt(0)
    s_mov_b64 exec, 0xff
    buffer_atomic_add v137, v136, s[28:31], s14 offen
    s_mov_b64 exec, -1
    s_barrier
    s_mov_b64 exec, -1
    s_branch g2_phase
g2_phase:
    s_load_dwordx2 s[4:5], s[0:1], 56
    s_load_dwordx2 s[8:9], s[0:1], 88
    v_lshrrev_b32 v1, 6, v0
    v_and_b32 v2, 63, v0
    s_and_b32 s3, s2, 7
    v_readfirstlane_b32 s58, v1
    s_lshr_b32 s14, s2, 3
    s_and_b32 s46, s3, 3
    s_lshr_b32 s3, s3, 2
    s_lshl_b32 s3, s3, 3
    s_lshr_b32 s10, s14, 2
    s_add_u32 s10, s10, s3
    s_and_b32 s11, s14, 3
    v_lshrrev_b32 v1, 4, v2
    v_and_b32 v7, 15, v2
    v_lshlrev_b32 v3, 4, v2
    s_and_b32 s12, s58, 3
    s_cmp_lt_u32 s58, 4
    s_cbranch_scc1 g2_phase_cons
    s_setprio 0
    s_mul_i32 s51, s11, 1
    s_mul_i32 s52, s10, 1
    s_add_u32 s51, s51, s52
    s_mul_i32 s52, s51, 21846
    s_lshr_b32 s52, s52, 16
    s_mul_i32 s52, s52, 3
    s_sub_u32 s51, s51, s52
    s_mov_b32 s37, 0
    s_mul_i32 s52, s46, 18
    s_add_u32 s52, s52, s51
    v_lshlrev_b32 v8, 1, v1
    v_xor_b32 v8, v7, v8
    v_xor_b32 v9, 8, v8
    v_mul_u32_u24 v10, 4096, v1
    v_lshl_add_u32 v4, v8, 4, v10
    v_lshl_add_u32 v5, v9, 4, v10
    s_lshl_b32 s14, s52, 2
    s_add_u32 s14, s14, s12
    s_mul_i32 s14, s14, 65536
    s_lshl_b32 s15, s10, 8
    s_add_u32 s14, s14, s15
    v_add_u32 v4, s14, v4
    v_add_u32 v5, s14, v5
    s_mov_b32 s32, 0
    s_mov_b32 s33, 15360
    s_mov_b32 s34, 30720
    s_mov_b32 s35, 46080
    s_lshl_b32 s43, s12, 12
    s_add_u32 s43, s43, 18432
    s_mul_i32 s13, s11, 72
    s_add_u32 s13, s13, s52
    s_mul_i32 s13, s13, 18432
    s_mul_i32 s40, s12, 4096
    s_add_u32 s13, s13, s40
    s_lshl_b32 s42, s12, 10
    s_add_u32 s42, s42, 16384
    s_sub_u32 s41, s42, s40
    s_mov_b32 s53, 262144
    s_mov_b32 s36, 0
    s_mov_b32 s18, 0x1200000
    s_mov_b32 s19, 0x00020000
    s_mov_b32 s22, 5308416
    s_mov_b32 s23, 0x00020000
    s_waitcnt lgkmcnt(0)
    s_mov_b32 s16, s4
    s_mov_b32 s17, s5
    s_add_u32 s20, s8, 4194304
    s_addc_u32 s21, s9, 0
    s_add_u32 s24, s8, 67108864
    s_addc_u32 s25, s9, 0
    s_mov_b32 s26, 65536
    s_mov_b32 s27, 0x00020000
    s_add_u32 m0, s43, s36
    s_add_u32 s15, s40, s36
    buffer_load_dwordx4 v4, s[16:19], s32 offen lds
    buffer_load_dwordx4 v5, s[16:19], s33 offen offset:1024 lds
    buffer_load_dwordx4 v4, s[16:19], s34 offen offset:2048 lds
    buffer_load_dwordx4 v5, s[16:19], s35 offen offset:3072 lds
    s_mov_b32 s84, s13
    s_add_u32 s51, s51, 1
    s_cmp_lg_u32 s51, 3
    s_cselect_b32 s44, 1, -2
    s_cselect_b32 s51, s51, 0
    s_add_u32 s37, s37, 1
    s_cmp_lg_u32 s37, 3
    s_cselect_b32 s52, 0, 3
    s_cselect_b32 s37, s37, 0
    s_add_u32 s44, s44, s52
    s_mul_i32 s52, s44, 18432
    s_mul_i32 s44, s44, s53
    v_add_u32 v4, s44, v4
    v_add_u32 v5, s44, v5
    s_add_u32 s13, s13, s52
    s_add_u32 s36, s36, 34816
    s_cmp_lg_u32 s36, 139264
    s_cselect_b32 s36, s36, 0
    s_add_u32 m0, s43, s36
    s_add_u32 s15, s40, s36
    buffer_load_dwordx4 v4, s[16:19], s32 offen lds
    buffer_load_dwordx4 v5, s[16:19], s33 offen offset:1024 lds
    buffer_load_dwordx4 v4, s[16:19], s34 offen offset:2048 lds
    buffer_load_dwordx4 v5, s[16:19], s35 offen offset:3072 lds
    s_mov_b32 s85, s13
    s_add_u32 s51, s51, 1
    s_cmp_lg_u32 s51, 3
    s_cselect_b32 s44, 1, -2
    s_cselect_b32 s51, s51, 0
    s_add_u32 s37, s37, 1
    s_cmp_lg_u32 s37, 3
    s_cselect_b32 s52, 0, 3
    s_cselect_b32 s37, s37, 0
    s_add_u32 s44, s44, s52
    s_mul_i32 s52, s44, 18432
    s_mul_i32 s44, s44, s53
    v_add_u32 v4, s44, v4
    v_add_u32 v5, s44, v5
    s_add_u32 s13, s13, s52
    s_add_u32 s36, s36, 34816
    s_cmp_lg_u32 s36, 139264
    s_cselect_b32 s36, s36, 0
    s_add_u32 m0, s43, s36
    s_add_u32 s15, s40, s36
    buffer_load_dwordx4 v4, s[16:19], s32 offen lds
    buffer_load_dwordx4 v5, s[16:19], s33 offen offset:1024 lds
    buffer_load_dwordx4 v4, s[16:19], s34 offen offset:2048 lds
    buffer_load_dwordx4 v5, s[16:19], s35 offen offset:3072 lds
    s_mov_b32 s86, s13
    s_add_u32 s51, s51, 1
    s_cmp_lg_u32 s51, 3
    s_cselect_b32 s44, 1, -2
    s_cselect_b32 s51, s51, 0
    s_add_u32 s37, s37, 1
    s_cmp_lg_u32 s37, 3
    s_cselect_b32 s52, 0, 3
    s_cselect_b32 s37, s37, 0
    s_add_u32 s44, s44, s52
    s_mul_i32 s52, s44, 18432
    s_mul_i32 s44, s44, s53
    v_add_u32 v4, s44, v4
    v_add_u32 v5, s44, v5
    s_add_u32 s13, s13, s52
    s_add_u32 s36, s36, 34816
    s_cmp_lg_u32 s36, 139264
    s_cselect_b32 s36, s36, 0
    s_add_u32 m0, s43, s36
    s_add_u32 s15, s40, s36
    buffer_load_dwordx4 v4, s[16:19], s32 offen lds
    buffer_load_dwordx4 v5, s[16:19], s33 offen offset:1024 lds
    buffer_load_dwordx4 v4, s[16:19], s34 offen offset:2048 lds
    buffer_load_dwordx4 v5, s[16:19], s35 offen offset:3072 lds
    s_mov_b32 s87, s13
    s_add_u32 s51, s51, 1
    s_cmp_lg_u32 s51, 3
    s_cselect_b32 s44, 1, -2
    s_cselect_b32 s51, s51, 0
    s_add_u32 s37, s37, 1
    s_cmp_lg_u32 s37, 3
    s_cselect_b32 s52, 0, 3
    s_cselect_b32 s37, s37, 0
    s_add_u32 s44, s44, s52
    s_mul_i32 s52, s44, 18432
    s_mul_i32 s44, s44, s53
    v_add_u32 v4, s44, v4
    v_add_u32 v5, s44, v5
    s_add_u32 s13, s13, s52
    s_add_u32 s36, s36, 34816
    s_cmp_lg_u32 s36, 139264
    s_cselect_b32 s36, s36, 0
    s_and_b32 s3, s2, 7
    s_mul_i32 s14, s11, 3
    s_lshr_b32 s14, s14, 1
    s_lshl_b32 s14, s14, 2
    s_add_u32 s14, s14, s46
    s_lshl_b32 s14, s14, 3
    s_add_u32 s14, s14, s3
    s_lshl_b32 s14, s14, 7
    s_add_u32 s14, s14, 4096
    v_lshlrev_b32 v8, 12, v2
    s_mov_b64 exec, 3
g2_phase_dp_14:
    buffer_load_dword v9, v8, s[24:27], s14 offen sc1
    s_waitcnt vmcnt(0)
    v_cmp_gt_u32 vcc, 36, v9
    s_cbranch_vccz g2_phase_dd_15
    s_sleep 2
    s_branch g2_phase_dp_14
g2_phase_dd_15:
    s_mov_b64 exec, -1
    s_add_u32 m0, s40, 0
    s_nop 0
    buffer_load_dwordx4 v3, s[20:23], s84 offen offset:0 sc1 lds
    buffer_load_dwordx4 v3, s[20:23], s84 offen offset:1024 sc1 lds
    buffer_load_dwordx4 v3, s[20:23], s84 offen offset:2048 sc1 lds
    buffer_load_dwordx4 v3, s[20:23], s84 offen offset:3072 sc1 lds
    s_add_u32 m0, s42, 0
    s_add_u32 s14, s84, s41
    s_cmp_ge_u32 s12, 2
    s_cbranch_scc1 g2_phase_d_16
    buffer_load_dwordx4 v3, s[20:23], s14 offen sc1 lds
g2_phase_d_16:
    s_add_u32 m0, s40, 34816
    s_nop 0
    buffer_load_dwordx4 v3, s[20:23], s85 offen offset:0 sc1 lds
    buffer_load_dwordx4 v3, s[20:23], s85 offen offset:1024 sc1 lds
    buffer_load_dwordx4 v3, s[20:23], s85 offen offset:2048 sc1 lds
    buffer_load_dwordx4 v3, s[20:23], s85 offen offset:3072 sc1 lds
    s_add_u32 m0, s42, 34816
    s_add_u32 s14, s85, s41
    s_cmp_ge_u32 s12, 2
    s_cbranch_scc1 g2_phase_d_17
    buffer_load_dwordx4 v3, s[20:23], s14 offen sc1 lds
g2_phase_d_17:
    s_waitcnt vmcnt(4)
    s_barrier
    s_add_u32 m0, s40, 69632
    s_nop 0
    buffer_load_dwordx4 v3, s[20:23], s86 offen offset:0 sc1 lds
    buffer_load_dwordx4 v3, s[20:23], s86 offen offset:1024 sc1 lds
    buffer_load_dwordx4 v3, s[20:23], s86 offen offset:2048 sc1 lds
    buffer_load_dwordx4 v3, s[20:23], s86 offen offset:3072 sc1 lds
    s_add_u32 m0, s42, 69632
    s_add_u32 s14, s86, s41
    s_cmp_ge_u32 s12, 2
    s_cbranch_scc1 g2_phase_d_18
    buffer_load_dwordx4 v3, s[20:23], s14 offen sc1 lds
g2_phase_d_18:
    s_add_u32 m0, s40, 104448
    s_nop 0
    buffer_load_dwordx4 v3, s[20:23], s87 offen offset:0 sc1 lds
    buffer_load_dwordx4 v3, s[20:23], s87 offen offset:1024 sc1 lds
    buffer_load_dwordx4 v3, s[20:23], s87 offen offset:2048 sc1 lds
    buffer_load_dwordx4 v3, s[20:23], s87 offen offset:3072 sc1 lds
    s_add_u32 m0, s42, 104448
    s_add_u32 s14, s87, s41
    s_cmp_ge_u32 s12, 2
    s_cbranch_scc1 g2_phase_d_19
    buffer_load_dwordx4 v3, s[20:23], s14 offen sc1 lds
g2_phase_d_19:
    s_waitcnt vmcnt(8)
    s_barrier
    s_add_u32 m0, s43, s36
    s_add_u32 s15, s40, s36
    buffer_load_dwordx4 v4, s[16:19], s32 offen lds
    buffer_load_dwordx4 v5, s[16:19], s33 offen offset:1024 lds
    buffer_load_dwordx4 v4, s[16:19], s34 offen offset:2048 lds
    buffer_load_dwordx4 v5, s[16:19], s35 offen offset:3072 lds
    s_mov_b32 m0, s15
    s_nop 0
    buffer_load_dwordx4 v3, s[20:23], s13 offen offset:0 sc1 lds
    buffer_load_dwordx4 v3, s[20:23], s13 offen offset:1024 sc1 lds
    buffer_load_dwordx4 v3, s[20:23], s13 offen offset:2048 sc1 lds
    buffer_load_dwordx4 v3, s[20:23], s13 offen offset:3072 sc1 lds
    s_add_u32 m0, s42, s36
    s_add_u32 s14, s13, s41
    s_cmp_ge_u32 s12, 2
    s_cbranch_scc1 g2_phase_d_20
    buffer_load_dwordx4 v3, s[20:23], s14 offen sc1 lds
g2_phase_d_20:
    s_add_u32 s51, s51, 1
    s_cmp_lg_u32 s51, 3
    s_cselect_b32 s44, 1, -2
    s_cselect_b32 s51, s51, 0
    s_add_u32 s37, s37, 1
    s_cmp_lg_u32 s37, 3
    s_cselect_b32 s52, 0, 3
    s_cselect_b32 s37, s37, 0
    s_add_u32 s44, s44, s52
    s_mul_i32 s52, s44, 18432
    s_mul_i32 s44, s44, s53
    v_add_u32 v4, s44, v4
    v_add_u32 v5, s44, v5
    s_add_u32 s13, s13, s52
    s_add_u32 s36, s36, 34816
    s_cmp_lg_u32 s36, 139264
    s_cselect_b32 s36, s36, 0
    s_waitcnt vmcnt(12)
    s_barrier
    s_add_u32 m0, s43, s36
    s_add_u32 s15, s40, s36
    buffer_load_dwordx4 v4, s[16:19], s32 offen lds
    buffer_load_dwordx4 v5, s[16:19], s33 offen offset:1024 lds
    buffer_load_dwordx4 v4, s[16:19], s34 offen offset:2048 lds
    buffer_load_dwordx4 v5, s[16:19], s35 offen offset:3072 lds
    s_mov_b32 m0, s15
    s_nop 0
    buffer_load_dwordx4 v3, s[20:23], s13 offen offset:0 sc1 lds
    buffer_load_dwordx4 v3, s[20:23], s13 offen offset:1024 sc1 lds
    buffer_load_dwordx4 v3, s[20:23], s13 offen offset:2048 sc1 lds
    buffer_load_dwordx4 v3, s[20:23], s13 offen offset:3072 sc1 lds
    s_add_u32 m0, s42, s36
    s_add_u32 s14, s13, s41
    s_cmp_ge_u32 s12, 2
    s_cbranch_scc1 g2_phase_d_21
    buffer_load_dwordx4 v3, s[20:23], s14 offen sc1 lds
g2_phase_d_21:
    s_add_u32 s51, s51, 1
    s_cmp_lg_u32 s51, 3
    s_cselect_b32 s44, 1, -2
    s_cselect_b32 s51, s51, 0
    s_add_u32 s37, s37, 1
    s_cmp_lg_u32 s37, 3
    s_cselect_b32 s52, 0, 3
    s_cselect_b32 s37, s37, 0
    s_add_u32 s44, s44, s52
    s_mul_i32 s52, s44, 18432
    s_mul_i32 s44, s44, s53
    v_add_u32 v4, s44, v4
    v_add_u32 v5, s44, v5
    s_add_u32 s13, s13, s52
    s_add_u32 s36, s36, 34816
    s_cmp_lg_u32 s36, 139264
    s_cselect_b32 s36, s36, 0
    s_waitcnt vmcnt(16)
    s_barrier
    s_add_u32 m0, s43, s36
    s_add_u32 s15, s40, s36
    buffer_load_dwordx4 v4, s[16:19], s32 offen lds
    buffer_load_dwordx4 v5, s[16:19], s33 offen offset:1024 lds
    buffer_load_dwordx4 v4, s[16:19], s34 offen offset:2048 lds
    buffer_load_dwordx4 v5, s[16:19], s35 offen offset:3072 lds
    s_mov_b32 m0, s15
    s_nop 0
    buffer_load_dwordx4 v3, s[20:23], s13 offen offset:0 sc1 lds
    buffer_load_dwordx4 v3, s[20:23], s13 offen offset:1024 sc1 lds
    buffer_load_dwordx4 v3, s[20:23], s13 offen offset:2048 sc1 lds
    buffer_load_dwordx4 v3, s[20:23], s13 offen offset:3072 sc1 lds
    s_add_u32 m0, s42, s36
    s_add_u32 s14, s13, s41
    s_cmp_ge_u32 s12, 2
    s_cbranch_scc1 g2_phase_d_22
    buffer_load_dwordx4 v3, s[20:23], s14 offen sc1 lds
g2_phase_d_22:
    s_add_u32 s51, s51, 1
    s_cmp_lg_u32 s51, 3
    s_cselect_b32 s44, 1, -2
    s_cselect_b32 s51, s51, 0
    s_add_u32 s37, s37, 1
    s_cmp_lg_u32 s37, 3
    s_cselect_b32 s52, 0, 3
    s_cselect_b32 s37, s37, 0
    s_add_u32 s44, s44, s52
    s_mul_i32 s52, s44, 18432
    s_mul_i32 s44, s44, s53
    v_add_u32 v4, s44, v4
    v_add_u32 v5, s44, v5
    s_add_u32 s13, s13, s52
    s_add_u32 s36, s36, 34816
    s_cmp_lg_u32 s36, 139264
    s_cselect_b32 s36, s36, 0
    s_mov_b32 s45, 7
g2_phase_ll_23:
    s_waitcnt vmcnt(16)
    s_barrier
    s_add_u32 m0, s43, s36
    s_add_u32 s15, s40, s36
    buffer_load_dwordx4 v4, s[16:19], s32 offen lds
    buffer_load_dwordx4 v5, s[16:19], s33 offen offset:1024 lds
    buffer_load_dwordx4 v4, s[16:19], s34 offen offset:2048 lds
    buffer_load_dwordx4 v5, s[16:19], s35 offen offset:3072 lds
    s_mov_b32 m0, s15
    s_nop 0
    buffer_load_dwordx4 v3, s[20:23], s13 offen offset:0 sc1 lds
    buffer_load_dwordx4 v3, s[20:23], s13 offen offset:1024 sc1 lds
    buffer_load_dwordx4 v3, s[20:23], s13 offen offset:2048 sc1 lds
    buffer_load_dwordx4 v3, s[20:23], s13 offen offset:3072 sc1 lds
    s_add_u32 m0, s42, s36
    s_add_u32 s14, s13, s41
    s_cmp_ge_u32 s12, 2
    s_cbranch_scc1 g2_phase_d_24
    buffer_load_dwordx4 v3, s[20:23], s14 offen sc1 lds
g2_phase_d_24:
    s_add_u32 s51, s51, 1
    s_cmp_lg_u32 s51, 3
    s_cselect_b32 s44, 1, -2
    s_cselect_b32 s51, s51, 0
    s_add_u32 s37, s37, 1
    s_cmp_lg_u32 s37, 3
    s_cselect_b32 s52, 0, 3
    s_cselect_b32 s37, s37, 0
    s_add_u32 s44, s44, s52
    s_mul_i32 s52, s44, 18432
    s_mul_i32 s44, s44, s53
    v_add_u32 v4, s44, v4
    v_add_u32 v5, s44, v5
    s_add_u32 s13, s13, s52
    s_add_u32 s36, s36, 34816
    s_cmp_lg_u32 s36, 139264
    s_cselect_b32 s36, s36, 0
    s_add_u32 s45, s45, 1
    s_cmp_lt_u32 s45, 18
    s_cbranch_scc1 g2_phase_ll_23
    s_waitcnt vmcnt(16)
    s_barrier
    s_waitcnt vmcnt(8)
    s_barrier
    s_waitcnt vmcnt(0)
    s_barrier
    s_mov_b64 exec, -1
    s_endpgm
g2_phase_cons:
    s_setprio 0
    s_load_dwordx2 s[6:7], s[0:1], 64
    s_load_dwordx2 s[56:57], s[0:1], 72
    s_mov_b32 s47, 0
    s_mov_b32 s48, s12
    s_mul_i32 s14, s47, 9216
    v_add_u32 v6, s14, v3
    v_lshrrev_b32 v192, 2, v2
    v_and_b32 v193, 7, v192
    v_lshlrev_b32 v193, 5, v193
    v_lshl_add_u32 v193, v192, 8, v193
    v_and_b32 v194, 3, v2
    v_lshl_add_u32 v193, v194, 3, v193
    s_mul_i32 s14, s48, 2
    s_add_u32 s15, s14, 0
    s_lshl_b32 s15, s15, 5
    v_xor_b32 v8, s15, v193
    s_add_u32 s15, s14, 1
    s_lshl_b32 s15, s15, 5
    v_xor_b32 v9, s15, v193
    v_add_u32 v200, 65536, v6
    v_add_u32 v201, 65536, v8
    v_add_u32 v202, 65536, v9
    v_add_u32 v205, 131072, v6
    v_add_u32 v206, 131072, v8
    v_add_u32 v207, 131072, v9
    v_pk_mov_b32 v[120:121], 0, 0
    v_pk_mov_b32 v[122:123], 0, 0
    v_pk_mov_b32 v[124:125], 0, 0
    v_pk_mov_b32 v[126:127], 0, 0
    v_pk_mov_b32 v[128:129], 0, 0
    v_pk_mov_b32 v[130:131], 0, 0
    v_pk_mov_b32 v[132:133], 0, 0
    v_pk_mov_b32 v[134:135], 0, 0
    v_pk_mov_b32 v[136:137], 0, 0
    v_pk_mov_b32 v[138:139], 0, 0
    v_pk_mov_b32 v[140:141], 0, 0
    v_pk_mov_b32 v[142:143], 0, 0
    v_pk_mov_b32 v[144:145], 0, 0
    v_pk_mov_b32 v[146:147], 0, 0
    v_pk_mov_b32 v[148:149], 0, 0
    v_pk_mov_b32 v[150:151], 0, 0
    v_pk_mov_b32 v[152:153], 0, 0
    v_pk_mov_b32 v[154:155], 0, 0
    v_pk_mov_b32 v[156:157], 0, 0
    v_pk_mov_b32 v[158:159], 0, 0
    v_pk_mov_b32 v[160:161], 0, 0
    v_pk_mov_b32 v[162:163], 0, 0
    v_pk_mov_b32 v[164:165], 0, 0
    v_pk_mov_b32 v[166:167], 0, 0
    v_pk_mov_b32 v[168:169], 0, 0
    v_pk_mov_b32 v[170:171], 0, 0
    v_pk_mov_b32 v[172:173], 0, 0
    v_pk_mov_b32 v[174:175], 0, 0
    v_pk_mov_b32 v[176:177], 0, 0
    v_pk_mov_b32 v[178:179], 0, 0
    v_pk_mov_b32 v[180:181], 0, 0
    v_pk_mov_b32 v[182:183], 0, 0
    v_pk_mov_b32 v[184:185], 0, 0
    v_pk_mov_b32 v[186:187], 0, 0
    v_pk_mov_b32 v[188:189], 0, 0
    v_pk_mov_b32 v[190:191], 0, 0
    s_mov_b32 s45, 0xffff0000
    s_waitcnt lgkmcnt(0)
    s_mov_b32 s28, s6
    s_mov_b32 s29, s7
    s_mov_b32 s30, 4096
    s_mov_b32 s31, 0x00020000
    s_mov_b32 s24, s56
    s_mov_b32 s25, s57
    s_mov_b32 s26, 2359296
    s_mov_b32 s27, 0x00020000
    s_mov_b32 s59, 20480
    s_add_u32 s60, s8, 12582912
    s_addc_u32 s61, s9, 0
    s_mov_b32 s62, 2359296
    s_mov_b32 s63, 0x00020000
    s_add_u32 s84, s8, 16777216
    s_addc_u32 s85, s9, 0
    s_mov_b32 s86, 33554432
    s_mov_b32 s87, 0x00020000
    s_add_u32 s88, s8, 67108864
    s_addc_u32 s89, s9, 0
    s_mov_b32 s90, 65536
    s_mov_b32 s91, 0x00020000
    s_lshl_b32 s14, s10, 7
    s_lshl_b32 s15, s46, 5
    s_add_u32 s14, s14, s15
    v_add_u32 v192, s14, v7
    v_lshlrev_b32 v193, 1, v192
    buffer_load_ushort v12, v193, s[28:31], 0 offen
    buffer_load_ushort v13, v193, s[28:31], 0 offen offset:32
    v_lshlrev_b32 v14, 3, v2
    s_lshl_b32 s14, s10, 3
    s_lshl_b32 s15, s46, 1
    s_add_u32 s14, s14, s15
    s_mul_i32 s14, s14, 36
    s_mul_i32 s15, s11, 9
    s_add_u32 s14, s14, s15
    s_add_u32 s14, s14, s12
    s_lshl_b32 s32, s14, 9
    s_add_u32 s33, s32, 18432
    s_add_u32 s34, s32, 4096
    s_add_u32 s35, s33, 4096
    s_cmp_lg_u32 s12, 0
    s_cselect_b32 s34, 0x40000000, s34
    s_cselect_b32 s35, 0x40000000, s35
    v_mul_u32_u24 v15, 304, v7
    v_lshl_add_u32 v15, v1, 3, v15
    s_lshl_b32 s15, s12, 5
    s_add_u32 s15, s15, 20480
    v_add_u32 v15, s15, v15
    s_lshl_b32 s15, s12, 6
    v_add_u32 v194, s15, v2
    v_mul_u32_u24 v195, 3641, v194
    v_lshrrev_b32 v195, 16, v195
    v_lshlrev_b32 v194, 4, v194
    v_mul_u32_u24 v196, 16, v195
    v_add3_u32 v16, v194, v196, s59
    v_mul_u32_u24 v196, 864, v195
    v_add_u32 v4, v194, v196
    v_add_u32 v194, s15, v2
    v_add_u32 v194, 256, v194
    v_mul_u32_u24 v195, 3641, v194
    v_lshrrev_b32 v195, 16, v195
    v_lshlrev_b32 v194, 4, v194
    v_mul_u32_u24 v196, 16, v195
    v_add3_u32 v17, v194, v196, s59
    v_mul_u32_u24 v196, 864, v195
    v_add_u32 v5, v194, v196
    v_add_u32 v194, s15, v2
    v_add_u32 v194, 512, v194
    v_mul_u32_u24 v195, 3641, v194
    v_lshrrev_b32 v195, 16, v195
    v_lshlrev_b32 v194, 4, v194
    v_mul_u32_u24 v196, 16, v195
    v_add3_u32 v18, v194, v196, s59
    v_mul_u32_u24 v196, 864, v195
    v_add_u32 v19, v194, v196
    s_lshl_b32 s14, s10, 7
    s_lshl_b32 s15, s46, 5
    s_add_u32 s14, s14, s15
    s_mul_i32 s14, s14, 1152
    s_mul_i32 s15, s11, 288
    s_add_u32 s36, s14, s15
    s_lshl_b32 s14, s10, 2
    s_add_u32 s14, s14, s11
    s_lshl_b32 s14, s14, 2
    s_add_u32 s15, s14, s12
    s_lshl_b32 s49, s15, 7
    s_add_u32 s49, s49, 32768
    s_lshl_b32 s15, s15, 2
    s_add_u32 s15, s15, s46
    s_mul_i32 s40, s15, 9216
    s_add_u32 s15, s14, s46
    s_lshl_b32 s38, s15, 7
    s_add_u32 s38, s38, 32768
    s_mul_i32 s41, s15, 36864
    s_lshl_b32 s15, s12, 10
    s_add_u32 s41, s41, s15
    s_add_u32 s15, s46, 1
    s_and_b32 s15, s15, 3
    s_mul_i32 s15, s15, 9216
    s_add_u32 s42, s41, s15
    s_add_u32 s15, s46, 2
    s_and_b32 s15, s15, 3
    s_mul_i32 s15, s15, 9216
    s_add_u32 s43, s41, s15
    s_add_u32 s15, s46, 3
    s_and_b32 s15, s15, 3
    s_mul_i32 s15, s15, 9216
    s_add_u32 s44, s41, s15
    s_barrier
    ds_read_b64_tr_b16 v[68:69], v8 offset:18432
    ds_read_b64_tr_b16 v[70:71], v8 offset:22528
    ds_read_b128 v[32:35], v6 offset:0
    ds_read_b128 v[36:39], v6 offset:1024
    ds_read_b128 v[40:43], v6 offset:2048
    ds_read_b128 v[44:47], v6 offset:3072
    ds_read_b128 v[48:51], v6 offset:4096
    ds_read_b128 v[52:55], v6 offset:5120
    ds_read_b128 v[56:59], v6 offset:6144
    ds_read_b128 v[60:63], v6 offset:7168
    ds_read_b128 v[64:67], v6 offset:8192
    ds_read_b64_tr_b16 v[72:73], v9 offset:18432
    ds_read_b64_tr_b16 v[74:75], v9 offset:22528
    buffer_load_dwordx2 v[20:21], v14, s[60:63], s32 offen offset:0 sc1
    buffer_load_dwordx2 v[22:23], v14, s[60:63], s33 offen offset:0 sc1
    buffer_load_dwordx2 v[24:25], v14, s[60:63], s32 offen offset:2048 sc1
    buffer_load_dwordx2 v[26:27], v14, s[60:63], s33 offen offset:2048 sc1
    buffer_load_dwordx2 v[28:29], v14, s[60:63], s34 offen offset:0 sc1
    buffer_load_dwordx2 v[30:31], v14, s[60:63], s35 offen offset:0 sc1
    s_mov_b32 s59, 0
g2_phase_loop_25:
    s_waitcnt lgkmcnt(0)
    v_mfma_f32_16x16x32_bf16 v[120:123], v[32:35], v[68:71], v[120:123]
    ds_read_b64_tr_b16 v[112:113], v8 offset:26624
    v_mfma_f32_16x16x32_bf16 v[124:127], v[36:39], v[68:71], v[124:127]
    ds_read_b64_tr_b16 v[114:115], v8 offset:30720
    v_mfma_f32_16x16x32_bf16 v[128:131], v[40:43], v[68:71], v[128:131]
    ds_read_b128 v[76:79], v6 offset:9216
    v_mfma_f32_16x16x32_bf16 v[132:135], v[44:47], v[68:71], v[132:135]
    ds_read_b128 v[80:83], v6 offset:10240
    v_mfma_f32_16x16x32_bf16 v[136:139], v[48:51], v[68:71], v[136:139]
    ds_read_b128 v[84:87], v6 offset:11264
    v_mfma_f32_16x16x32_bf16 v[140:143], v[52:55], v[68:71], v[140:143]
    ds_read_b128 v[88:91], v6 offset:12288
    v_mfma_f32_16x16x32_bf16 v[144:147], v[56:59], v[68:71], v[144:147]
    ds_read_b128 v[92:95], v6 offset:13312
    v_mfma_f32_16x16x32_bf16 v[148:151], v[60:63], v[68:71], v[148:151]
    ds_read_b128 v[96:99], v6 offset:14336
    v_mfma_f32_16x16x32_bf16 v[152:155], v[64:67], v[68:71], v[152:155]
    ds_read_b128 v[100:103], v6 offset:15360
    v_mfma_f32_16x16x32_bf16 v[156:159], v[32:35], v[72:75], v[156:159]
    ds_read_b128 v[104:107], v6 offset:16384
    v_mfma_f32_16x16x32_bf16 v[160:163], v[36:39], v[72:75], v[160:163]
    ds_read_b128 v[108:111], v6 offset:17408
    v_mfma_f32_16x16x32_bf16 v[164:167], v[40:43], v[72:75], v[164:167]
    ds_read_b64_tr_b16 v[116:117], v9 offset:26624
    v_mfma_f32_16x16x32_bf16 v[168:171], v[44:47], v[72:75], v[168:171]
    ds_read_b64_tr_b16 v[118:119], v9 offset:30720
    v_mfma_f32_16x16x32_bf16 v[172:175], v[48:51], v[72:75], v[172:175]
    v_mfma_f32_16x16x32_bf16 v[176:179], v[52:55], v[72:75], v[176:179]
    v_mfma_f32_16x16x32_bf16 v[180:183], v[56:59], v[72:75], v[180:183]
    v_mfma_f32_16x16x32_bf16 v[184:187], v[60:63], v[72:75], v[184:187]
    v_mfma_f32_16x16x32_bf16 v[188:191], v[64:67], v[72:75], v[188:191]
    s_waitcnt lgkmcnt(0)
    s_barrier
    v_mfma_f32_16x16x32_bf16 v[120:123], v[76:79], v[112:115], v[120:123]
    ds_read_b64_tr_b16 v[68:69], v8 offset:53248
    v_mfma_f32_16x16x32_bf16 v[124:127], v[80:83], v[112:115], v[124:127]
    ds_read_b64_tr_b16 v[70:71], v8 offset:57344
    v_mfma_f32_16x16x32_bf16 v[128:131], v[84:87], v[112:115], v[128:131]
    ds_read_b128 v[32:35], v6 offset:34816
    v_mfma_f32_16x16x32_bf16 v[132:135], v[88:91], v[112:115], v[132:135]
    ds_read_b128 v[36:39], v6 offset:35840
    v_mfma_f32_16x16x32_bf16 v[136:139], v[92:95], v[112:115], v[136:139]
    ds_read_b128 v[40:43], v6 offset:36864
    v_mfma_f32_16x16x32_bf16 v[140:143], v[96:99], v[112:115], v[140:143]
    ds_read_b128 v[44:47], v6 offset:37888
    v_mfma_f32_16x16x32_bf16 v[144:147], v[100:103], v[112:115], v[144:147]
    ds_read_b128 v[48:51], v6 offset:38912
    v_mfma_f32_16x16x32_bf16 v[148:151], v[104:107], v[112:115], v[148:151]
    ds_read_b128 v[52:55], v6 offset:39936
    v_mfma_f32_16x16x32_bf16 v[152:155], v[108:111], v[112:115], v[152:155]
    ds_read_b128 v[56:59], v6 offset:40960
    v_mfma_f32_16x16x32_bf16 v[156:159], v[76:79], v[116:119], v[156:159]
    ds_read_b128 v[60:63], v6 offset:41984
    v_mfma_f32_16x16x32_bf16 v[160:163], v[80:83], v[116:119], v[160:163]
    ds_read_b128 v[64:67], v6 offset:43008
    v_mfma_f32_16x16x32_bf16 v[164:167], v[84:87], v[116:119], v[164:167]
    ds_read_b64_tr_b16 v[72:73], v9 offset:53248
    v_mfma_f32_16x16x32_bf16 v[168:171], v[88:91], v[116:119], v[168:171]
    ds_read_b64_tr_b16 v[74:75], v9 offset:57344
    v_mfma_f32_16x16x32_bf16 v[172:175], v[92:95], v[116:119], v[172:175]
    v_mfma_f32_16x16x32_bf16 v[176:179], v[96:99], v[116:119], v[176:179]
    v_mfma_f32_16x16x32_bf16 v[180:183], v[100:103], v[116:119], v[180:183]
    v_mfma_f32_16x16x32_bf16 v[184:187], v[104:107], v[116:119], v[184:187]
    v_mfma_f32_16x16x32_bf16 v[188:191], v[108:111], v[116:119], v[188:191]
    s_waitcnt lgkmcnt(0)
    v_mfma_f32_16x16x32_bf16 v[120:123], v[32:35], v[68:71], v[120:123]
    ds_read_b64_tr_b16 v[112:113], v8 offset:61440
    v_mfma_f32_16x16x32_bf16 v[124:127], v[36:39], v[68:71], v[124:127]
    ds_read_b64_tr_b16 v[114:115], v201 offset:0
    v_mfma_f32_16x16x32_bf16 v[128:131], v[40:43], v[68:71], v[128:131]
    ds_read_b128 v[76:79], v6 offset:44032
    v_mfma_f32_16x16x32_bf16 v[132:135], v[44:47], v[68:71], v[132:135]
    ds_read_b128 v[80:83], v6 offset:45056
    v_mfma_f32_16x16x32_bf16 v[136:139], v[48:51], v[68:71], v[136:139]
    ds_read_b128 v[84:87], v6 offset:46080
    v_mfma_f32_16x16x32_bf16 v[140:143], v[52:55], v[68:71], v[140:143]
    ds_read_b128 v[88:91], v6 offset:47104
    v_mfma_f32_16x16x32_bf16 v[144:147], v[56:59], v[68:71], v[144:147]
    ds_read_b128 v[92:95], v6 offset:48128
    v_mfma_f32_16x16x32_bf16 v[148:151], v[60:63], v[68:71], v[148:151]
    ds_read_b128 v[96:99], v6 offset:49152
    v_mfma_f32_16x16x32_bf16 v[152:155], v[64:67], v[68:71], v[152:155]
    ds_read_b128 v[100:103], v6 offset:50176
    v_mfma_f32_16x16x32_bf16 v[156:159], v[32:35], v[72:75], v[156:159]
    ds_read_b128 v[104:107], v6 offset:51200
    v_mfma_f32_16x16x32_bf16 v[160:163], v[36:39], v[72:75], v[160:163]
    ds_read_b128 v[108:111], v6 offset:52224
    v_mfma_f32_16x16x32_bf16 v[164:167], v[40:43], v[72:75], v[164:167]
    ds_read_b64_tr_b16 v[116:117], v9 offset:61440
    v_mfma_f32_16x16x32_bf16 v[168:171], v[44:47], v[72:75], v[168:171]
    ds_read_b64_tr_b16 v[118:119], v202 offset:0
    v_mfma_f32_16x16x32_bf16 v[172:175], v[48:51], v[72:75], v[172:175]
    v_mfma_f32_16x16x32_bf16 v[176:179], v[52:55], v[72:75], v[176:179]
    v_mfma_f32_16x16x32_bf16 v[180:183], v[56:59], v[72:75], v[180:183]
    v_mfma_f32_16x16x32_bf16 v[184:187], v[60:63], v[72:75], v[184:187]
    v_mfma_f32_16x16x32_bf16 v[188:191], v[64:67], v[72:75], v[188:191]
    s_waitcnt lgkmcnt(0)
    s_barrier
    v_mfma_f32_16x16x32_bf16 v[120:123], v[76:79], v[112:115], v[120:123]
    ds_read_b64_tr_b16 v[68:69], v201 offset:22528
    v_mfma_f32_16x16x32_bf16 v[124:127], v[80:83], v[112:115], v[124:127]
    ds_read_b64_tr_b16 v[70:71], v201 offset:26624
    v_mfma_f32_16x16x32_bf16 v[128:131], v[84:87], v[112:115], v[128:131]
    ds_read_b128 v[32:35], v200 offset:4096
    v_mfma_f32_16x16x32_bf16 v[132:135], v[88:91], v[112:115], v[132:135]
    ds_read_b128 v[36:39], v200 offset:5120
    v_mfma_f32_16x16x32_bf16 v[136:139], v[92:95], v[112:115], v[136:139]
    ds_read_b128 v[40:43], v200 offset:6144
    v_mfma_f32_16x16x32_bf16 v[140:143], v[96:99], v[112:115], v[140:143]
    ds_read_b128 v[44:47], v200 offset:7168
    v_mfma_f32_16x16x32_bf16 v[144:147], v[100:103], v[112:115], v[144:147]
    ds_read_b128 v[48:51], v200 offset:8192
    v_mfma_f32_16x16x32_bf16 v[148:151], v[104:107], v[112:115], v[148:151]
    ds_read_b128 v[52:55], v200 offset:9216
    v_mfma_f32_16x16x32_bf16 v[152:155], v[108:111], v[112:115], v[152:155]
    ds_read_b128 v[56:59], v200 offset:10240
    v_mfma_f32_16x16x32_bf16 v[156:159], v[76:79], v[116:119], v[156:159]
    ds_read_b128 v[60:63], v200 offset:11264
    v_mfma_f32_16x16x32_bf16 v[160:163], v[80:83], v[116:119], v[160:163]
    ds_read_b128 v[64:67], v200 offset:12288
    v_mfma_f32_16x16x32_bf16 v[164:167], v[84:87], v[116:119], v[164:167]
    ds_read_b64_tr_b16 v[72:73], v202 offset:22528
    v_mfma_f32_16x16x32_bf16 v[168:171], v[88:91], v[116:119], v[168:171]
    ds_read_b64_tr_b16 v[74:75], v202 offset:26624
    v_mfma_f32_16x16x32_bf16 v[172:175], v[92:95], v[116:119], v[172:175]
    v_mfma_f32_16x16x32_bf16 v[176:179], v[96:99], v[116:119], v[176:179]
    v_mfma_f32_16x16x32_bf16 v[180:183], v[100:103], v[116:119], v[180:183]
    v_mfma_f32_16x16x32_bf16 v[184:187], v[104:107], v[116:119], v[184:187]
    v_mfma_f32_16x16x32_bf16 v[188:191], v[108:111], v[116:119], v[188:191]
    s_waitcnt lgkmcnt(0)
    v_mfma_f32_16x16x32_bf16 v[120:123], v[32:35], v[68:71], v[120:123]
    ds_read_b64_tr_b16 v[112:113], v201 offset:30720
    v_mfma_f32_16x16x32_bf16 v[124:127], v[36:39], v[68:71], v[124:127]
    ds_read_b64_tr_b16 v[114:115], v201 offset:34816
    v_mfma_f32_16x16x32_bf16 v[128:131], v[40:43], v[68:71], v[128:131]
    ds_read_b128 v[76:79], v200 offset:13312
    v_mfma_f32_16x16x32_bf16 v[132:135], v[44:47], v[68:71], v[132:135]
    ds_read_b128 v[80:83], v200 offset:14336
    v_mfma_f32_16x16x32_bf16 v[136:139], v[48:51], v[68:71], v[136:139]
    ds_read_b128 v[84:87], v200 offset:15360
    v_mfma_f32_16x16x32_bf16 v[140:143], v[52:55], v[68:71], v[140:143]
    ds_read_b128 v[88:91], v200 offset:16384
    v_mfma_f32_16x16x32_bf16 v[144:147], v[56:59], v[68:71], v[144:147]
    ds_read_b128 v[92:95], v200 offset:17408
    v_mfma_f32_16x16x32_bf16 v[148:151], v[60:63], v[68:71], v[148:151]
    ds_read_b128 v[96:99], v200 offset:18432
    v_mfma_f32_16x16x32_bf16 v[152:155], v[64:67], v[68:71], v[152:155]
    ds_read_b128 v[100:103], v200 offset:19456
    v_mfma_f32_16x16x32_bf16 v[156:159], v[32:35], v[72:75], v[156:159]
    ds_read_b128 v[104:107], v200 offset:20480
    v_mfma_f32_16x16x32_bf16 v[160:163], v[36:39], v[72:75], v[160:163]
    ds_read_b128 v[108:111], v200 offset:21504
    v_mfma_f32_16x16x32_bf16 v[164:167], v[40:43], v[72:75], v[164:167]
    ds_read_b64_tr_b16 v[116:117], v202 offset:30720
    v_mfma_f32_16x16x32_bf16 v[168:171], v[44:47], v[72:75], v[168:171]
    ds_read_b64_tr_b16 v[118:119], v202 offset:34816
    v_mfma_f32_16x16x32_bf16 v[172:175], v[48:51], v[72:75], v[172:175]
    v_mfma_f32_16x16x32_bf16 v[176:179], v[52:55], v[72:75], v[176:179]
    v_mfma_f32_16x16x32_bf16 v[180:183], v[56:59], v[72:75], v[180:183]
    v_mfma_f32_16x16x32_bf16 v[184:187], v[60:63], v[72:75], v[184:187]
    v_mfma_f32_16x16x32_bf16 v[188:191], v[64:67], v[72:75], v[188:191]
    s_waitcnt lgkmcnt(0)
    s_barrier
    v_mfma_f32_16x16x32_bf16 v[120:123], v[76:79], v[112:115], v[120:123]
    ds_read_b64_tr_b16 v[68:69], v201 offset:57344
    v_mfma_f32_16x16x32_bf16 v[124:127], v[80:83], v[112:115], v[124:127]
    ds_read_b64_tr_b16 v[70:71], v201 offset:61440
    v_mfma_f32_16x16x32_bf16 v[128:131], v[84:87], v[112:115], v[128:131]
    ds_read_b128 v[32:35], v200 offset:38912
    v_mfma_f32_16x16x32_bf16 v[132:135], v[88:91], v[112:115], v[132:135]
    ds_read_b128 v[36:39], v200 offset:39936
    v_mfma_f32_16x16x32_bf16 v[136:139], v[92:95], v[112:115], v[136:139]
    ds_read_b128 v[40:43], v200 offset:40960
    v_mfma_f32_16x16x32_bf16 v[140:143], v[96:99], v[112:115], v[140:143]
    ds_read_b128 v[44:47], v200 offset:41984
    v_mfma_f32_16x16x32_bf16 v[144:147], v[100:103], v[112:115], v[144:147]
    ds_read_b128 v[48:51], v200 offset:43008
    v_mfma_f32_16x16x32_bf16 v[148:151], v[104:107], v[112:115], v[148:151]
    ds_read_b128 v[52:55], v200 offset:44032
    v_mfma_f32_16x16x32_bf16 v[152:155], v[108:111], v[112:115], v[152:155]
    ds_read_b128 v[56:59], v200 offset:45056
    v_mfma_f32_16x16x32_bf16 v[156:159], v[76:79], v[116:119], v[156:159]
    ds_read_b128 v[60:63], v200 offset:46080
    v_mfma_f32_16x16x32_bf16 v[160:163], v[80:83], v[116:119], v[160:163]
    ds_read_b128 v[64:67], v200 offset:47104
    v_mfma_f32_16x16x32_bf16 v[164:167], v[84:87], v[116:119], v[164:167]
    ds_read_b64_tr_b16 v[72:73], v202 offset:57344
    v_mfma_f32_16x16x32_bf16 v[168:171], v[88:91], v[116:119], v[168:171]
    ds_read_b64_tr_b16 v[74:75], v202 offset:61440
    v_mfma_f32_16x16x32_bf16 v[172:175], v[92:95], v[116:119], v[172:175]
    v_mfma_f32_16x16x32_bf16 v[176:179], v[96:99], v[116:119], v[176:179]
    v_mfma_f32_16x16x32_bf16 v[180:183], v[100:103], v[116:119], v[180:183]
    v_mfma_f32_16x16x32_bf16 v[184:187], v[104:107], v[116:119], v[184:187]
    v_mfma_f32_16x16x32_bf16 v[188:191], v[108:111], v[116:119], v[188:191]
    s_waitcnt lgkmcnt(0)
    v_mfma_f32_16x16x32_bf16 v[120:123], v[32:35], v[68:71], v[120:123]
    ds_read_b64_tr_b16 v[112:113], v206 offset:0
    v_mfma_f32_16x16x32_bf16 v[124:127], v[36:39], v[68:71], v[124:127]
    ds_read_b64_tr_b16 v[114:115], v206 offset:4096
    v_mfma_f32_16x16x32_bf16 v[128:131], v[40:43], v[68:71], v[128:131]
    ds_read_b128 v[76:79], v200 offset:48128
    v_mfma_f32_16x16x32_bf16 v[132:135], v[44:47], v[68:71], v[132:135]
    ds_read_b128 v[80:83], v200 offset:49152
    v_mfma_f32_16x16x32_bf16 v[136:139], v[48:51], v[68:71], v[136:139]
    ds_read_b128 v[84:87], v200 offset:50176
    v_mfma_f32_16x16x32_bf16 v[140:143], v[52:55], v[68:71], v[140:143]
    ds_read_b128 v[88:91], v200 offset:51200
    v_mfma_f32_16x16x32_bf16 v[144:147], v[56:59], v[68:71], v[144:147]
    ds_read_b128 v[92:95], v200 offset:52224
    v_mfma_f32_16x16x32_bf16 v[148:151], v[60:63], v[68:71], v[148:151]
    ds_read_b128 v[96:99], v200 offset:53248
    v_mfma_f32_16x16x32_bf16 v[152:155], v[64:67], v[68:71], v[152:155]
    ds_read_b128 v[100:103], v200 offset:54272
    v_mfma_f32_16x16x32_bf16 v[156:159], v[32:35], v[72:75], v[156:159]
    ds_read_b128 v[104:107], v200 offset:55296
    v_mfma_f32_16x16x32_bf16 v[160:163], v[36:39], v[72:75], v[160:163]
    ds_read_b128 v[108:111], v200 offset:56320
    v_mfma_f32_16x16x32_bf16 v[164:167], v[40:43], v[72:75], v[164:167]
    ds_read_b64_tr_b16 v[116:117], v207 offset:0
    v_mfma_f32_16x16x32_bf16 v[168:171], v[44:47], v[72:75], v[168:171]
    ds_read_b64_tr_b16 v[118:119], v207 offset:4096
    v_mfma_f32_16x16x32_bf16 v[172:175], v[48:51], v[72:75], v[172:175]
    v_mfma_f32_16x16x32_bf16 v[176:179], v[52:55], v[72:75], v[176:179]
    v_mfma_f32_16x16x32_bf16 v[180:183], v[56:59], v[72:75], v[180:183]
    v_mfma_f32_16x16x32_bf16 v[184:187], v[60:63], v[72:75], v[184:187]
    v_mfma_f32_16x16x32_bf16 v[188:191], v[64:67], v[72:75], v[188:191]
    s_waitcnt lgkmcnt(0)
    s_barrier
    v_mfma_f32_16x16x32_bf16 v[120:123], v[76:79], v[112:115], v[120:123]
    ds_read_b64_tr_b16 v[68:69], v8 offset:18432
    v_mfma_f32_16x16x32_bf16 v[124:127], v[80:83], v[112:115], v[124:127]
    ds_read_b64_tr_b16 v[70:71], v8 offset:22528
    v_mfma_f32_16x16x32_bf16 v[128:131], v[84:87], v[112:115], v[128:131]
    ds_read_b128 v[32:35], v6 offset:0
    v_mfma_f32_16x16x32_bf16 v[132:135], v[88:91], v[112:115], v[132:135]
    ds_read_b128 v[36:39], v6 offset:1024
    v_mfma_f32_16x16x32_bf16 v[136:139], v[92:95], v[112:115], v[136:139]
    ds_read_b128 v[40:43], v6 offset:2048
    v_mfma_f32_16x16x32_bf16 v[140:143], v[96:99], v[112:115], v[140:143]
    ds_read_b128 v[44:47], v6 offset:3072
    v_mfma_f32_16x16x32_bf16 v[144:147], v[100:103], v[112:115], v[144:147]
    ds_read_b128 v[48:51], v6 offset:4096
    v_mfma_f32_16x16x32_bf16 v[148:151], v[104:107], v[112:115], v[148:151]
    ds_read_b128 v[52:55], v6 offset:5120
    v_mfma_f32_16x16x32_bf16 v[152:155], v[108:111], v[112:115], v[152:155]
    ds_read_b128 v[56:59], v6 offset:6144
    v_mfma_f32_16x16x32_bf16 v[156:159], v[76:79], v[116:119], v[156:159]
    ds_read_b128 v[60:63], v6 offset:7168
    v_mfma_f32_16x16x32_bf16 v[160:163], v[80:83], v[116:119], v[160:163]
    ds_read_b128 v[64:67], v6 offset:8192
    v_mfma_f32_16x16x32_bf16 v[164:167], v[84:87], v[116:119], v[164:167]
    ds_read_b64_tr_b16 v[72:73], v9 offset:18432
    v_mfma_f32_16x16x32_bf16 v[168:171], v[88:91], v[116:119], v[168:171]
    ds_read_b64_tr_b16 v[74:75], v9 offset:22528
    v_mfma_f32_16x16x32_bf16 v[172:175], v[92:95], v[116:119], v[172:175]
    v_mfma_f32_16x16x32_bf16 v[176:179], v[96:99], v[116:119], v[176:179]
    v_mfma_f32_16x16x32_bf16 v[180:183], v[100:103], v[116:119], v[180:183]
    v_mfma_f32_16x16x32_bf16 v[184:187], v[104:107], v[116:119], v[184:187]
    v_mfma_f32_16x16x32_bf16 v[188:191], v[108:111], v[116:119], v[188:191]
    s_add_u32 s59, s59, 1
    s_cmp_lt_u32 s59, 4
    s_cbranch_scc1 g2_phase_loop_25
    s_waitcnt lgkmcnt(0)
    v_mfma_f32_16x16x32_bf16 v[120:123], v[32:35], v[68:71], v[120:123]
    ds_read_b64_tr_b16 v[112:113], v8 offset:26624
    v_mfma_f32_16x16x32_bf16 v[124:127], v[36:39], v[68:71], v[124:127]
    ds_read_b64_tr_b16 v[114:115], v8 offset:30720
    v_mfma_f32_16x16x32_bf16 v[128:131], v[40:43], v[68:71], v[128:131]
    ds_read_b128 v[76:79], v6 offset:9216
    v_mfma_f32_16x16x32_bf16 v[132:135], v[44:47], v[68:71], v[132:135]
    ds_read_b128 v[80:83], v6 offset:10240
    v_mfma_f32_16x16x32_bf16 v[136:139], v[48:51], v[68:71], v[136:139]
    ds_read_b128 v[84:87], v6 offset:11264
    v_mfma_f32_16x16x32_bf16 v[140:143], v[52:55], v[68:71], v[140:143]
    ds_read_b128 v[88:91], v6 offset:12288
    v_mfma_f32_16x16x32_bf16 v[144:147], v[56:59], v[68:71], v[144:147]
    ds_read_b128 v[92:95], v6 offset:13312
    v_mfma_f32_16x16x32_bf16 v[148:151], v[60:63], v[68:71], v[148:151]
    ds_read_b128 v[96:99], v6 offset:14336
    v_mfma_f32_16x16x32_bf16 v[152:155], v[64:67], v[68:71], v[152:155]
    ds_read_b128 v[100:103], v6 offset:15360
    v_mfma_f32_16x16x32_bf16 v[156:159], v[32:35], v[72:75], v[156:159]
    ds_read_b128 v[104:107], v6 offset:16384
    v_mfma_f32_16x16x32_bf16 v[160:163], v[36:39], v[72:75], v[160:163]
    ds_read_b128 v[108:111], v6 offset:17408
    v_mfma_f32_16x16x32_bf16 v[164:167], v[40:43], v[72:75], v[164:167]
    ds_read_b64_tr_b16 v[116:117], v9 offset:26624
    v_mfma_f32_16x16x32_bf16 v[168:171], v[44:47], v[72:75], v[168:171]
    ds_read_b64_tr_b16 v[118:119], v9 offset:30720
    v_mfma_f32_16x16x32_bf16 v[172:175], v[48:51], v[72:75], v[172:175]
    v_mfma_f32_16x16x32_bf16 v[176:179], v[52:55], v[72:75], v[176:179]
    v_mfma_f32_16x16x32_bf16 v[180:183], v[56:59], v[72:75], v[180:183]
    v_mfma_f32_16x16x32_bf16 v[184:187], v[60:63], v[72:75], v[184:187]
    v_mfma_f32_16x16x32_bf16 v[188:191], v[64:67], v[72:75], v[188:191]
    s_waitcnt lgkmcnt(0)
    s_barrier
    v_mfma_f32_16x16x32_bf16 v[120:123], v[76:79], v[112:115], v[120:123]
    ds_read_b64_tr_b16 v[68:69], v8 offset:53248
    v_mfma_f32_16x16x32_bf16 v[124:127], v[80:83], v[112:115], v[124:127]
    ds_read_b64_tr_b16 v[70:71], v8 offset:57344
    v_mfma_f32_16x16x32_bf16 v[128:131], v[84:87], v[112:115], v[128:131]
    ds_read_b128 v[32:35], v6 offset:34816
    v_mfma_f32_16x16x32_bf16 v[132:135], v[88:91], v[112:115], v[132:135]
    ds_read_b128 v[36:39], v6 offset:35840
    v_mfma_f32_16x16x32_bf16 v[136:139], v[92:95], v[112:115], v[136:139]
    ds_read_b128 v[40:43], v6 offset:36864
    v_mfma_f32_16x16x32_bf16 v[140:143], v[96:99], v[112:115], v[140:143]
    ds_read_b128 v[44:47], v6 offset:37888
    v_mfma_f32_16x16x32_bf16 v[144:147], v[100:103], v[112:115], v[144:147]
    ds_read_b128 v[48:51], v6 offset:38912
    v_mfma_f32_16x16x32_bf16 v[148:151], v[104:107], v[112:115], v[148:151]
    ds_read_b128 v[52:55], v6 offset:39936
    v_mfma_f32_16x16x32_bf16 v[152:155], v[108:111], v[112:115], v[152:155]
    ds_read_b128 v[56:59], v6 offset:40960
    v_mfma_f32_16x16x32_bf16 v[156:159], v[76:79], v[116:119], v[156:159]
    ds_read_b128 v[60:63], v6 offset:41984
    v_mfma_f32_16x16x32_bf16 v[160:163], v[80:83], v[116:119], v[160:163]
    ds_read_b128 v[64:67], v6 offset:43008
    v_mfma_f32_16x16x32_bf16 v[164:167], v[84:87], v[116:119], v[164:167]
    ds_read_b64_tr_b16 v[72:73], v9 offset:53248
    v_mfma_f32_16x16x32_bf16 v[168:171], v[88:91], v[116:119], v[168:171]
    ds_read_b64_tr_b16 v[74:75], v9 offset:57344
    v_mfma_f32_16x16x32_bf16 v[172:175], v[92:95], v[116:119], v[172:175]
    v_mfma_f32_16x16x32_bf16 v[176:179], v[96:99], v[116:119], v[176:179]
    v_mfma_f32_16x16x32_bf16 v[180:183], v[100:103], v[116:119], v[180:183]
    v_mfma_f32_16x16x32_bf16 v[184:187], v[104:107], v[116:119], v[184:187]
    v_mfma_f32_16x16x32_bf16 v[188:191], v[108:111], v[116:119], v[188:191]
    s_waitcnt lgkmcnt(0)
    v_mfma_f32_16x16x32_bf16 v[120:123], v[32:35], v[68:71], v[120:123]
    ds_read_b64_tr_b16 v[112:113], v8 offset:61440
    v_mfma_f32_16x16x32_bf16 v[124:127], v[36:39], v[68:71], v[124:127]
    ds_read_b64_tr_b16 v[114:115], v201 offset:0
    v_mfma_f32_16x16x32_bf16 v[128:131], v[40:43], v[68:71], v[128:131]
    ds_read_b128 v[76:79], v6 offset:44032
    v_mfma_f32_16x16x32_bf16 v[132:135], v[44:47], v[68:71], v[132:135]
    ds_read_b128 v[80:83], v6 offset:45056
    v_mfma_f32_16x16x32_bf16 v[136:139], v[48:51], v[68:71], v[136:139]
    ds_read_b128 v[84:87], v6 offset:46080
    v_mfma_f32_16x16x32_bf16 v[140:143], v[52:55], v[68:71], v[140:143]
    ds_read_b128 v[88:91], v6 offset:47104
    v_mfma_f32_16x16x32_bf16 v[144:147], v[56:59], v[68:71], v[144:147]
    ds_read_b128 v[92:95], v6 offset:48128
    v_mfma_f32_16x16x32_bf16 v[148:151], v[60:63], v[68:71], v[148:151]
    ds_read_b128 v[96:99], v6 offset:49152
    v_mfma_f32_16x16x32_bf16 v[152:155], v[64:67], v[68:71], v[152:155]
    ds_read_b128 v[100:103], v6 offset:50176
    v_mfma_f32_16x16x32_bf16 v[156:159], v[32:35], v[72:75], v[156:159]
    ds_read_b128 v[104:107], v6 offset:51200
    v_mfma_f32_16x16x32_bf16 v[160:163], v[36:39], v[72:75], v[160:163]
    ds_read_b128 v[108:111], v6 offset:52224
    v_mfma_f32_16x16x32_bf16 v[164:167], v[40:43], v[72:75], v[164:167]
    ds_read_b64_tr_b16 v[116:117], v9 offset:61440
    v_mfma_f32_16x16x32_bf16 v[168:171], v[44:47], v[72:75], v[168:171]
    ds_read_b64_tr_b16 v[118:119], v202 offset:0
    v_mfma_f32_16x16x32_bf16 v[172:175], v[48:51], v[72:75], v[172:175]
    v_mfma_f32_16x16x32_bf16 v[176:179], v[52:55], v[72:75], v[176:179]
    v_mfma_f32_16x16x32_bf16 v[180:183], v[56:59], v[72:75], v[180:183]
    v_mfma_f32_16x16x32_bf16 v[184:187], v[60:63], v[72:75], v[184:187]
    v_mfma_f32_16x16x32_bf16 v[188:191], v[64:67], v[72:75], v[188:191]
    s_waitcnt lgkmcnt(0)
    v_mfma_f32_16x16x32_bf16 v[120:123], v[76:79], v[112:115], v[120:123]
    v_mfma_f32_16x16x32_bf16 v[124:127], v[80:83], v[112:115], v[124:127]
    v_mfma_f32_16x16x32_bf16 v[128:131], v[84:87], v[112:115], v[128:131]
    v_mfma_f32_16x16x32_bf16 v[132:135], v[88:91], v[112:115], v[132:135]
    v_mfma_f32_16x16x32_bf16 v[136:139], v[92:95], v[112:115], v[136:139]
    v_mfma_f32_16x16x32_bf16 v[140:143], v[96:99], v[112:115], v[140:143]
    v_mfma_f32_16x16x32_bf16 v[144:147], v[100:103], v[112:115], v[144:147]
    v_mfma_f32_16x16x32_bf16 v[148:151], v[104:107], v[112:115], v[148:151]
    v_mfma_f32_16x16x32_bf16 v[152:155], v[108:111], v[112:115], v[152:155]
    v_mfma_f32_16x16x32_bf16 v[156:159], v[76:79], v[116:119], v[156:159]
    v_mfma_f32_16x16x32_bf16 v[160:163], v[80:83], v[116:119], v[160:163]
    v_mfma_f32_16x16x32_bf16 v[164:167], v[84:87], v[116:119], v[164:167]
    v_mfma_f32_16x16x32_bf16 v[168:171], v[88:91], v[116:119], v[168:171]
    v_mfma_f32_16x16x32_bf16 v[172:175], v[92:95], v[116:119], v[172:175]
    v_mfma_f32_16x16x32_bf16 v[176:179], v[96:99], v[116:119], v[176:179]
    v_mfma_f32_16x16x32_bf16 v[180:183], v[100:103], v[116:119], v[180:183]
    v_mfma_f32_16x16x32_bf16 v[184:187], v[104:107], v[116:119], v[184:187]
    v_mfma_f32_16x16x32_bf16 v[188:191], v[108:111], v[116:119], v[188:191]
    v_mov_b32 v193, 0
    v_mov_b32 v192, 1
    s_lshl_b32 s15, s12, 10
    v_add_u32 v194, s15, v3
    v_lshlrev_b32 v12, 16, v12
    v_lshlrev_b32 v13, 16, v13
    s_cmp_eq_u32 s12, s46
    s_cbranch_scc1 g2_phase_own_26
    v_cvt_pk_bf16_f32 v32, v120, v121
    v_cvt_pk_bf16_f32 v33, v122, v123
    v_cvt_pk_bf16_f32 v34, v156, v157
    v_cvt_pk_bf16_f32 v35, v158, v159
    buffer_store_dwordx4 v[32:35], v3, s[84:87], s40 offen offset:0 sc1
    v_cvt_pk_bf16_f32 v36, v124, v125
    v_cvt_pk_bf16_f32 v37, v126, v127
    v_cvt_pk_bf16_f32 v38, v160, v161
    v_cvt_pk_bf16_f32 v39, v162, v163
    buffer_store_dwordx4 v[36:39], v3, s[84:87], s40 offen offset:1024 sc1
    v_cvt_pk_bf16_f32 v40, v128, v129
    v_cvt_pk_bf16_f32 v41, v130, v131
    v_cvt_pk_bf16_f32 v42, v164, v165
    v_cvt_pk_bf16_f32 v43, v166, v167
    buffer_store_dwordx4 v[40:43], v3, s[84:87], s40 offen offset:2048 sc1
    v_cvt_pk_bf16_f32 v44, v132, v133
    v_cvt_pk_bf16_f32 v45, v134, v135
    v_cvt_pk_bf16_f32 v46, v168, v169
    v_cvt_pk_bf16_f32 v47, v170, v171
    buffer_store_dwordx4 v[44:47], v3, s[84:87], s40 offen offset:3072 sc1
    v_cvt_pk_bf16_f32 v48, v136, v137
    v_cvt_pk_bf16_f32 v49, v138, v139
    v_cvt_pk_bf16_f32 v50, v172, v173
    v_cvt_pk_bf16_f32 v51, v174, v175
    s_add_u32 s40, s40, 4096
    buffer_store_dwordx4 v[48:51], v3, s[84:87], s40 offen offset:0 sc1
    v_cvt_pk_bf16_f32 v52, v140, v141
    v_cvt_pk_bf16_f32 v53, v142, v143
    v_cvt_pk_bf16_f32 v54, v176, v177
    v_cvt_pk_bf16_f32 v55, v178, v179
    buffer_store_dwordx4 v[52:55], v3, s[84:87], s40 offen offset:1024 sc1
    v_cvt_pk_bf16_f32 v56, v144, v145
    v_cvt_pk_bf16_f32 v57, v146, v147
    v_cvt_pk_bf16_f32 v58, v180, v181
    v_cvt_pk_bf16_f32 v59, v182, v183
    buffer_store_dwordx4 v[56:59], v3, s[84:87], s40 offen offset:2048 sc1
    v_cvt_pk_bf16_f32 v60, v148, v149
    v_cvt_pk_bf16_f32 v61, v150, v151
    v_cvt_pk_bf16_f32 v62, v184, v185
    v_cvt_pk_bf16_f32 v63, v186, v187
    buffer_store_dwordx4 v[60:63], v3, s[84:87], s40 offen offset:3072 sc1
    v_cvt_pk_bf16_f32 v64, v152, v153
    v_cvt_pk_bf16_f32 v65, v154, v155
    v_cvt_pk_bf16_f32 v66, v188, v189
    v_cvt_pk_bf16_f32 v67, v190, v191
    s_add_u32 s40, s40, 4096
    buffer_store_dwordx4 v[64:67], v3, s[84:87], s40 offen offset:0 sc1
    s_barrier
    s_waitcnt vmcnt(0)
    s_mov_b64 exec, 1
    buffer_atomic_add v192, v193, s[88:91], s49 offen
    s_mov_b64 exec, -1
    s_branch g2_phase_join_27
g2_phase_own_26:
    s_barrier
    ds_write_b128 v3, v[120:123] offset:0
    ds_write_b128 v3, v[124:127] offset:2048
    ds_write_b128 v3, v[128:131] offset:4096
    ds_write_b128 v3, v[132:135] offset:6144
    ds_write_b128 v3, v[136:139] offset:8192
    ds_write_b128 v3, v[140:143] offset:10240
    ds_write_b128 v3, v[144:147] offset:12288
    ds_write_b128 v3, v[148:151] offset:14336
    ds_write_b128 v3, v[152:155] offset:16384
    ds_write_b128 v3, v[156:159] offset:1024
    ds_write_b128 v3, v[160:163] offset:3072
    ds_write_b128 v3, v[164:167] offset:5120
    ds_write_b128 v3, v[168:171] offset:7168
    ds_write_b128 v3, v[172:175] offset:9216
    ds_write_b128 v3, v[176:179] offset:11264
    ds_write_b128 v3, v[180:183] offset:13312
    ds_write_b128 v3, v[184:187] offset:15360
    ds_write_b128 v3, v[188:191] offset:17408
    s_mov_b64 exec, 1
g2_phase_poll_28:
    buffer_load_dword v195, v193, s[88:91], s38 offen sc1
    s_waitcnt vmcnt(0)
    v_readfirstlane_b32 s39, v195
    s_cmp_ge_u32 s39, 3
    s_cbranch_scc1 g2_phase_pd_29
    s_sleep 2
    s_branch g2_phase_poll_28
g2_phase_pd_29:
    s_mov_b64 exec, -1
    s_waitcnt lgkmcnt(0)
g2_phase_join_27:
    s_barrier
    v_add_u32 v194, s15, v194
    s_add_u32 s15, s42, 0
    buffer_load_dwordx4 v[32:35], v3, s[84:87], s15 offen sc1
    s_add_u32 s15, s43, 0
    buffer_load_dwordx4 v[36:39], v3, s[84:87], s15 offen sc1
    s_add_u32 s15, s44, 0
    buffer_load_dwordx4 v[40:43], v3, s[84:87], s15 offen sc1
    ds_read_b128 v[44:47], v194 offset:0
    ds_read_b128 v[48:51], v194 offset:1024
    s_add_u32 s15, s42, 4096
    buffer_load_dwordx4 v[52:55], v3, s[84:87], s15 offen sc1
    s_add_u32 s15, s43, 4096
    buffer_load_dwordx4 v[56:59], v3, s[84:87], s15 offen sc1
    s_add_u32 s15, s44, 4096
    buffer_load_dwordx4 v[60:63], v3, s[84:87], s15 offen sc1
    ds_read_b128 v[64:67], v194 offset:8192
    ds_read_b128 v[68:71], v194 offset:9216
    s_cmp_lg_u32 s12, 0
    s_cbranch_scc1 g2_phase_sk_30
    s_add_u32 s15, s42, 8192
    buffer_load_dwordx4 v[72:75], v3, s[84:87], s15 offen sc1
    s_add_u32 s15, s43, 8192
    buffer_load_dwordx4 v[76:79], v3, s[84:87], s15 offen sc1
    s_add_u32 s15, s44, 8192
    buffer_load_dwordx4 v[80:83], v3, s[84:87], s15 offen sc1
    ds_read_b128 v[84:87], v194 offset:16384
    ds_read_b128 v[88:91], v194 offset:17408
g2_phase_sk_30:
    s_waitcnt vmcnt(3) lgkmcnt(2)
    v_lshlrev_b32 v196, 16, v32
    v_and_b32 v197, s45, v32
    v_lshlrev_b32 v198, 16, v33
    v_and_b32 v199, s45, v33
    v_pk_add_f32 v[44:45], v[44:45], v[196:197]
    v_pk_add_f32 v[46:47], v[46:47], v[198:199]
    v_lshlrev_b32 v200, 16, v36
    v_and_b32 v201, s45, v36
    v_lshlrev_b32 v202, 16, v37
    v_and_b32 v203, s45, v37
    v_pk_add_f32 v[44:45], v[44:45], v[200:201]
    v_pk_add_f32 v[46:47], v[46:47], v[202:203]
    v_lshlrev_b32 v196, 16, v40
    v_and_b32 v197, s45, v40
    v_lshlrev_b32 v198, 16, v41
    v_and_b32 v199, s45, v41
    v_pk_add_f32 v[44:45], v[44:45], v[196:197]
    v_pk_add_f32 v[46:47], v[46:47], v[198:199]
    v_lshlrev_b32 v204, 16, v20
    v_and_b32 v205, s45, v20
    v_lshlrev_b32 v206, 16, v21
    v_and_b32 v207, s45, v21
    v_add_f32 v44, v44, v12
    v_add_f32 v45, v45, v12
    v_add_f32 v46, v46, v12
    v_add_f32 v47, v47, v12
    v_pk_add_f32 v[44:45], v[44:45], v[204:205]
    v_pk_add_f32 v[46:47], v[46:47], v[206:207]
    v_cvt_pk_bf16_f32 v208, v44, v45
    v_cvt_pk_bf16_f32 v209, v46, v47
    ds_write_b64 v15, v[208:209] offset:0
    v_lshlrev_b32 v196, 16, v34
    v_and_b32 v197, s45, v34
    v_lshlrev_b32 v198, 16, v35
    v_and_b32 v199, s45, v35
    v_pk_add_f32 v[48:49], v[48:49], v[196:197]
    v_pk_add_f32 v[50:51], v[50:51], v[198:199]
    v_lshlrev_b32 v200, 16, v38
    v_and_b32 v201, s45, v38
    v_lshlrev_b32 v202, 16, v39
    v_and_b32 v203, s45, v39
    v_pk_add_f32 v[48:49], v[48:49], v[200:201]
    v_pk_add_f32 v[50:51], v[50:51], v[202:203]
    v_lshlrev_b32 v196, 16, v42
    v_and_b32 v197, s45, v42
    v_lshlrev_b32 v198, 16, v43
    v_and_b32 v199, s45, v43
    v_pk_add_f32 v[48:49], v[48:49], v[196:197]
    v_pk_add_f32 v[50:51], v[50:51], v[198:199]
    v_lshlrev_b32 v204, 16, v22
    v_and_b32 v205, s45, v22
    v_lshlrev_b32 v206, 16, v23
    v_and_b32 v207, s45, v23
    v_add_f32 v48, v48, v13
    v_add_f32 v49, v49, v13
    v_add_f32 v50, v50, v13
    v_add_f32 v51, v51, v13
    v_pk_add_f32 v[48:49], v[48:49], v[204:205]
    v_pk_add_f32 v[50:51], v[50:51], v[206:207]
    v_cvt_pk_bf16_f32 v210, v48, v49
    v_cvt_pk_bf16_f32 v211, v50, v51
    ds_write_b64 v15, v[210:211] offset:4864
    s_waitcnt vmcnt(0) lgkmcnt(2)
    v_lshlrev_b32 v196, 16, v52
    v_and_b32 v197, s45, v52
    v_lshlrev_b32 v198, 16, v53
    v_and_b32 v199, s45, v53
    v_pk_add_f32 v[64:65], v[64:65], v[196:197]
    v_pk_add_f32 v[66:67], v[66:67], v[198:199]
    v_lshlrev_b32 v200, 16, v56
    v_and_b32 v201, s45, v56
    v_lshlrev_b32 v202, 16, v57
    v_and_b32 v203, s45, v57
    v_pk_add_f32 v[64:65], v[64:65], v[200:201]
    v_pk_add_f32 v[66:67], v[66:67], v[202:203]
    v_lshlrev_b32 v196, 16, v60
    v_and_b32 v197, s45, v60
    v_lshlrev_b32 v198, 16, v61
    v_and_b32 v199, s45, v61
    v_pk_add_f32 v[64:65], v[64:65], v[196:197]
    v_pk_add_f32 v[66:67], v[66:67], v[198:199]
    v_lshlrev_b32 v204, 16, v24
    v_and_b32 v205, s45, v24
    v_lshlrev_b32 v206, 16, v25
    v_and_b32 v207, s45, v25
    v_add_f32 v64, v64, v12
    v_add_f32 v65, v65, v12
    v_add_f32 v66, v66, v12
    v_add_f32 v67, v67, v12
    v_pk_add_f32 v[64:65], v[64:65], v[204:205]
    v_pk_add_f32 v[66:67], v[66:67], v[206:207]
    v_cvt_pk_bf16_f32 v212, v64, v65
    v_cvt_pk_bf16_f32 v213, v66, v67
    ds_write_b64 v15, v[212:213] offset:128
    v_lshlrev_b32 v196, 16, v54
    v_and_b32 v197, s45, v54
    v_lshlrev_b32 v198, 16, v55
    v_and_b32 v199, s45, v55
    v_pk_add_f32 v[68:69], v[68:69], v[196:197]
    v_pk_add_f32 v[70:71], v[70:71], v[198:199]
    v_lshlrev_b32 v200, 16, v58
    v_and_b32 v201, s45, v58
    v_lshlrev_b32 v202, 16, v59
    v_and_b32 v203, s45, v59
    v_pk_add_f32 v[68:69], v[68:69], v[200:201]
    v_pk_add_f32 v[70:71], v[70:71], v[202:203]
    v_lshlrev_b32 v196, 16, v62
    v_and_b32 v197, s45, v62
    v_lshlrev_b32 v198, 16, v63
    v_and_b32 v199, s45, v63
    v_pk_add_f32 v[68:69], v[68:69], v[196:197]
    v_pk_add_f32 v[70:71], v[70:71], v[198:199]
    v_lshlrev_b32 v204, 16, v26
    v_and_b32 v205, s45, v26
    v_lshlrev_b32 v206, 16, v27
    v_and_b32 v207, s45, v27
    v_add_f32 v68, v68, v13
    v_add_f32 v69, v69, v13
    v_add_f32 v70, v70, v13
    v_add_f32 v71, v71, v13
    v_pk_add_f32 v[68:69], v[68:69], v[204:205]
    v_pk_add_f32 v[70:71], v[70:71], v[206:207]
    v_cvt_pk_bf16_f32 v214, v68, v69
    v_cvt_pk_bf16_f32 v215, v70, v71
    ds_write_b64 v15, v[214:215] offset:4992
    s_cmp_lg_u32 s12, 0
    s_cbranch_scc1 g2_phase_sk_31
    s_waitcnt vmcnt(0) lgkmcnt(4)
    v_lshlrev_b32 v196, 16, v72
    v_and_b32 v197, s45, v72
    v_lshlrev_b32 v198, 16, v73
    v_and_b32 v199, s45, v73
    v_pk_add_f32 v[84:85], v[84:85], v[196:197]
    v_pk_add_f32 v[86:87], v[86:87], v[198:199]
    v_lshlrev_b32 v200, 16, v76
    v_and_b32 v201, s45, v76
    v_lshlrev_b32 v202, 16, v77
    v_and_b32 v203, s45, v77
    v_pk_add_f32 v[84:85], v[84:85], v[200:201]
    v_pk_add_f32 v[86:87], v[86:87], v[202:203]
    v_lshlrev_b32 v196, 16, v80
    v_and_b32 v197, s45, v80
    v_lshlrev_b32 v198, 16, v81
    v_and_b32 v199, s45, v81
    v_pk_add_f32 v[84:85], v[84:85], v[196:197]
    v_pk_add_f32 v[86:87], v[86:87], v[198:199]
    v_lshlrev_b32 v204, 16, v28
    v_and_b32 v205, s45, v28
    v_lshlrev_b32 v206, 16, v29
    v_and_b32 v207, s45, v29
    v_add_f32 v84, v84, v12
    v_add_f32 v85, v85, v12
    v_add_f32 v86, v86, v12
    v_add_f32 v87, v87, v12
    v_pk_add_f32 v[84:85], v[84:85], v[204:205]
    v_pk_add_f32 v[86:87], v[86:87], v[206:207]
    v_cvt_pk_bf16_f32 v216, v84, v85
    v_cvt_pk_bf16_f32 v217, v86, v87
    ds_write_b64 v15, v[216:217] offset:256
    v_lshlrev_b32 v196, 16, v74
    v_and_b32 v197, s45, v74
    v_lshlrev_b32 v198, 16, v75
    v_and_b32 v199, s45, v75
    v_pk_add_f32 v[88:89], v[88:89], v[196:197]
    v_pk_add_f32 v[90:91], v[90:91], v[198:199]
    v_lshlrev_b32 v200, 16, v78
    v_and_b32 v201, s45, v78
    v_lshlrev_b32 v202, 16, v79
    v_and_b32 v203, s45, v79
    v_pk_add_f32 v[88:89], v[88:89], v[200:201]
    v_pk_add_f32 v[90:91], v[90:91], v[202:203]
    v_lshlrev_b32 v196, 16, v82
    v_and_b32 v197, s45, v82
    v_lshlrev_b32 v198, 16, v83
    v_and_b32 v199, s45, v83
    v_pk_add_f32 v[88:89], v[88:89], v[196:197]
    v_pk_add_f32 v[90:91], v[90:91], v[198:199]
    v_lshlrev_b32 v204, 16, v30
    v_and_b32 v205, s45, v30
    v_lshlrev_b32 v206, 16, v31
    v_and_b32 v207, s45, v31
    v_add_f32 v88, v88, v13
    v_add_f32 v89, v89, v13
    v_add_f32 v90, v90, v13
    v_add_f32 v91, v91, v13
    v_pk_add_f32 v[88:89], v[88:89], v[204:205]
    v_pk_add_f32 v[90:91], v[90:91], v[206:207]
    v_cvt_pk_bf16_f32 v218, v88, v89
    v_cvt_pk_bf16_f32 v219, v90, v91
    ds_write_b64 v15, v[218:219] offset:5120
g2_phase_sk_31:
    s_waitcnt lgkmcnt(0)
    s_barrier
    ds_read_b128 v[32:35], v16
    ds_read_b128 v[36:39], v17
    ds_read_b128 v[40:43], v18
    s_waitcnt lgkmcnt(2)
    buffer_store_dwordx4 v[32:35], v4, s[24:27], s36 offen
    s_waitcnt lgkmcnt(1)
    buffer_store_dwordx4 v[36:39], v5, s[24:27], s36 offen
    s_cmp_lg_u32 s12, 0
    s_cbranch_scc1 g2_phase_sk_32
    s_waitcnt lgkmcnt(0)
    buffer_store_dwordx4 v[40:43], v19, s[24:27], s36 offen
g2_phase_sk_32:
    s_mov_b64 exec, -1
    s_endpgm
    s_endpgm
.section .rodata,"a"
.p2align 6
.amdhsa_kernel sequential_preLN__linear_kernel_hedgehog__mixer_token_mlp__prompt_kernel
  .amdhsa_next_free_vgpr 256
  .amdhsa_next_free_sgpr 102
  .amdhsa_accum_offset 256
  .amdhsa_group_segment_fixed_size 0
  .amdhsa_kernarg_size 96
  .amdhsa_user_sgpr_count 2
  .amdhsa_user_sgpr_kernarg_segment_ptr 1
  .amdhsa_system_sgpr_workgroup_id_x 1
.end_amdhsa_kernel
.text
.Lcode_end:
    s_endpgm
```
